```python
import torch

def _softmax(x, axis=-1):
    return torch.softmax(x, dim=axis)
def _gelu(x):
    return torch.nn.functional.gelu(x, approximate="tanh")
def _silu(x):
    return torch.nn.functional.silu(x)
def _sigmoid(x):
    return torch.sigmoid(x)
def _layernorm(x, axis=-1, eps=1e-5):
    m = x.mean(dim=axis, keepdim=True)
    v = x.var(dim=axis, keepdim=True, unbiased=False)
    return (x - m) / torch.sqrt(v + eps)
def _scatter_add(tgt, idx, src, axis=0):
    return tgt.clone().index_add_(axis, idx, src)
def _segment_sum(src, seg, n):
    out = torch.zeros((n,) + src.shape[1:], dtype=src.dtype)
    return out.index_add_(0, seg, src)
def _pad(x, pw):
    flat = tuple(v for pair in reversed(pw) for v in pair)
    return torch.nn.functional.pad(x, flat)

kernel_name = 'concat_heads__gqa_block_cached__gqa_block_cached__near_ridge'

def setup_inputs():

    _w = (lambda a: (lambda t: t.to(torch.bfloat16) if t.is_floating_point() else t)(torch.as_tensor(a)))
    def _A_setup():
        B, Sq, D = 16, 112, 576
        Hq, Hkv, Sk, Dh = 32, 16, 512, 128
        assert Hq % Hkv == 0, (Hq, Hkv)
        return {
            "x": _w((lambda *s: torch.randn(*s, dtype=torch.bfloat16) * 0.8)(B, Sq, D)),
            "k_cache": _w((lambda *s: torch.randn(*s, dtype=torch.bfloat16) * 0.8)(B, Hkv, Sk, Dh)),
            "v_cache": _w((lambda *s: torch.randn(*s, dtype=torch.bfloat16) * 0.05)(B, Hkv, Sk, Dh)),
            "wq": _w((lambda *s: torch.randn(*s, dtype=torch.bfloat16) * 0.8)(D, Hq * Dh) * (D ** -0.5)),
            "wo": _w((lambda *s: torch.randn(*s, dtype=torch.bfloat16) * 0.05)(Hq * Dh, D) * ((Hq * Dh) ** -0.5)),
        }
    _A_in = _A_setup()

    def _B_setup():
        B, Sq, D = 16, 112, 576
        Hq, Hkv, Sk, Dh = 32, 16, 512, 128
        assert Hq % Hkv == 0, (Hq, Hkv)
        return {
            "x": _w((lambda *s: torch.randn(*s, dtype=torch.bfloat16) * 0.8)(B, Sq, D)),
            "k_cache": _w((lambda *s: torch.randn(*s, dtype=torch.bfloat16) * 0.8)(B, Hkv, Sk, Dh)),
            "v_cache": _w((lambda *s: torch.randn(*s, dtype=torch.bfloat16) * 0.05)(B, Hkv, Sk, Dh)),
            "wq": _w((lambda *s: torch.randn(*s, dtype=torch.bfloat16) * 0.8)(D, Hq * Dh) * (D ** -0.5)),
            "wo": _w((lambda *s: torch.randn(*s, dtype=torch.bfloat16) * 0.05)(Hq * Dh, D) * ((Hq * Dh) ** -0.5)),
        }
    _B_in = _B_setup()

    return {
        "A_x": _A_in["x"],
        "A_k_cache": _A_in["k_cache"],
        "A_v_cache": _A_in["v_cache"],
        "A_wq": _A_in["wq"],
        "A_wo": _A_in["wo"],
        "B_x": _B_in["x"],
        "B_k_cache": _B_in["k_cache"],
        "B_v_cache": _B_in["v_cache"],
        "B_wq": _B_in["wq"],
        "B_wo": _B_in["wo"],
    }

def reference(A_x, A_k_cache, A_v_cache, A_wq, A_wo, B_x, B_k_cache, B_v_cache, B_wq, B_wo):
    def _A_ref(x, k_cache, v_cache, wq, wo):
        B, Sq, D = x.shape
        Hq, Dh = 32, 128
        Hkv = k_cache.shape[1]
        rep = Hq // Hkv
        q = (lambda x, *d: x.permute(*d))((x @ wq).reshape(B, Sq, Hq, Dh), 0, 2, 1, 3)
        k = (lambda x, n, axis: torch.repeat_interleave(x, n, dim=axis))(k_cache, rep, axis=1)
        v = (lambda x, n, axis: torch.repeat_interleave(x, n, dim=axis))(v_cache, rep, axis=1)
        scores = torch.einsum("bhqd,bhkd->bhqk", q, k) * (Dh ** -0.5)
        p = _softmax(scores, axis=-1)
        o = torch.einsum("bhqk,bhkd->bhqd", p, v)
        return (lambda x, *d: x.permute(*d))(o, 0, 2, 1, 3).reshape(B, Sq, Hq * Dh) @ wo

    def _B_ref(x, k_cache, v_cache, wq, wo):
        B, Sq, D = x.shape
        Hq, Dh = 32, 128
        Hkv = k_cache.shape[1]
        rep = Hq // Hkv
        q = (lambda x, *d: x.permute(*d))((x @ wq).reshape(B, Sq, Hq, Dh), 0, 2, 1, 3)
        k = (lambda x, n, axis: torch.repeat_interleave(x, n, dim=axis))(k_cache, rep, axis=1)
        v = (lambda x, n, axis: torch.repeat_interleave(x, n, dim=axis))(v_cache, rep, axis=1)
        scores = torch.einsum("bhqd,bhkd->bhqk", q, k) * (Dh ** -0.5)
        p = _softmax(scores, axis=-1)
        o = torch.einsum("bhqk,bhkd->bhqd", p, v)
        return (lambda x, *d: x.permute(*d))(o, 0, 2, 1, 3).reshape(B, Sq, Hq * Dh) @ wo

    a = _A_ref(A_x, A_k_cache, A_v_cache, A_wq, A_wo)
    b = _B_ref(B_x, B_k_cache, B_v_cache, B_wq, B_wo)
    return torch.concatenate([a, b], axis=-1)
```

```asm
; @launch grid=(256,1,1) block=(256,1,1) lds=163840
.amdgcn_target "amdgcn-amd-amdhsa--gfx950"
.text
.globl concat_heads__gqa_block_cached__gqa_block_cached__near_ridge_kernel
.p2align 8
.type concat_heads__gqa_block_cached__gqa_block_cached__near_ridge_kernel,@function
concat_heads__gqa_block_cached__gqa_block_cached__near_ridge_kernel:
    s_cmp_ge_u32 s2, 256
    s_cbranch_scc1 L_end
    s_load_dwordx8 s[8:15], s[0:1], 0
    s_load_dwordx8 s[16:23], s[0:1], 40
    s_load_dwordx2 s[6:7], s[0:1], 32
    s_load_dwordx8 s[80:87], s[0:1], 72
    v_lshrrev_b32 v1, 6, v0
    v_and_b32 v224, 63, v0
    v_readfirstlane_b32 s26, v1
    s_and_b32 s3, s2, 7
    s_lshr_b32 s33, s2, 3
    s_lshr_b32 s30, s3, 2
    s_and_b32 s34, s3, 3
    s_lshl_b32 s31, s34, 1
    s_and_b32 s4, s33, 1
    s_or_b32 s31, s31, s4
    s_lshr_b32 s32, s33, 1
    s_sub_u32 s5, s32, 9
    s_cmp_ge_u32 s32, 9
    s_cselect_b32 s73, s5, s32
    s_lshl_b32 s58, s73, 19
    s_lshl_b32 s59, s73, 7
    s_lshl_b32 s24, s30, 4
    s_add_u32 s24, s24, s32
    s_lshr_b32 s27, s26, 1
    s_and_b32 s28, s26, 1
    v_and_b32 v225, 15, v224
    v_lshrrev_b32 v226, 4, v224
    v_and_b32 v227, 3, v225
    v_bfe_u32 v228, v225, 2, 1
    v_lshl_add_u32 v227, v227, 1, v228
    v_and_b32 v228, 8, v225
    v_add_lshl_u32 v227, v227, v228, 4
    v_lshl_add_u32 v229, v226, 16, v227
    s_min_u32 s3, s26, 1
    s_mul_i32 s4, s26, 3
    s_add_u32 s5, s3, s4
    v_lshrrev_b32 v227, 3, v224
    v_mul_u32_u24 v227, 1152, v227
    v_and_b32 v228, 7, v224
    v_xor_b32 v228, v228, v226
    v_lshl_add_u32 v227, v228, 4, v227
    s_and_b32 s3, s5, 1
    s_lshl_b32 s3, s3, 6
    v_xor_b32 v227, s3, v227
    v_xor_b32 v228, 64, v227
    s_mul_i32 s3, s5, 9216
    v_add_u32 v236, s3, v227
    s_add_u32 s3, s3, 8192
    v_add_u32 v237, s3, v228
    v_add_u32 v238, 16384, v236
    v_add_u32 v239, 16384, v237
    s_lshl_b32 s3, s5, 10
    s_add_u32 s57, s3, 135168
    s_mov_b32 s92, 0x05040100
    s_mov_b32 s93, 0x07060302
    s_mov_b32 s69, 0x40000000
    s_waitcnt lgkmcnt(0)
    s_cmp_eq_u32 s30, 0
    s_cselect_b64 s[8:9], s[8:9], s[16:17]
    s_cselect_b64 s[10:11], s[10:11], s[18:19]
    s_cselect_b64 s[12:13], s[12:13], s[20:21]
    s_cselect_b64 s[14:15], s[14:15], s[22:23]
    s_cselect_b64 s[6:7], s[6:7], s[80:81]
    s_lshl_b32 s35, s31, 2
    s_add_u32 s35, s35, s26
    s_lshl_b32 s3, s35, 8
    s_add_u32 s36, s14, s3
    s_addc_u32 s37, s15, 0
    s_sub_u32 s38, 4718592, s3
    s_mov_b32 s39, 0x00020000
    s_mul_i32 s3, s32, 129024
    s_add_u32 s40, s8, s3
    s_addc_u32 s41, s9, 0
    s_mov_b32 s42, 129024
    s_mov_b32 s43, 0x00020000
    buffer_load_dwordx4 v[128:131], v229, s[36:39], s58 offen
    s_add_u32 s58, s58, 8192
    buffer_load_dwordx4 v[132:135], v229, s[36:39], s58 offen
    s_add_u32 s58, s58, 8192
    buffer_load_dwordx4 v[136:139], v229, s[36:39], s58 offen
    s_add_u32 s58, s58, 8192
    buffer_load_dwordx4 v[140:143], v229, s[36:39], s58 offen
    s_add_u32 s58, s58, 8192
    buffer_load_dwordx4 v[144:147], v229, s[36:39], s58 offen
    s_add_u32 s58, s58, 8192
    buffer_load_dwordx4 v[148:151], v229, s[36:39], s58 offen
    s_add_u32 s58, s58, 8192
    buffer_load_dwordx4 v[152:155], v229, s[36:39], s58 offen
    s_add_u32 s58, s58, 8192
    buffer_load_dwordx4 v[156:159], v229, s[36:39], s58 offen
    s_add_u32 s58, s58, 204800
    s_cmp_ge_u32 s58, 4718592
    s_cselect_b32 s58, 0, s58
    s_add_u32 m0, s57, 0
    s_mov_b32 s61, s59
    buffer_load_dwordx4 v236, s[40:43], s61 offen offset:0 lds
    buffer_load_dwordx4 v237, s[40:43], s61 offen offset:1024 lds
    buffer_load_dwordx4 v238, s[40:43], s61 offen offset:2048 lds
    buffer_load_dwordx4 v239, s[40:43], s61 offen offset:3072 lds
    s_add_u32 s59, s59, 128
    s_cmp_ge_u32 s59, 1152
    s_cselect_b32 s59, 0, s59
    s_add_u32 s52, s86, 41943040
    s_addc_u32 s53, s87, 0
    s_movk_i32 s54, 16384
    s_mov_b32 s55, 0x00020000
    s_lshl_b32 s74, s24, 9
    s_lshl_b32 s3, s26, 7
    s_add_u32 s74, s74, s3
    s_lshl_b32 s3, s31, 3
    s_add_u32 s25, s74, s3
    s_mov_b32 s76, s84
    s_mov_b32 s77, s85
    s_movk_i32 s78, 256
    s_mov_b32 s79, 0x00020000
    v_mov_b32 v227, 0x40000000
    v_cmp_eq_u32 vcc, 0, v224
    s_nop 1
    v_cndmask_b32 v233, v227, v224, vcc
    v_mov_b32 v234, 0
    v_mov_b32 v235, 0
    s_lshl_b32 s75, s24, 2
    s_add_u32 s75, s75, 128
    buffer_store_dwordx2 v[234:235], v233, s[52:55], s25 offen sc1
    s_and_b32 s3, s33, 1
    s_mul_i32 s3, s3, 168
    s_mul_i32 s4, s26, 42
    s_add_u32 s3, s3, s4
    v_add_u32 v227, s3, v224
    v_mul_u32_u24 v228, 171, v227
    v_lshrrev_b32 v228, 9, v228
    v_mul_u32_u24 v244, 1152, v228
    v_mul_u32_u24 v228, 3, v228
    v_sub_u32 v248, v227, v228
    v_add_u32 v248, s73, v248
    v_add_u32 v248, 0, v248
    v_mov_b32 v227, 0x40000000
    v_cmp_gt_u32 vcc, 42, v224
    s_nop 1
    v_cndmask_b32 v244, v227, v244, vcc
    v_subrev_u32 v227, 9, v248
    v_min_u32 v248, v227, v248
    v_lshl_add_u32 v227, v248, 7, v244
    v_add_u32 v248, 3, v248
    buffer_load_dword v231, v227, s[40:43], 0 offen
    s_getpc_b64 s[44:45]
L_pc:
    s_mov_b32 s46, L_end-L_pc
    s_mov_b32 s47, 0x00020000
    s_lshl_b32 s3, s33, 2
    s_add_u32 s3, s3, s26
    s_lshl_b32 s3, s3, 9
    v_lshlrev_b32 v228, 7, v224
    v_mov_b32 v227, 0x40000000
    v_cmp_gt_u32 vcc, 4, v224
    s_nop 1
    v_cndmask_b32 v228, v227, v228, vcc
    s_mov_b32 s22, s3
    s_mov_b32 s101, s3
    s_mov_b64 s[16:17], s[44:45]
    s_mov_b32 s18, s46
    s_mov_b32 s19, 0x00020000
    v_mov_b32 v249, v228
    buffer_load_dword v231, v249, s[44:47], s22 offen
    buffer_load_dwordx4 v[160:163], v229, s[36:39], s58 offen
    s_add_u32 s58, s58, 8192
    buffer_load_dwordx4 v[164:167], v229, s[36:39], s58 offen
    s_add_u32 s58, s58, 8192
    buffer_load_dwordx4 v[168:171], v229, s[36:39], s58 offen
    s_add_u32 s58, s58, 8192
    buffer_load_dwordx4 v[172:175], v229, s[36:39], s58 offen
    s_add_u32 s58, s58, 8192
    buffer_load_dwordx4 v[176:179], v229, s[36:39], s58 offen
    s_add_u32 s58, s58, 8192
    buffer_load_dwordx4 v[180:183], v229, s[36:39], s58 offen
    s_add_u32 s58, s58, 8192
    buffer_load_dwordx4 v[184:187], v229, s[36:39], s58 offen
    s_add_u32 s58, s58, 8192
    buffer_load_dwordx4 v[188:191], v229, s[36:39], s58 offen
    s_add_u32 s58, s58, 204800
    s_cmp_ge_u32 s58, 4718592
    s_cselect_b32 s58, 0, s58
    s_cmp_eq_u32 s28, 0
    s_cselect_b64 s[48:49], s[10:11], s[12:13]
    s_lshl_b32 s3, s32, 4
    s_lshl_b32 s4, s31, 1
    s_add_u32 s3, s3, s4
    s_add_u32 s3, s3, s27
    s_lshl_b32 s29, s3, 17
    s_add_u32 s48, s48, s29
    s_addc_u32 s49, s49, 0
    s_sub_u32 s48, s48, 4096
    s_subb_u32 s49, s49, 0
    s_mov_b32 s50, 135168
    s_mov_b32 s51, 0x00020000
    v_lshlrev_b32 v228, 4, v224
    v_add_u32 v240, 4096, v228
    v_add_u32 v241, 3040, v228
    v_add_u32 v242, 1984, v228
    v_add_u32 v243, 928, v228
    s_mul_i32 s4, s27, 16896
    s_mul_i32 s3, s28, 8448
    s_add_u32 s67, s4, s3
    s_add_u32 s68, s67, 135168
    s_lshl_b32 s3, s2, 1
    s_add_u32 s3, s3, s27
    s_mul_i32 s3, s3, 0x9e37
    s_lshr_b32 s3, s3, 3
    s_and_b32 s3, s3, 127
    s_lshl_b32 s62, s3, 10
    s_mov_b32 s66, 0
    v_lshrrev_b32 v245, 2, v225
    v_and_b32 v228, 1, v226
    v_lshl_or_b32 v245, v228, 2, v245
    v_mul_u32_u24 v246, 1056, v245
    v_and_b32 v228, 3, v225
    v_lshl_add_u32 v246, v228, 3, v246
    v_lshrrev_b32 v228, 1, v226
    v_lshl_add_u32 v246, v228, 8, v246
    s_add_u32 s3, s4, 8448
    v_add_u32 v246, s3, v246
    v_and_b32 v228, 7, v225
    v_mul_u32_u24 v245, 1056, v228
    v_lshrrev_b32 v228, 3, v225
    v_lshl_add_u32 v245, v228, 8, v245
    v_and_b32 v228, 1, v226
    v_lshl_add_u32 v245, v228, 4, v245
    v_lshrrev_b32 v228, 1, v226
    v_lshl_add_u32 v245, v228, 7, v245
    v_add_u32 v245, s4, v245
    v_lshrrev_b32 v228, 1, v225
    v_xor_b32 v228, v228, v226
    v_lshlrev_b32 v228, 4, v228
    v_lshl_add_u32 v230, v225, 7, v228
    v_add_u32 v230, 135168, v230
    v_xor_b32 v232, 64, v230
    s_mov_b32 s64, 0x3e0293ee
    s_mov_b32 s65, 0x3e0293ee
    v_mov_b32 v234, 1
    s_cmp_eq_u32 s26, 0
    s_cselect_b32 s3, 0, s69
    v_or_b32 v235, s3, v233
    s_waitcnt vmcnt(11)
    s_barrier
    ds_read_b128 a[128:131], v230 offset:0
    ds_read_b128 a[132:135], v230 offset:2048
    ds_read_b128 a[136:139], v230 offset:4096
    ds_read_b128 a[140:143], v230 offset:6144
    ds_read_b128 a[144:147], v230 offset:8192
    ds_read_b128 a[148:151], v230 offset:10240
    ds_read_b128 a[152:155], v230 offset:12288
    v_perm_b32 v96, v132, v128, s92
    v_perm_b32 v97, v140, v136, s92
    v_perm_b32 v98, v148, v144, s92
    v_perm_b32 v99, v156, v152, s92
    v_perm_b32 v100, v132, v128, s93
    v_perm_b32 v101, v140, v136, s93
    v_perm_b32 v102, v148, v144, s93
    v_perm_b32 v103, v156, v152, s93
    v_perm_b32 v104, v133, v129, s92
    v_perm_b32 v105, v141, v137, s92
    v_perm_b32 v106, v149, v145, s92
    v_perm_b32 v107, v157, v153, s92
    v_perm_b32 v108, v133, v129, s93
    v_perm_b32 v109, v141, v137, s93
    v_perm_b32 v110, v149, v145, s93
    v_perm_b32 v111, v157, v153, s93
    v_perm_b32 v112, v134, v130, s92
    v_perm_b32 v113, v142, v138, s92
    v_perm_b32 v114, v150, v146, s92
    v_perm_b32 v115, v158, v154, s92
    v_perm_b32 v116, v134, v130, s93
    v_perm_b32 v117, v142, v138, s93
    v_perm_b32 v118, v150, v146, s93
    v_perm_b32 v119, v158, v154, s93
    v_perm_b32 v120, v135, v131, s92
    v_perm_b32 v121, v143, v139, s92
    v_perm_b32 v122, v151, v147, s92
    v_perm_b32 v123, v159, v155, s92
    v_perm_b32 v124, v135, v131, s93
    v_perm_b32 v125, v143, v139, s93
    v_perm_b32 v126, v151, v147, s93
    v_perm_b32 v127, v159, v155, s93
    s_waitcnt lgkmcnt(0)
    v_mfma_f32_16x16x32_bf16 v[0:3], v[96:99], a[128:131], 0
    v_mfma_f32_16x16x32_bf16 v[32:35], v[96:99], a[132:135], 0
    v_mfma_f32_16x16x32_bf16 v[64:67], v[96:99], a[136:139], 0
    s_add_u32 m0, s57, 14336
    s_mov_b32 s61, s59
    buffer_load_dwordx4 v236, s[40:43], s61 offen offset:0 lds
    v_mfma_f32_16x16x32_bf16 a[0:3], v[96:99], a[140:143], 0
    v_mfma_f32_16x16x32_bf16 a[32:35], v[96:99], a[144:147], 0
    v_mfma_f32_16x16x32_bf16 a[64:67], v[96:99], a[148:151], 0
    v_mfma_f32_16x16x32_bf16 a[96:99], v[96:99], a[152:155], 0
    s_waitcnt vmcnt(1)
    buffer_load_dwordx4 v237, s[40:43], s61 offen offset:1024 lds
    v_mfma_f32_16x16x32_bf16 v[4:7], v[100:103], a[128:131], 0
    v_perm_b32 v96, v164, v160, s92
    v_perm_b32 v97, v172, v168, s92
    v_mfma_f32_16x16x32_bf16 v[36:39], v[100:103], a[132:135], 0
    v_perm_b32 v98, v180, v176, s92
    v_perm_b32 v99, v188, v184, s92
    v_mfma_f32_16x16x32_bf16 v[68:71], v[100:103], a[136:139], 0
    v_mfma_f32_16x16x32_bf16 a[4:7], v[100:103], a[140:143], 0
    buffer_load_dwordx4 v238, s[40:43], s61 offen offset:2048 lds
    v_mfma_f32_16x16x32_bf16 a[36:39], v[100:103], a[144:147], 0
    v_mfma_f32_16x16x32_bf16 a[68:71], v[100:103], a[148:151], 0
    v_mfma_f32_16x16x32_bf16 a[100:103], v[100:103], a[152:155], 0
    v_mfma_f32_16x16x32_bf16 v[8:11], v[104:107], a[128:131], 0
    v_perm_b32 v100, v164, v160, s93
    v_perm_b32 v101, v172, v168, s93
    v_mfma_f32_16x16x32_bf16 v[40:43], v[104:107], a[132:135], 0
    v_perm_b32 v102, v180, v176, s93
    v_perm_b32 v103, v188, v184, s93
    v_mfma_f32_16x16x32_bf16 v[72:75], v[104:107], a[136:139], 0
    buffer_load_dwordx4 v239, s[40:43], s61 offen offset:3072 lds
    s_add_u32 s59, s59, 128
    s_cmp_ge_u32 s59, 1152
    s_cselect_b32 s59, 0, s59
    v_mfma_f32_16x16x32_bf16 a[8:11], v[104:107], a[140:143], 0
    v_mfma_f32_16x16x32_bf16 a[40:43], v[104:107], a[144:147], 0
    buffer_load_dwordx4 v[192:195], v229, s[36:39], s58 offen
    s_add_u32 s58, s58, 8192
    v_mfma_f32_16x16x32_bf16 a[72:75], v[104:107], a[148:151], 0
    v_mfma_f32_16x16x32_bf16 a[104:107], v[104:107], a[152:155], 0
    v_mfma_f32_16x16x32_bf16 v[12:15], v[108:111], a[128:131], 0
    v_perm_b32 v104, v165, v161, s92
    v_perm_b32 v105, v173, v169, s92
    v_mfma_f32_16x16x32_bf16 v[44:47], v[108:111], a[132:135], 0
    v_perm_b32 v106, v181, v177, s92
    v_perm_b32 v107, v189, v185, s92
    v_mfma_f32_16x16x32_bf16 v[76:79], v[108:111], a[136:139], 0
    buffer_load_dwordx4 v[196:199], v229, s[36:39], s58 offen
    s_add_u32 s58, s58, 8192
    v_mfma_f32_16x16x32_bf16 a[12:15], v[108:111], a[140:143], 0
    v_mfma_f32_16x16x32_bf16 a[44:47], v[108:111], a[144:147], 0
    v_mfma_f32_16x16x32_bf16 a[76:79], v[108:111], a[148:151], 0
    buffer_load_dwordx4 v[200:203], v229, s[36:39], s58 offen
    s_add_u32 s58, s58, 8192
    v_mfma_f32_16x16x32_bf16 a[108:111], v[108:111], a[152:155], 0
    v_mfma_f32_16x16x32_bf16 v[16:19], v[112:115], a[128:131], 0
    v_perm_b32 v108, v165, v161, s93
    v_perm_b32 v109, v173, v169, s93
    v_mfma_f32_16x16x32_bf16 v[48:51], v[112:115], a[132:135], 0
    v_perm_b32 v110, v181, v177, s93
    v_perm_b32 v111, v189, v185, s93
    v_mfma_f32_16x16x32_bf16 v[80:83], v[112:115], a[136:139], 0
    buffer_load_dwordx4 v[204:207], v229, s[36:39], s58 offen
    s_add_u32 s58, s58, 8192
    v_mfma_f32_16x16x32_bf16 a[16:19], v[112:115], a[140:143], 0
    v_mfma_f32_16x16x32_bf16 a[48:51], v[112:115], a[144:147], 0
    v_mfma_f32_16x16x32_bf16 a[80:83], v[112:115], a[148:151], 0
    v_mfma_f32_16x16x32_bf16 a[112:115], v[112:115], a[152:155], 0
    buffer_load_dwordx4 v[208:211], v229, s[36:39], s58 offen
    s_add_u32 s58, s58, 8192
    v_mfma_f32_16x16x32_bf16 v[20:23], v[116:119], a[128:131], 0
    v_perm_b32 v112, v166, v162, s92
    v_perm_b32 v113, v174, v170, s92
    v_mfma_f32_16x16x32_bf16 v[52:55], v[116:119], a[132:135], 0
    ds_read_b128 a[156:159], v232 offset:0
    v_perm_b32 v114, v182, v178, s92
    v_perm_b32 v115, v190, v186, s92
    v_mfma_f32_16x16x32_bf16 v[84:87], v[116:119], a[136:139], 0
    v_mfma_f32_16x16x32_bf16 a[20:23], v[116:119], a[140:143], 0
    ds_read_b128 a[160:163], v232 offset:2048
    buffer_load_dwordx4 v[212:215], v229, s[36:39], s58 offen
    s_add_u32 s58, s58, 8192
    v_mfma_f32_16x16x32_bf16 a[52:55], v[116:119], a[144:147], 0
    v_mfma_f32_16x16x32_bf16 a[84:87], v[116:119], a[148:151], 0
    ds_read_b128 a[164:167], v232 offset:4096
    v_mfma_f32_16x16x32_bf16 a[116:119], v[116:119], a[152:155], 0
    v_mfma_f32_16x16x32_bf16 v[24:27], v[120:123], a[128:131], 0
    ds_read_b128 a[168:171], v232 offset:6144
    v_perm_b32 v116, v166, v162, s93
    v_perm_b32 v117, v174, v170, s93
    v_mfma_f32_16x16x32_bf16 v[56:59], v[120:123], a[132:135], 0
    v_perm_b32 v118, v182, v178, s93
    v_perm_b32 v119, v190, v186, s93
    v_mfma_f32_16x16x32_bf16 v[88:91], v[120:123], a[136:139], 0
    ds_read_b128 a[172:175], v232 offset:8192
    buffer_load_dwordx4 v[216:219], v229, s[36:39], s58 offen
    s_add_u32 s58, s58, 8192
    v_mfma_f32_16x16x32_bf16 a[24:27], v[120:123], a[140:143], 0
    v_mfma_f32_16x16x32_bf16 a[56:59], v[120:123], a[144:147], 0
    ds_read_b128 a[176:179], v232 offset:10240
    buffer_load_dwordx4 v[220:223], v229, s[36:39], s58 offen
    s_add_u32 s58, s58, 204800
    s_cmp_ge_u32 s58, 4718592
    s_cselect_b32 s58, 0, s58
    v_mfma_f32_16x16x32_bf16 a[88:91], v[120:123], a[148:151], 0
    v_mfma_f32_16x16x32_bf16 a[120:123], v[120:123], a[152:155], 0
    ds_read_b128 a[180:183], v232 offset:12288
    v_mfma_f32_16x16x32_bf16 v[28:31], v[124:127], a[128:131], 0
    v_perm_b32 v120, v167, v163, s92
    v_perm_b32 v121, v175, v171, s92
    v_mfma_f32_16x16x32_bf16 v[60:63], v[124:127], a[132:135], 0
    v_perm_b32 v122, v183, v179, s92
    v_perm_b32 v123, v191, v187, s92
    v_mfma_f32_16x16x32_bf16 v[92:95], v[124:127], a[136:139], 0
    buffer_load_dwordx4 v[128:131], v229, s[36:39], s58 offen
    s_add_u32 s58, s58, 8192
    v_mfma_f32_16x16x32_bf16 a[28:31], v[124:127], a[140:143], 0
    v_mfma_f32_16x16x32_bf16 a[60:63], v[124:127], a[144:147], 0
    v_mfma_f32_16x16x32_bf16 a[92:95], v[124:127], a[148:151], 0
    v_mfma_f32_16x16x32_bf16 a[124:127], v[124:127], a[152:155], 0
    s_waitcnt lgkmcnt(0)
    v_mfma_f32_16x16x32_bf16 v[0:3], v[96:99], a[156:159], v[0:3]
    v_perm_b32 v124, v167, v163, s93
    v_perm_b32 v125, v175, v171, s93
    v_mfma_f32_16x16x32_bf16 v[32:35], v[96:99], a[160:163], v[32:35]
    v_perm_b32 v126, v183, v179, s93
    v_perm_b32 v127, v191, v187, s93
    v_mfma_f32_16x16x32_bf16 v[64:67], v[96:99], a[164:167], v[64:67]
    buffer_load_dwordx4 v[132:135], v229, s[36:39], s58 offen
    s_add_u32 s58, s58, 8192
    v_mfma_f32_16x16x32_bf16 a[0:3], v[96:99], a[168:171], a[0:3]
    v_mfma_f32_16x16x32_bf16 a[32:35], v[96:99], a[172:175], a[32:35]
    buffer_load_dwordx4 v[136:139], v229, s[36:39], s58 offen
    s_add_u32 s58, s58, 8192
    v_mfma_f32_16x16x32_bf16 a[64:67], v[96:99], a[176:179], a[64:67]
    v_mfma_f32_16x16x32_bf16 a[96:99], v[96:99], a[180:183], a[96:99]
    s_waitcnt vmcnt(3)
    v_mfma_f32_16x16x32_bf16 v[4:7], v[100:103], a[156:159], v[4:7]
    v_perm_b32 v96, v196, v192, s92
    v_perm_b32 v97, v204, v200, s92
    v_mfma_f32_16x16x32_bf16 v[36:39], v[100:103], a[160:163], v[36:39]
    v_perm_b32 v98, v212, v208, s92
    v_perm_b32 v99, v220, v216, s92
    v_mfma_f32_16x16x32_bf16 v[68:71], v[100:103], a[164:167], v[68:71]
    buffer_load_dwordx4 v[140:143], v229, s[36:39], s58 offen
    s_add_u32 s58, s58, 8192
    v_mfma_f32_16x16x32_bf16 a[4:7], v[100:103], a[168:171], a[4:7]
    v_mfma_f32_16x16x32_bf16 a[36:39], v[100:103], a[172:175], a[36:39]
    v_mfma_f32_16x16x32_bf16 a[68:71], v[100:103], a[176:179], a[68:71]
    buffer_load_dwordx4 v[144:147], v229, s[36:39], s58 offen
    s_add_u32 s58, s58, 8192
    v_mfma_f32_16x16x32_bf16 a[100:103], v[100:103], a[180:183], a[100:103]
    v_mfma_f32_16x16x32_bf16 v[8:11], v[104:107], a[156:159], v[8:11]
    v_perm_b32 v100, v196, v192, s93
    v_perm_b32 v101, v204, v200, s93
    v_mfma_f32_16x16x32_bf16 v[40:43], v[104:107], a[160:163], v[40:43]
    v_perm_b32 v102, v212, v208, s93
    v_perm_b32 v103, v220, v216, s93
    v_mfma_f32_16x16x32_bf16 v[72:75], v[104:107], a[164:167], v[72:75]
    buffer_load_dwordx4 v[148:151], v229, s[36:39], s58 offen
    s_add_u32 s58, s58, 8192
    v_mfma_f32_16x16x32_bf16 a[8:11], v[104:107], a[168:171], a[8:11]
    v_mfma_f32_16x16x32_bf16 a[40:43], v[104:107], a[172:175], a[40:43]
    v_mfma_f32_16x16x32_bf16 a[72:75], v[104:107], a[176:179], a[72:75]
    v_mfma_f32_16x16x32_bf16 a[104:107], v[104:107], a[180:183], a[104:107]
    buffer_load_dwordx4 v[152:155], v229, s[36:39], s58 offen
    s_add_u32 s58, s58, 8192
    v_mfma_f32_16x16x32_bf16 v[12:15], v[108:111], a[156:159], v[12:15]
    v_perm_b32 v104, v197, v193, s92
    v_perm_b32 v105, v205, v201, s92
    v_mfma_f32_16x16x32_bf16 v[44:47], v[108:111], a[160:163], v[44:47]
    v_perm_b32 v106, v213, v209, s92
    v_perm_b32 v107, v221, v217, s92
    v_mfma_f32_16x16x32_bf16 v[76:79], v[108:111], a[164:167], v[76:79]
    v_mfma_f32_16x16x32_bf16 a[12:15], v[108:111], a[168:171], a[12:15]
    buffer_load_dwordx4 v[156:159], v229, s[36:39], s58 offen
    s_add_u32 s58, s58, 204800
    s_cmp_ge_u32 s58, 4718592
    s_cselect_b32 s58, 0, s58
    v_mfma_f32_16x16x32_bf16 a[44:47], v[108:111], a[172:175], a[44:47]
    v_mfma_f32_16x16x32_bf16 a[76:79], v[108:111], a[176:179], a[76:79]
    v_mfma_f32_16x16x32_bf16 a[108:111], v[108:111], a[180:183], a[108:111]
    v_mfma_f32_16x16x32_bf16 v[16:19], v[112:115], a[156:159], v[16:19]
    v_perm_b32 v108, v197, v193, s93
    v_perm_b32 v109, v205, v201, s93
    v_mfma_f32_16x16x32_bf16 v[48:51], v[112:115], a[160:163], v[48:51]
    v_perm_b32 v110, v213, v209, s93
    v_perm_b32 v111, v221, v217, s93
    v_mfma_f32_16x16x32_bf16 v[80:83], v[112:115], a[164:167], v[80:83]
    buffer_load_dwordx4 v[160:163], v229, s[36:39], s58 offen
    s_add_u32 s58, s58, 8192
    v_mfma_f32_16x16x32_bf16 a[16:19], v[112:115], a[168:171], a[16:19]
    v_mfma_f32_16x16x32_bf16 a[48:51], v[112:115], a[172:175], a[48:51]
    buffer_load_dwordx4 v[164:167], v229, s[36:39], s58 offen
    s_add_u32 s58, s58, 8192
    v_mfma_f32_16x16x32_bf16 a[80:83], v[112:115], a[176:179], a[80:83]
    s_barrier
    v_mfma_f32_16x16x32_bf16 a[112:115], v[112:115], a[180:183], a[112:115]
    v_mfma_f32_16x16x32_bf16 v[20:23], v[116:119], a[156:159], v[20:23]
    v_perm_b32 v112, v198, v194, s92
    v_perm_b32 v113, v206, v202, s92
    v_mfma_f32_16x16x32_bf16 v[52:55], v[116:119], a[160:163], v[52:55]
    ds_read_b128 a[128:131], v230 offset:14336
    v_perm_b32 v114, v214, v210, s92
    v_perm_b32 v115, v222, v218, s92
    v_mfma_f32_16x16x32_bf16 v[84:87], v[116:119], a[164:167], v[84:87]
    buffer_load_dwordx4 v[168:171], v229, s[36:39], s58 offen
    s_add_u32 s58, s58, 8192
    v_mfma_f32_16x16x32_bf16 a[20:23], v[116:119], a[168:171], a[20:23]
    ds_read_b128 a[132:135], v230 offset:16384
    v_mfma_f32_16x16x32_bf16 a[52:55], v[116:119], a[172:175], a[52:55]
    v_mfma_f32_16x16x32_bf16 a[84:87], v[116:119], a[176:179], a[84:87]
    ds_read_b128 a[136:139], v230 offset:18432
    buffer_load_dwordx4 v[172:175], v229, s[36:39], s58 offen
    s_add_u32 s58, s58, 8192
    v_mfma_f32_16x16x32_bf16 a[116:119], v[116:119], a[180:183], a[116:119]
    v_mfma_f32_16x16x32_bf16 v[24:27], v[120:123], a[156:159], v[24:27]
    ds_read_b128 a[140:143], v230 offset:20480
    v_perm_b32 v116, v198, v194, s93
    v_perm_b32 v117, v206, v202, s93
    v_mfma_f32_16x16x32_bf16 v[56:59], v[120:123], a[160:163], v[56:59]
    v_perm_b32 v118, v214, v210, s93
    v_perm_b32 v119, v222, v218, s93
    v_mfma_f32_16x16x32_bf16 v[88:91], v[120:123], a[164:167], v[88:91]
    ds_read_b128 a[144:147], v230 offset:22528
    v_mfma_f32_16x16x32_bf16 a[24:27], v[120:123], a[168:171], a[24:27]
    buffer_load_dwordx4 v[176:179], v229, s[36:39], s58 offen
    s_add_u32 s58, s58, 8192
    v_mfma_f32_16x16x32_bf16 a[56:59], v[120:123], a[172:175], a[56:59]
    ds_read_b128 a[148:151], v230 offset:24576
    v_mfma_f32_16x16x32_bf16 a[88:91], v[120:123], a[176:179], a[88:91]
    v_mfma_f32_16x16x32_bf16 a[120:123], v[120:123], a[180:183], a[120:123]
    ds_read_b128 a[152:155], v230 offset:26624
    v_mfma_f32_16x16x32_bf16 v[28:31], v[124:127], a[156:159], v[28:31]
    v_perm_b32 v120, v199, v195, s92
    v_perm_b32 v121, v207, v203, s92
    v_mfma_f32_16x16x32_bf16 v[60:63], v[124:127], a[160:163], v[60:63]
    v_perm_b32 v122, v215, v211, s92
    v_perm_b32 v123, v223, v219, s92
    v_mfma_f32_16x16x32_bf16 v[92:95], v[124:127], a[164:167], v[92:95]
    buffer_load_dwordx4 v[180:183], v229, s[36:39], s58 offen
    s_add_u32 s58, s58, 8192
    v_mfma_f32_16x16x32_bf16 a[28:31], v[124:127], a[168:171], a[28:31]
    v_mfma_f32_16x16x32_bf16 a[60:63], v[124:127], a[172:175], a[60:63]
    v_mfma_f32_16x16x32_bf16 a[92:95], v[124:127], a[176:179], a[92:95]
    v_mfma_f32_16x16x32_bf16 a[124:127], v[124:127], a[180:183], a[124:127]
    s_waitcnt lgkmcnt(0)
    buffer_load_dwordx4 v[184:187], v229, s[36:39], s58 offen
    s_add_u32 s58, s58, 8192
    v_mfma_f32_16x16x32_bf16 v[0:3], v[96:99], a[128:131], v[0:3]
    v_perm_b32 v124, v199, v195, s93
    v_perm_b32 v125, v207, v203, s93
    v_mfma_f32_16x16x32_bf16 v[32:35], v[96:99], a[132:135], v[32:35]
    v_perm_b32 v126, v215, v211, s93
    v_perm_b32 v127, v223, v219, s93
    v_mfma_f32_16x16x32_bf16 v[64:67], v[96:99], a[136:139], v[64:67]
    v_mfma_f32_16x16x32_bf16 a[0:3], v[96:99], a[140:143], a[0:3]
    v_mfma_f32_16x16x32_bf16 a[32:35], v[96:99], a[144:147], a[32:35]
    buffer_load_dwordx4 v[188:191], v229, s[36:39], s58 offen
    s_add_u32 s58, s58, 204800
    s_cmp_ge_u32 s58, 4718592
    s_cselect_b32 s58, 0, s58
    v_mfma_f32_16x16x32_bf16 a[64:67], v[96:99], a[148:151], a[64:67]
    v_mfma_f32_16x16x32_bf16 a[96:99], v[96:99], a[152:155], a[96:99]
    s_waitcnt vmcnt(8)
    v_mfma_f32_16x16x32_bf16 v[4:7], v[100:103], a[128:131], v[4:7]
    v_perm_b32 v96, v132, v128, s92
    v_perm_b32 v97, v140, v136, s92
    v_mfma_f32_16x16x32_bf16 v[36:39], v[100:103], a[132:135], v[36:39]
    v_perm_b32 v98, v148, v144, s92
    v_perm_b32 v99, v156, v152, s92
    v_mfma_f32_16x16x32_bf16 v[68:71], v[100:103], a[136:139], v[68:71]
    s_add_u32 m0, s57, 0
    s_mov_b32 s61, s59
    buffer_load_dwordx4 v236, s[40:43], s61 offen offset:0 lds
    v_mfma_f32_16x16x32_bf16 a[4:7], v[100:103], a[140:143], a[4:7]
    v_mfma_f32_16x16x32_bf16 a[36:39], v[100:103], a[144:147], a[36:39]
    v_mfma_f32_16x16x32_bf16 a[68:71], v[100:103], a[148:151], a[68:71]
    buffer_load_dwordx4 v237, s[40:43], s61 offen offset:1024 lds
    v_mfma_f32_16x16x32_bf16 a[100:103], v[100:103], a[152:155], a[100:103]
    v_mfma_f32_16x16x32_bf16 v[8:11], v[104:107], a[128:131], v[8:11]
    v_perm_b32 v100, v132, v128, s93
    v_perm_b32 v101, v140, v136, s93
    v_mfma_f32_16x16x32_bf16 v[40:43], v[104:107], a[132:135], v[40:43]
    v_perm_b32 v102, v148, v144, s93
    v_perm_b32 v103, v156, v152, s93
    v_mfma_f32_16x16x32_bf16 v[72:75], v[104:107], a[136:139], v[72:75]
    buffer_load_dwordx4 v238, s[40:43], s61 offen offset:2048 lds
    v_mfma_f32_16x16x32_bf16 a[8:11], v[104:107], a[140:143], a[8:11]
    v_mfma_f32_16x16x32_bf16 a[40:43], v[104:107], a[144:147], a[40:43]
    v_mfma_f32_16x16x32_bf16 a[72:75], v[104:107], a[148:151], a[72:75]
    v_mfma_f32_16x16x32_bf16 a[104:107], v[104:107], a[152:155], a[104:107]
    buffer_load_dwordx4 v239, s[40:43], s61 offen offset:3072 lds
    s_add_u32 s59, s59, 128
    s_cmp_ge_u32 s59, 1152
    s_cselect_b32 s59, 0, s59
    v_mfma_f32_16x16x32_bf16 v[12:15], v[108:111], a[128:131], v[12:15]
    v_perm_b32 v104, v133, v129, s92
    v_perm_b32 v105, v141, v137, s92
    v_mfma_f32_16x16x32_bf16 v[44:47], v[108:111], a[132:135], v[44:47]
    v_perm_b32 v106, v149, v145, s92
    v_perm_b32 v107, v157, v153, s92
    v_mfma_f32_16x16x32_bf16 v[76:79], v[108:111], a[136:139], v[76:79]
    v_mfma_f32_16x16x32_bf16 a[12:15], v[108:111], a[140:143], a[12:15]
    buffer_load_dwordx4 v[192:195], v229, s[36:39], s58 offen
    s_add_u32 s58, s58, 8192
    v_mfma_f32_16x16x32_bf16 a[44:47], v[108:111], a[144:147], a[44:47]
    v_mfma_f32_16x16x32_bf16 a[76:79], v[108:111], a[148:151], a[76:79]
    v_mfma_f32_16x16x32_bf16 a[108:111], v[108:111], a[152:155], a[108:111]
    v_mfma_f32_16x16x32_bf16 v[16:19], v[112:115], a[128:131], v[16:19]
    v_perm_b32 v108, v133, v129, s93
    v_perm_b32 v109, v141, v137, s93
    v_mfma_f32_16x16x32_bf16 v[48:51], v[112:115], a[132:135], v[48:51]
    v_perm_b32 v110, v149, v145, s93
    v_perm_b32 v111, v157, v153, s93
    v_mfma_f32_16x16x32_bf16 v[80:83], v[112:115], a[136:139], v[80:83]
    buffer_load_dwordx4 v[196:199], v229, s[36:39], s58 offen
    s_add_u32 s58, s58, 8192
    v_mfma_f32_16x16x32_bf16 a[16:19], v[112:115], a[140:143], a[16:19]
    v_mfma_f32_16x16x32_bf16 a[48:51], v[112:115], a[144:147], a[48:51]
    v_mfma_f32_16x16x32_bf16 a[80:83], v[112:115], a[148:151], a[80:83]
    v_mfma_f32_16x16x32_bf16 a[112:115], v[112:115], a[152:155], a[112:115]
    buffer_load_dwordx4 v[200:203], v229, s[36:39], s58 offen
    s_add_u32 s58, s58, 8192
    v_mfma_f32_16x16x32_bf16 v[20:23], v[116:119], a[128:131], v[20:23]
    v_perm_b32 v112, v134, v130, s92
    v_perm_b32 v113, v142, v138, s92
    v_mfma_f32_16x16x32_bf16 v[52:55], v[116:119], a[132:135], v[52:55]
    ds_read_b128 a[156:159], v232 offset:14336
    v_perm_b32 v114, v150, v146, s92
    v_perm_b32 v115, v158, v154, s92
    v_mfma_f32_16x16x32_bf16 v[84:87], v[116:119], a[136:139], v[84:87]
    v_mfma_f32_16x16x32_bf16 a[20:23], v[116:119], a[140:143], a[20:23]
    ds_read_b128 a[160:163], v232 offset:16384
    v_mfma_f32_16x16x32_bf16 a[52:55], v[116:119], a[144:147], a[52:55]
    buffer_load_dwordx4 v[204:207], v229, s[36:39], s58 offen
    s_add_u32 s58, s58, 8192
    v_mfma_f32_16x16x32_bf16 a[84:87], v[116:119], a[148:151], a[84:87]
    ds_read_b128 a[164:167], v232 offset:18432
    v_mfma_f32_16x16x32_bf16 a[116:119], v[116:119], a[152:155], a[116:119]
    v_mfma_f32_16x16x32_bf16 v[24:27], v[120:123], a[128:131], v[24:27]
    ds_read_b128 a[168:171], v232 offset:20480
    v_perm_b32 v116, v134, v130, s93
    v_perm_b32 v117, v142, v138, s93
    v_mfma_f32_16x16x32_bf16 v[56:59], v[120:123], a[132:135], v[56:59]
    v_perm_b32 v118, v150, v146, s93
    v_perm_b32 v119, v158, v154, s93
    v_mfma_f32_16x16x32_bf16 v[88:91], v[120:123], a[136:139], v[88:91]
    ds_read_b128 a[172:175], v232 offset:22528
    buffer_load_dwordx4 v[208:211], v229, s[36:39], s58 offen
    s_add_u32 s58, s58, 8192
    v_mfma_f32_16x16x32_bf16 a[24:27], v[120:123], a[140:143], a[24:27]
    v_mfma_f32_16x16x32_bf16 a[56:59], v[120:123], a[144:147], a[56:59]
    ds_read_b128 a[176:179], v232 offset:24576
    v_mfma_f32_16x16x32_bf16 a[88:91], v[120:123], a[148:151], a[88:91]
    v_mfma_f32_16x16x32_bf16 a[120:123], v[120:123], a[152:155], a[120:123]
    ds_read_b128 a[180:183], v232 offset:26624
    v_mfma_f32_16x16x32_bf16 v[28:31], v[124:127], a[128:131], v[28:31]
    v_perm_b32 v120, v135, v131, s92
    v_perm_b32 v121, v143, v139, s92
    v_mfma_f32_16x16x32_bf16 v[60:63], v[124:127], a[132:135], v[60:63]
    v_perm_b32 v122, v151, v147, s92
    v_perm_b32 v123, v159, v155, s92
    v_mfma_f32_16x16x32_bf16 v[92:95], v[124:127], a[136:139], v[92:95]
    buffer_load_dwordx4 v[212:215], v229, s[36:39], s58 offen
    s_add_u32 s58, s58, 8192
    v_mfma_f32_16x16x32_bf16 a[28:31], v[124:127], a[140:143], a[28:31]
    v_mfma_f32_16x16x32_bf16 a[60:63], v[124:127], a[144:147], a[60:63]
    v_mfma_f32_16x16x32_bf16 a[92:95], v[124:127], a[148:151], a[92:95]
    buffer_load_dwordx4 v[216:219], v229, s[36:39], s58 offen
    s_add_u32 s58, s58, 8192
    v_mfma_f32_16x16x32_bf16 a[124:127], v[124:127], a[152:155], a[124:127]
    s_waitcnt lgkmcnt(0)
    v_mfma_f32_16x16x32_bf16 v[0:3], v[96:99], a[156:159], v[0:3]
    v_perm_b32 v124, v135, v131, s93
    v_perm_b32 v125, v143, v139, s93
    v_mfma_f32_16x16x32_bf16 v[32:35], v[96:99], a[160:163], v[32:35]
    v_perm_b32 v126, v151, v147, s93
    v_perm_b32 v127, v159, v155, s93
    v_mfma_f32_16x16x32_bf16 v[64:67], v[96:99], a[164:167], v[64:67]
    v_mfma_f32_16x16x32_bf16 a[0:3], v[96:99], a[168:171], a[0:3]
    buffer_load_dwordx4 v[220:223], v229, s[36:39], s58 offen
    s_add_u32 s58, s58, 204800
    s_cmp_ge_u32 s58, 4718592
    s_cselect_b32 s58, 0, s58
    v_mfma_f32_16x16x32_bf16 a[32:35], v[96:99], a[172:175], a[32:35]
    v_mfma_f32_16x16x32_bf16 a[64:67], v[96:99], a[176:179], a[64:67]
    v_mfma_f32_16x16x32_bf16 a[96:99], v[96:99], a[180:183], a[96:99]
    s_waitcnt vmcnt(12)
    v_mfma_f32_16x16x32_bf16 v[4:7], v[100:103], a[156:159], v[4:7]
    v_perm_b32 v96, v164, v160, s92
    v_perm_b32 v97, v172, v168, s92
    v_mfma_f32_16x16x32_bf16 v[36:39], v[100:103], a[160:163], v[36:39]
    v_perm_b32 v98, v180, v176, s92
    v_perm_b32 v99, v188, v184, s92
    v_mfma_f32_16x16x32_bf16 v[68:71], v[100:103], a[164:167], v[68:71]
    v_subrev_u32 v227, 9, v248
    v_min_u32 v248, v227, v248
    v_lshl_add_u32 v227, v248, 7, v244
    v_add_u32 v248, 3, v248
    buffer_load_dword v231, v227, s[40:43], 0 offen
    v_mfma_f32_16x16x32_bf16 a[4:7], v[100:103], a[168:171], a[4:7]
    v_mfma_f32_16x16x32_bf16 a[36:39], v[100:103], a[172:175], a[36:39]
    buffer_load_dwordx4 v[128:131], v229, s[36:39], s58 offen
    s_add_u32 s58, s58, 8192
    v_mfma_f32_16x16x32_bf16 a[68:71], v[100:103], a[176:179], a[68:71]
    v_mfma_f32_16x16x32_bf16 a[100:103], v[100:103], a[180:183], a[100:103]
    v_mfma_f32_16x16x32_bf16 v[8:11], v[104:107], a[156:159], v[8:11]
    v_perm_b32 v100, v164, v160, s93
    v_perm_b32 v101, v172, v168, s93
    v_mfma_f32_16x16x32_bf16 v[40:43], v[104:107], a[160:163], v[40:43]
    v_perm_b32 v102, v180, v176, s93
    v_perm_b32 v103, v188, v184, s93
    v_mfma_f32_16x16x32_bf16 v[72:75], v[104:107], a[164:167], v[72:75]
    buffer_load_dwordx4 v[132:135], v229, s[36:39], s58 offen
    s_add_u32 s58, s58, 8192
    v_mfma_f32_16x16x32_bf16 a[8:11], v[104:107], a[168:171], a[8:11]
    v_mfma_f32_16x16x32_bf16 a[40:43], v[104:107], a[172:175], a[40:43]
    v_mfma_f32_16x16x32_bf16 a[72:75], v[104:107], a[176:179], a[72:75]
    buffer_load_dwordx4 v[136:139], v229, s[36:39], s58 offen
    s_add_u32 s58, s58, 8192
    v_mfma_f32_16x16x32_bf16 a[104:107], v[104:107], a[180:183], a[104:107]
    v_mfma_f32_16x16x32_bf16 v[12:15], v[108:111], a[156:159], v[12:15]
    v_perm_b32 v104, v165, v161, s92
    v_perm_b32 v105, v173, v169, s92
    v_mfma_f32_16x16x32_bf16 v[44:47], v[108:111], a[160:163], v[44:47]
    v_perm_b32 v106, v181, v177, s92
    v_perm_b32 v107, v189, v185, s92
    v_mfma_f32_16x16x32_bf16 v[76:79], v[108:111], a[164:167], v[76:79]
    buffer_load_dwordx4 v[140:143], v229, s[36:39], s58 offen
    s_add_u32 s58, s58, 8192
    v_mfma_f32_16x16x32_bf16 a[12:15], v[108:111], a[168:171], a[12:15]
    v_mfma_f32_16x16x32_bf16 a[44:47], v[108:111], a[172:175], a[44:47]
    v_mfma_f32_16x16x32_bf16 a[76:79], v[108:111], a[176:179], a[76:79]
    v_mfma_f32_16x16x32_bf16 a[108:111], v[108:111], a[180:183], a[108:111]
    v_mfma_f32_16x16x32_bf16 v[16:19], v[112:115], a[156:159], v[16:19]
    v_perm_b32 v108, v165, v161, s93
    v_perm_b32 v109, v173, v169, s93
    v_mfma_f32_16x16x32_bf16 v[48:51], v[112:115], a[160:163], v[48:51]
    v_perm_b32 v110, v181, v177, s93
    v_perm_b32 v111, v189, v185, s93
    v_mfma_f32_16x16x32_bf16 v[80:83], v[112:115], a[164:167], v[80:83]
    buffer_load_dwordx4 v[144:147], v229, s[36:39], s58 offen
    s_add_u32 s58, s58, 8192
    v_mfma_f32_16x16x32_bf16 a[16:19], v[112:115], a[168:171], a[16:19]
    v_mfma_f32_16x16x32_bf16 a[48:51], v[112:115], a[172:175], a[48:51]
    v_mfma_f32_16x16x32_bf16 a[80:83], v[112:115], a[176:179], a[80:83]
    s_waitcnt vmcnt(14)
    s_barrier
    buffer_load_dwordx4 v[148:151], v229, s[36:39], s58 offen
    s_add_u32 s58, s58, 8192
    v_mfma_f32_16x16x32_bf16 a[112:115], v[112:115], a[180:183], a[112:115]
    v_mfma_f32_16x16x32_bf16 v[20:23], v[116:119], a[156:159], v[20:23]
    v_perm_b32 v112, v166, v162, s92
    v_perm_b32 v113, v174, v170, s92
    v_mfma_f32_16x16x32_bf16 v[52:55], v[116:119], a[160:163], v[52:55]
    ds_read_b128 a[128:131], v230 offset:0
    v_perm_b32 v114, v182, v178, s92
    v_perm_b32 v115, v190, v186, s92
    v_mfma_f32_16x16x32_bf16 v[84:87], v[116:119], a[164:167], v[84:87]
    v_mfma_f32_16x16x32_bf16 a[20:23], v[116:119], a[168:171], a[20:23]
    ds_read_b128 a[132:135], v230 offset:2048
    buffer_load_dwordx4 v[152:155], v229, s[36:39], s58 offen
    s_add_u32 s58, s58, 8192
    v_mfma_f32_16x16x32_bf16 a[52:55], v[116:119], a[172:175], a[52:55]
    v_mfma_f32_16x16x32_bf16 a[84:87], v[116:119], a[176:179], a[84:87]
    ds_read_b128 a[136:139], v230 offset:4096
    v_mfma_f32_16x16x32_bf16 a[116:119], v[116:119], a[180:183], a[116:119]
    v_mfma_f32_16x16x32_bf16 v[24:27], v[120:123], a[156:159], v[24:27]
    ds_read_b128 a[140:143], v230 offset:6144
    v_perm_b32 v116, v166, v162, s93
    v_perm_b32 v117, v174, v170, s93
    v_mfma_f32_16x16x32_bf16 v[56:59], v[120:123], a[160:163], v[56:59]
    v_perm_b32 v118, v182, v178, s93
    v_perm_b32 v119, v190, v186, s93
    v_mfma_f32_16x16x32_bf16 v[88:91], v[120:123], a[164:167], v[88:91]
    ds_read_b128 a[144:147], v230 offset:8192
    buffer_load_dwordx4 v[156:159], v229, s[36:39], s58 offen
    s_add_u32 s58, s58, 204800
    s_cmp_ge_u32 s58, 4718592
    s_cselect_b32 s58, 0, s58
    v_mfma_f32_16x16x32_bf16 a[24:27], v[120:123], a[168:171], a[24:27]
    v_mfma_f32_16x16x32_bf16 a[56:59], v[120:123], a[172:175], a[56:59]
    ds_read_b128 a[148:151], v230 offset:10240
    v_mfma_f32_16x16x32_bf16 a[88:91], v[120:123], a[176:179], a[88:91]
    v_mfma_f32_16x16x32_bf16 a[120:123], v[120:123], a[180:183], a[120:123]
    ds_read_b128 a[152:155], v230 offset:12288
    s_add_u32 m0, s57, 14336
    s_mov_b32 s61, s59
    buffer_load_dwordx4 v236, s[40:43], s61 offen offset:0 lds
    v_mfma_f32_16x16x32_bf16 v[28:31], v[124:127], a[156:159], v[28:31]
    v_perm_b32 v120, v167, v163, s92
    v_perm_b32 v121, v175, v171, s92
    v_mfma_f32_16x16x32_bf16 v[60:63], v[124:127], a[160:163], v[60:63]
    v_perm_b32 v122, v183, v179, s92
    v_perm_b32 v123, v191, v187, s92
    v_mfma_f32_16x16x32_bf16 v[92:95], v[124:127], a[164:167], v[92:95]
    v_mfma_f32_16x16x32_bf16 a[28:31], v[124:127], a[168:171], a[28:31]
    v_mfma_f32_16x16x32_bf16 a[60:63], v[124:127], a[172:175], a[60:63]
    buffer_load_dwordx4 v237, s[40:43], s61 offen offset:1024 lds
    v_mfma_f32_16x16x32_bf16 a[92:95], v[124:127], a[176:179], a[92:95]
    v_mfma_f32_16x16x32_bf16 a[124:127], v[124:127], a[180:183], a[124:127]
    s_waitcnt lgkmcnt(0)
    v_mfma_f32_16x16x32_bf16 v[0:3], v[96:99], a[128:131], v[0:3]
    v_perm_b32 v124, v167, v163, s93
    v_perm_b32 v125, v175, v171, s93
    v_mfma_f32_16x16x32_bf16 v[32:35], v[96:99], a[132:135], v[32:35]
    v_perm_b32 v126, v183, v179, s93
    v_perm_b32 v127, v191, v187, s93
    v_mfma_f32_16x16x32_bf16 v[64:67], v[96:99], a[136:139], v[64:67]
    buffer_load_dwordx4 v238, s[40:43], s61 offen offset:2048 lds
    v_mfma_f32_16x16x32_bf16 a[0:3], v[96:99], a[140:143], a[0:3]
    v_mfma_f32_16x16x32_bf16 a[32:35], v[96:99], a[144:147], a[32:35]
    v_mfma_f32_16x16x32_bf16 a[64:67], v[96:99], a[148:151], a[64:67]
    v_mfma_f32_16x16x32_bf16 a[96:99], v[96:99], a[152:155], a[96:99]
    s_waitcnt vmcnt(12)
    buffer_load_dwordx4 v239, s[40:43], s61 offen offset:3072 lds
    s_add_u32 s59, s59, 128
    s_cmp_ge_u32 s59, 1152
    s_cselect_b32 s59, 0, s59
    v_mfma_f32_16x16x32_bf16 v[4:7], v[100:103], a[128:131], v[4:7]
    v_perm_b32 v96, v196, v192, s92
    v_perm_b32 v97, v204, v200, s92
    v_mfma_f32_16x16x32_bf16 v[36:39], v[100:103], a[132:135], v[36:39]
    v_perm_b32 v98, v212, v208, s92
    v_perm_b32 v99, v220, v216, s92
    v_mfma_f32_16x16x32_bf16 v[68:71], v[100:103], a[136:139], v[68:71]
    v_mfma_f32_16x16x32_bf16 a[4:7], v[100:103], a[140:143], a[4:7]
    v_mfma_f32_16x16x32_bf16 a[36:39], v[100:103], a[144:147], a[36:39]
    buffer_load_dwordx4 v[160:163], v229, s[36:39], s58 offen
    s_add_u32 s58, s58, 8192
    v_mfma_f32_16x16x32_bf16 a[68:71], v[100:103], a[148:151], a[68:71]
    v_mfma_f32_16x16x32_bf16 a[100:103], v[100:103], a[152:155], a[100:103]
    v_mfma_f32_16x16x32_bf16 v[8:11], v[104:107], a[128:131], v[8:11]
    v_perm_b32 v100, v196, v192, s93
    v_perm_b32 v101, v204, v200, s93
    v_mfma_f32_16x16x32_bf16 v[40:43], v[104:107], a[132:135], v[40:43]
    v_perm_b32 v102, v212, v208, s93
    v_perm_b32 v103, v220, v216, s93
    v_mfma_f32_16x16x32_bf16 v[72:75], v[104:107], a[136:139], v[72:75]
    buffer_load_dwordx4 v[164:167], v229, s[36:39], s58 offen
    s_add_u32 s58, s58, 8192
    v_mfma_f32_16x16x32_bf16 a[8:11], v[104:107], a[140:143], a[8:11]
    v_mfma_f32_16x16x32_bf16 a[40:43], v[104:107], a[144:147], a[40:43]
    v_mfma_f32_16x16x32_bf16 a[72:75], v[104:107], a[148:151], a[72:75]
    v_mfma_f32_16x16x32_bf16 a[104:107], v[104:107], a[152:155], a[104:107]
    v_mfma_f32_16x16x32_bf16 v[12:15], v[108:111], a[128:131], v[12:15]
    v_perm_b32 v104, v197, v193, s92
    v_perm_b32 v105, v205, v201, s92
    v_mfma_f32_16x16x32_bf16 v[44:47], v[108:111], a[132:135], v[44:47]
    v_perm_b32 v106, v213, v209, s92
    v_perm_b32 v107, v221, v217, s92
    v_mfma_f32_16x16x32_bf16 v[76:79], v[108:111], a[136:139], v[76:79]
    buffer_load_dwordx4 v[168:171], v229, s[36:39], s58 offen
    s_add_u32 s58, s58, 8192
    v_mfma_f32_16x16x32_bf16 a[12:15], v[108:111], a[140:143], a[12:15]
    v_mfma_f32_16x16x32_bf16 a[44:47], v[108:111], a[144:147], a[44:47]
    v_mfma_f32_16x16x32_bf16 a[76:79], v[108:111], a[148:151], a[76:79]
    buffer_load_dwordx4 v[172:175], v229, s[36:39], s58 offen
    s_add_u32 s58, s58, 8192
    v_mfma_f32_16x16x32_bf16 a[108:111], v[108:111], a[152:155], a[108:111]
    v_mfma_f32_16x16x32_bf16 v[16:19], v[112:115], a[128:131], v[16:19]
    v_perm_b32 v108, v197, v193, s93
    v_perm_b32 v109, v205, v201, s93
    v_mfma_f32_16x16x32_bf16 v[48:51], v[112:115], a[132:135], v[48:51]
    v_perm_b32 v110, v213, v209, s93
    v_perm_b32 v111, v221, v217, s93
    v_mfma_f32_16x16x32_bf16 v[80:83], v[112:115], a[136:139], v[80:83]
    v_mfma_f32_16x16x32_bf16 a[16:19], v[112:115], a[140:143], a[16:19]
    buffer_load_dwordx4 v[176:179], v229, s[36:39], s58 offen
    s_add_u32 s58, s58, 8192
    v_mfma_f32_16x16x32_bf16 a[48:51], v[112:115], a[144:147], a[48:51]
    v_mfma_f32_16x16x32_bf16 a[80:83], v[112:115], a[148:151], a[80:83]
    v_mfma_f32_16x16x32_bf16 a[112:115], v[112:115], a[152:155], a[112:115]
    v_mfma_f32_16x16x32_bf16 v[20:23], v[116:119], a[128:131], v[20:23]
    v_perm_b32 v112, v198, v194, s92
    v_perm_b32 v113, v206, v202, s92
    v_mfma_f32_16x16x32_bf16 v[52:55], v[116:119], a[132:135], v[52:55]
    ds_read_b128 a[156:159], v232 offset:0
    v_perm_b32 v114, v214, v210, s92
    v_perm_b32 v115, v222, v218, s92
    v_mfma_f32_16x16x32_bf16 v[84:87], v[116:119], a[136:139], v[84:87]
    buffer_load_dwordx4 v[180:183], v229, s[36:39], s58 offen
    s_add_u32 s58, s58, 8192
    v_mfma_f32_16x16x32_bf16 a[20:23], v[116:119], a[140:143], a[20:23]
    ds_read_b128 a[160:163], v232 offset:2048
    v_mfma_f32_16x16x32_bf16 a[52:55], v[116:119], a[144:147], a[52:55]
    v_mfma_f32_16x16x32_bf16 a[84:87], v[116:119], a[148:151], a[84:87]
    ds_read_b128 a[164:167], v232 offset:4096
    v_mfma_f32_16x16x32_bf16 a[116:119], v[116:119], a[152:155], a[116:119]
    buffer_load_dwordx4 v[184:187], v229, s[36:39], s58 offen
    s_add_u32 s58, s58, 8192
    v_mfma_f32_16x16x32_bf16 v[24:27], v[120:123], a[128:131], v[24:27]
    ds_read_b128 a[168:171], v232 offset:6144
    v_perm_b32 v116, v198, v194, s93
    v_perm_b32 v117, v206, v202, s93
    v_mfma_f32_16x16x32_bf16 v[56:59], v[120:123], a[132:135], v[56:59]
    v_perm_b32 v118, v214, v210, s93
    v_perm_b32 v119, v222, v218, s93
    v_mfma_f32_16x16x32_bf16 v[88:91], v[120:123], a[136:139], v[88:91]
    ds_read_b128 a[172:175], v232 offset:8192
    v_mfma_f32_16x16x32_bf16 a[24:27], v[120:123], a[140:143], a[24:27]
    v_mfma_f32_16x16x32_bf16 a[56:59], v[120:123], a[144:147], a[56:59]
    ds_read_b128 a[176:179], v232 offset:10240
    buffer_load_dwordx4 v[188:191], v229, s[36:39], s58 offen
    s_add_u32 s58, s58, 204800
    s_cmp_ge_u32 s58, 4718592
    s_cselect_b32 s58, 0, s58
    v_mfma_f32_16x16x32_bf16 a[88:91], v[120:123], a[148:151], a[88:91]
    v_mfma_f32_16x16x32_bf16 a[120:123], v[120:123], a[152:155], a[120:123]
    ds_read_b128 a[180:183], v232 offset:12288
    v_mfma_f32_16x16x32_bf16 v[28:31], v[124:127], a[128:131], v[28:31]
    v_perm_b32 v120, v199, v195, s92
    v_perm_b32 v121, v207, v203, s92
    v_mfma_f32_16x16x32_bf16 v[60:63], v[124:127], a[132:135], v[60:63]
    v_perm_b32 v122, v215, v211, s92
    v_perm_b32 v123, v223, v219, s92
    v_mfma_f32_16x16x32_bf16 v[92:95], v[124:127], a[136:139], v[92:95]
    v_mfma_f32_16x16x32_bf16 a[28:31], v[124:127], a[140:143], a[28:31]
    v_mfma_f32_16x16x32_bf16 a[60:63], v[124:127], a[144:147], a[60:63]
    v_mfma_f32_16x16x32_bf16 a[92:95], v[124:127], a[148:151], a[92:95]
    v_mfma_f32_16x16x32_bf16 a[124:127], v[124:127], a[152:155], a[124:127]
    s_waitcnt lgkmcnt(0)
    v_mfma_f32_16x16x32_bf16 v[0:3], v[96:99], a[156:159], v[0:3]
    v_perm_b32 v124, v199, v195, s93
    v_perm_b32 v125, v207, v203, s93
    v_mfma_f32_16x16x32_bf16 v[32:35], v[96:99], a[160:163], v[32:35]
    v_perm_b32 v126, v215, v211, s93
    v_perm_b32 v127, v223, v219, s93
    v_mfma_f32_16x16x32_bf16 v[64:67], v[96:99], a[164:167], v[64:67]
    buffer_load_dwordx4 v[192:195], v229, s[36:39], s58 offen
    s_add_u32 s58, s58, 8192
    v_mfma_f32_16x16x32_bf16 a[0:3], v[96:99], a[168:171], a[0:3]
    v_mfma_f32_16x16x32_bf16 a[32:35], v[96:99], a[172:175], a[32:35]
    v_mfma_f32_16x16x32_bf16 a[64:67], v[96:99], a[176:179], a[64:67]
    v_mfma_f32_16x16x32_bf16 a[96:99], v[96:99], a[180:183], a[96:99]
    s_waitcnt vmcnt(13)
    buffer_load_dwordx4 v[196:199], v229, s[36:39], s58 offen
    s_add_u32 s58, s58, 8192
    v_mfma_f32_16x16x32_bf16 v[4:7], v[100:103], a[156:159], v[4:7]
    v_perm_b32 v96, v132, v128, s92
    v_perm_b32 v97, v140, v136, s92
    v_mfma_f32_16x16x32_bf16 v[36:39], v[100:103], a[160:163], v[36:39]
    v_perm_b32 v98, v148, v144, s92
    v_perm_b32 v99, v156, v152, s92
    v_mfma_f32_16x16x32_bf16 v[68:71], v[100:103], a[164:167], v[68:71]
    v_mfma_f32_16x16x32_bf16 a[4:7], v[100:103], a[168:171], a[4:7]
    buffer_load_dwordx4 v[200:203], v229, s[36:39], s58 offen
    s_add_u32 s58, s58, 8192
    v_mfma_f32_16x16x32_bf16 a[36:39], v[100:103], a[172:175], a[36:39]
    v_mfma_f32_16x16x32_bf16 a[68:71], v[100:103], a[176:179], a[68:71]
    v_mfma_f32_16x16x32_bf16 a[100:103], v[100:103], a[180:183], a[100:103]
    v_mfma_f32_16x16x32_bf16 v[8:11], v[104:107], a[156:159], v[8:11]
    v_perm_b32 v100, v132, v128, s93
    v_perm_b32 v101, v140, v136, s93
    v_mfma_f32_16x16x32_bf16 v[40:43], v[104:107], a[160:163], v[40:43]
    v_perm_b32 v102, v148, v144, s93
    v_perm_b32 v103, v156, v152, s93
    v_mfma_f32_16x16x32_bf16 v[72:75], v[104:107], a[164:167], v[72:75]
    buffer_load_dwordx4 v[204:207], v229, s[36:39], s58 offen
    s_add_u32 s58, s58, 8192
    v_mfma_f32_16x16x32_bf16 a[8:11], v[104:107], a[168:171], a[8:11]
    v_mfma_f32_16x16x32_bf16 a[40:43], v[104:107], a[172:175], a[40:43]
    v_mfma_f32_16x16x32_bf16 a[72:75], v[104:107], a[176:179], a[72:75]
    buffer_load_dwordx4 v[208:211], v229, s[36:39], s58 offen
    s_add_u32 s58, s58, 8192
    v_mfma_f32_16x16x32_bf16 a[104:107], v[104:107], a[180:183], a[104:107]
    v_mfma_f32_16x16x32_bf16 v[12:15], v[108:111], a[156:159], v[12:15]
    v_perm_b32 v104, v133, v129, s92
    v_perm_b32 v105, v141, v137, s92
    v_mfma_f32_16x16x32_bf16 v[44:47], v[108:111], a[160:163], v[44:47]
    v_perm_b32 v106, v149, v145, s92
    v_perm_b32 v107, v157, v153, s92
    v_mfma_f32_16x16x32_bf16 v[76:79], v[108:111], a[164:167], v[76:79]
    v_mfma_f32_16x16x32_bf16 a[12:15], v[108:111], a[168:171], a[12:15]
    buffer_load_dwordx4 v[212:215], v229, s[36:39], s58 offen
    s_add_u32 s58, s58, 8192
    v_mfma_f32_16x16x32_bf16 a[44:47], v[108:111], a[172:175], a[44:47]
    v_mfma_f32_16x16x32_bf16 a[76:79], v[108:111], a[176:179], a[76:79]
    v_mfma_f32_16x16x32_bf16 a[108:111], v[108:111], a[180:183], a[108:111]
    v_mfma_f32_16x16x32_bf16 v[16:19], v[112:115], a[156:159], v[16:19]
    v_perm_b32 v108, v133, v129, s93
    v_perm_b32 v109, v141, v137, s93
    v_mfma_f32_16x16x32_bf16 v[48:51], v[112:115], a[160:163], v[48:51]
    v_perm_b32 v110, v149, v145, s93
    v_perm_b32 v111, v157, v153, s93
    v_mfma_f32_16x16x32_bf16 v[80:83], v[112:115], a[164:167], v[80:83]
    buffer_load_dwordx4 v[216:219], v229, s[36:39], s58 offen
    s_add_u32 s58, s58, 8192
    v_mfma_f32_16x16x32_bf16 a[16:19], v[112:115], a[168:171], a[16:19]
    v_mfma_f32_16x16x32_bf16 a[48:51], v[112:115], a[172:175], a[48:51]
    v_mfma_f32_16x16x32_bf16 a[80:83], v[112:115], a[176:179], a[80:83]
    s_waitcnt vmcnt(15)
    s_barrier
    v_mfma_f32_16x16x32_bf16 a[112:115], v[112:115], a[180:183], a[112:115]
    buffer_load_dwordx4 v[220:223], v229, s[36:39], s58 offen
    s_add_u32 s58, s58, 204800
    s_cmp_ge_u32 s58, 4718592
    s_cselect_b32 s58, 0, s58
    v_mfma_f32_16x16x32_bf16 v[20:23], v[116:119], a[156:159], v[20:23]
    v_perm_b32 v112, v134, v130, s92
    v_perm_b32 v113, v142, v138, s92
    v_mfma_f32_16x16x32_bf16 v[52:55], v[116:119], a[160:163], v[52:55]
    ds_read_b128 a[128:131], v230 offset:14336
    v_perm_b32 v114, v150, v146, s92
    v_perm_b32 v115, v158, v154, s92
    v_mfma_f32_16x16x32_bf16 v[84:87], v[116:119], a[164:167], v[84:87]
    v_mfma_f32_16x16x32_bf16 a[20:23], v[116:119], a[168:171], a[20:23]
    ds_read_b128 a[132:135], v230 offset:16384
    v_mfma_f32_16x16x32_bf16 a[52:55], v[116:119], a[172:175], a[52:55]
    s_add_u32 m0, s57, 0
    s_mov_b32 s61, s59
    buffer_load_dwordx4 v236, s[40:43], s61 offen offset:0 lds
    v_mfma_f32_16x16x32_bf16 a[84:87], v[116:119], a[176:179], a[84:87]
    ds_read_b128 a[136:139], v230 offset:18432
    v_mfma_f32_16x16x32_bf16 a[116:119], v[116:119], a[180:183], a[116:119]
    v_mfma_f32_16x16x32_bf16 v[24:27], v[120:123], a[156:159], v[24:27]
    ds_read_b128 a[140:143], v230 offset:20480
    v_perm_b32 v116, v134, v130, s93
    v_perm_b32 v117, v142, v138, s93
    v_mfma_f32_16x16x32_bf16 v[56:59], v[120:123], a[160:163], v[56:59]
    v_perm_b32 v118, v150, v146, s93
    v_perm_b32 v119, v158, v154, s93
    v_mfma_f32_16x16x32_bf16 v[88:91], v[120:123], a[164:167], v[88:91]
    ds_read_b128 a[144:147], v230 offset:22528
    buffer_load_dwordx4 v237, s[40:43], s61 offen offset:1024 lds
    v_mfma_f32_16x16x32_bf16 a[24:27], v[120:123], a[168:171], a[24:27]
    v_mfma_f32_16x16x32_bf16 a[56:59], v[120:123], a[172:175], a[56:59]
    ds_read_b128 a[148:151], v230 offset:24576
    v_mfma_f32_16x16x32_bf16 a[88:91], v[120:123], a[176:179], a[88:91]
    v_mfma_f32_16x16x32_bf16 a[120:123], v[120:123], a[180:183], a[120:123]
    ds_read_b128 a[152:155], v230 offset:26624
    v_mfma_f32_16x16x32_bf16 v[28:31], v[124:127], a[156:159], v[28:31]
    v_perm_b32 v120, v135, v131, s92
    v_perm_b32 v121, v143, v139, s92
    v_mfma_f32_16x16x32_bf16 v[60:63], v[124:127], a[160:163], v[60:63]
    v_perm_b32 v122, v151, v147, s92
    v_perm_b32 v123, v159, v155, s92
    v_mfma_f32_16x16x32_bf16 v[92:95], v[124:127], a[164:167], v[92:95]
    buffer_load_dwordx4 v238, s[40:43], s61 offen offset:2048 lds
    v_mfma_f32_16x16x32_bf16 a[28:31], v[124:127], a[168:171], a[28:31]
    v_mfma_f32_16x16x32_bf16 a[60:63], v[124:127], a[172:175], a[60:63]
    v_mfma_f32_16x16x32_bf16 a[92:95], v[124:127], a[176:179], a[92:95]
    buffer_load_dwordx4 v239, s[40:43], s61 offen offset:3072 lds
    s_add_u32 s59, s59, 128
    s_cmp_ge_u32 s59, 1152
    s_cselect_b32 s59, 0, s59
    v_mfma_f32_16x16x32_bf16 a[124:127], v[124:127], a[180:183], a[124:127]
    s_waitcnt lgkmcnt(0)
    v_mfma_f32_16x16x32_bf16 v[0:3], v[96:99], a[128:131], v[0:3]
    v_perm_b32 v124, v135, v131, s93
    v_perm_b32 v125, v143, v139, s93
    v_mfma_f32_16x16x32_bf16 v[32:35], v[96:99], a[132:135], v[32:35]
    v_perm_b32 v126, v151, v147, s93
    v_perm_b32 v127, v159, v155, s93
    v_mfma_f32_16x16x32_bf16 v[64:67], v[96:99], a[136:139], v[64:67]
    v_mfma_f32_16x16x32_bf16 a[0:3], v[96:99], a[140:143], a[0:3]
    buffer_load_dwordx4 v[128:131], v229, s[36:39], s58 offen
    s_add_u32 s58, s58, 8192
    v_mfma_f32_16x16x32_bf16 a[32:35], v[96:99], a[144:147], a[32:35]
    v_mfma_f32_16x16x32_bf16 a[64:67], v[96:99], a[148:151], a[64:67]
    v_mfma_f32_16x16x32_bf16 a[96:99], v[96:99], a[152:155], a[96:99]
    s_waitcnt vmcnt(13)
    v_mfma_f32_16x16x32_bf16 v[4:7], v[100:103], a[128:131], v[4:7]
    v_perm_b32 v96, v164, v160, s92
    v_perm_b32 v97, v172, v168, s92
    v_mfma_f32_16x16x32_bf16 v[36:39], v[100:103], a[132:135], v[36:39]
    v_perm_b32 v98, v180, v176, s92
    v_perm_b32 v99, v188, v184, s92
    v_mfma_f32_16x16x32_bf16 v[68:71], v[100:103], a[136:139], v[68:71]
    buffer_load_dwordx4 v[132:135], v229, s[36:39], s58 offen
    s_add_u32 s58, s58, 8192
    v_mfma_f32_16x16x32_bf16 a[4:7], v[100:103], a[140:143], a[4:7]
    v_mfma_f32_16x16x32_bf16 a[36:39], v[100:103], a[144:147], a[36:39]
    v_mfma_f32_16x16x32_bf16 a[68:71], v[100:103], a[148:151], a[68:71]
    v_mfma_f32_16x16x32_bf16 a[100:103], v[100:103], a[152:155], a[100:103]
    buffer_load_dwordx4 v[136:139], v229, s[36:39], s58 offen
    s_add_u32 s58, s58, 8192
    v_mfma_f32_16x16x32_bf16 v[8:11], v[104:107], a[128:131], v[8:11]
    v_perm_b32 v100, v164, v160, s93
    v_perm_b32 v101, v172, v168, s93
    v_mfma_f32_16x16x32_bf16 v[40:43], v[104:107], a[132:135], v[40:43]
    v_perm_b32 v102, v180, v176, s93
    v_perm_b32 v103, v188, v184, s93
    v_mfma_f32_16x16x32_bf16 v[72:75], v[104:107], a[136:139], v[72:75]
    v_mfma_f32_16x16x32_bf16 a[8:11], v[104:107], a[140:143], a[8:11]
    v_mfma_f32_16x16x32_bf16 a[40:43], v[104:107], a[144:147], a[40:43]
    buffer_load_dwordx4 v[140:143], v229, s[36:39], s58 offen
    s_add_u32 s58, s58, 8192
    v_mfma_f32_16x16x32_bf16 a[72:75], v[104:107], a[148:151], a[72:75]
    v_mfma_f32_16x16x32_bf16 a[104:107], v[104:107], a[152:155], a[104:107]
    v_mfma_f32_16x16x32_bf16 v[12:15], v[108:111], a[128:131], v[12:15]
    v_perm_b32 v104, v165, v161, s92
    v_perm_b32 v105, v173, v169, s92
    v_mfma_f32_16x16x32_bf16 v[44:47], v[108:111], a[132:135], v[44:47]
    v_perm_b32 v106, v181, v177, s92
    v_perm_b32 v107, v189, v185, s92
    v_mfma_f32_16x16x32_bf16 v[76:79], v[108:111], a[136:139], v[76:79]
    buffer_load_dwordx4 v[144:147], v229, s[36:39], s58 offen
    s_add_u32 s58, s58, 8192
    v_mfma_f32_16x16x32_bf16 a[12:15], v[108:111], a[140:143], a[12:15]
    v_mfma_f32_16x16x32_bf16 a[44:47], v[108:111], a[144:147], a[44:47]
    v_mfma_f32_16x16x32_bf16 a[76:79], v[108:111], a[148:151], a[76:79]
    v_mfma_f32_16x16x32_bf16 a[108:111], v[108:111], a[152:155], a[108:111]
    v_mfma_f32_16x16x32_bf16 v[16:19], v[112:115], a[128:131], v[16:19]
    v_perm_b32 v108, v165, v161, s93
    v_perm_b32 v109, v173, v169, s93
    v_mfma_f32_16x16x32_bf16 v[48:51], v[112:115], a[132:135], v[48:51]
    v_perm_b32 v110, v181, v177, s93
    v_perm_b32 v111, v189, v185, s93
    v_mfma_f32_16x16x32_bf16 v[80:83], v[112:115], a[136:139], v[80:83]
    buffer_load_dwordx4 v[148:151], v229, s[36:39], s58 offen
    s_add_u32 s58, s58, 8192
    v_mfma_f32_16x16x32_bf16 a[16:19], v[112:115], a[140:143], a[16:19]
    v_mfma_f32_16x16x32_bf16 a[48:51], v[112:115], a[144:147], a[48:51]
    v_mfma_f32_16x16x32_bf16 a[80:83], v[112:115], a[148:151], a[80:83]
    buffer_load_dwordx4 v[152:155], v229, s[36:39], s58 offen
    s_add_u32 s58, s58, 8192
    v_mfma_f32_16x16x32_bf16 a[112:115], v[112:115], a[152:155], a[112:115]
    v_mfma_f32_16x16x32_bf16 v[20:23], v[116:119], a[128:131], v[20:23]
    v_perm_b32 v112, v166, v162, s92
    v_perm_b32 v113, v174, v170, s92
    v_mfma_f32_16x16x32_bf16 v[52:55], v[116:119], a[132:135], v[52:55]
    ds_read_b128 a[156:159], v232 offset:14336
    v_perm_b32 v114, v182, v178, s92
    v_perm_b32 v115, v190, v186, s92
    v_mfma_f32_16x16x32_bf16 v[84:87], v[116:119], a[136:139], v[84:87]
    v_mfma_f32_16x16x32_bf16 a[20:23], v[116:119], a[140:143], a[20:23]
    ds_read_b128 a[160:163], v232 offset:16384
    buffer_load_dwordx4 v[156:159], v229, s[36:39], s58 offen
    s_add_u32 s58, s58, 204800
    s_cmp_ge_u32 s58, 4718592
    s_cselect_b32 s58, 0, s58
    v_mfma_f32_16x16x32_bf16 a[52:55], v[116:119], a[144:147], a[52:55]
    v_mfma_f32_16x16x32_bf16 a[84:87], v[116:119], a[148:151], a[84:87]
    ds_read_b128 a[164:167], v232 offset:18432
    v_mfma_f32_16x16x32_bf16 a[116:119], v[116:119], a[152:155], a[116:119]
    v_mfma_f32_16x16x32_bf16 v[24:27], v[120:123], a[128:131], v[24:27]
    ds_read_b128 a[168:171], v232 offset:20480
    v_perm_b32 v116, v166, v162, s93
    v_perm_b32 v117, v174, v170, s93
    v_mfma_f32_16x16x32_bf16 v[56:59], v[120:123], a[132:135], v[56:59]
    v_perm_b32 v118, v182, v178, s93
    v_perm_b32 v119, v190, v186, s93
    v_mfma_f32_16x16x32_bf16 v[88:91], v[120:123], a[136:139], v[88:91]
    ds_read_b128 a[172:175], v232 offset:22528
    v_mfma_f32_16x16x32_bf16 a[24:27], v[120:123], a[140:143], a[24:27]
    v_mfma_f32_16x16x32_bf16 a[56:59], v[120:123], a[144:147], a[56:59]
    ds_read_b128 a[176:179], v232 offset:24576
    v_mfma_f32_16x16x32_bf16 a[88:91], v[120:123], a[148:151], a[88:91]
    v_mfma_f32_16x16x32_bf16 a[120:123], v[120:123], a[152:155], a[120:123]
    ds_read_b128 a[180:183], v232 offset:26624
    v_mfma_f32_16x16x32_bf16 v[28:31], v[124:127], a[128:131], v[28:31]
    v_perm_b32 v120, v167, v163, s92
    v_perm_b32 v121, v175, v171, s92
    v_mfma_f32_16x16x32_bf16 v[60:63], v[124:127], a[132:135], v[60:63]
    v_perm_b32 v122, v183, v179, s92
    v_perm_b32 v123, v191, v187, s92
    v_mfma_f32_16x16x32_bf16 v[92:95], v[124:127], a[136:139], v[92:95]
    v_mfma_f32_16x16x32_bf16 a[28:31], v[124:127], a[140:143], a[28:31]
    v_mfma_f32_16x16x32_bf16 a[60:63], v[124:127], a[144:147], a[60:63]
    v_mfma_f32_16x16x32_bf16 a[92:95], v[124:127], a[148:151], a[92:95]
    v_mfma_f32_16x16x32_bf16 a[124:127], v[124:127], a[152:155], a[124:127]
    s_waitcnt lgkmcnt(0)
    v_mfma_f32_16x16x32_bf16 v[0:3], v[96:99], a[156:159], v[0:3]
    v_perm_b32 v124, v167, v163, s93
    v_perm_b32 v125, v175, v171, s93
    v_mfma_f32_16x16x32_bf16 v[32:35], v[96:99], a[160:163], v[32:35]
    v_perm_b32 v126, v183, v179, s93
    v_perm_b32 v127, v191, v187, s93
    v_mfma_f32_16x16x32_bf16 v[64:67], v[96:99], a[164:167], v[64:67]
    buffer_load_dwordx4 v[160:163], v229, s[36:39], s58 offen
    s_add_u32 s58, s58, 8192
    v_mfma_f32_16x16x32_bf16 a[0:3], v[96:99], a[168:171], a[0:3]
    v_mfma_f32_16x16x32_bf16 a[32:35], v[96:99], a[172:175], a[32:35]
    v_mfma_f32_16x16x32_bf16 a[64:67], v[96:99], a[176:179], a[64:67]
    v_mfma_f32_16x16x32_bf16 a[96:99], v[96:99], a[180:183], a[96:99]
    s_waitcnt vmcnt(13)
    buffer_load_dwordx4 v[164:167], v229, s[36:39], s58 offen
    s_add_u32 s58, s58, 8192
    v_mfma_f32_16x16x32_bf16 v[4:7], v[100:103], a[156:159], v[4:7]
    v_perm_b32 v96, v196, v192, s92
    v_perm_b32 v97, v204, v200, s92
    v_mfma_f32_16x16x32_bf16 v[36:39], v[100:103], a[160:163], v[36:39]
    v_perm_b32 v98, v212, v208, s92
    v_perm_b32 v99, v220, v216, s92
    v_mfma_f32_16x16x32_bf16 v[68:71], v[100:103], a[164:167], v[68:71]
    v_mfma_f32_16x16x32_bf16 a[4:7], v[100:103], a[168:171], a[4:7]
    buffer_load_dwordx4 v[168:171], v229, s[36:39], s58 offen
    s_add_u32 s58, s58, 8192
    v_mfma_f32_16x16x32_bf16 a[36:39], v[100:103], a[172:175], a[36:39]
    v_mfma_f32_16x16x32_bf16 a[68:71], v[100:103], a[176:179], a[68:71]
    v_mfma_f32_16x16x32_bf16 a[100:103], v[100:103], a[180:183], a[100:103]
    v_mfma_f32_16x16x32_bf16 v[8:11], v[104:107], a[156:159], v[8:11]
    v_perm_b32 v100, v196, v192, s93
    v_perm_b32 v101, v204, v200, s93
    v_mfma_f32_16x16x32_bf16 v[40:43], v[104:107], a[160:163], v[40:43]
    v_perm_b32 v102, v212, v208, s93
    v_perm_b32 v103, v220, v216, s93
    v_mfma_f32_16x16x32_bf16 v[72:75], v[104:107], a[164:167], v[72:75]
    buffer_load_dwordx4 v[172:175], v229, s[36:39], s58 offen
    s_add_u32 s58, s58, 8192
    v_mfma_f32_16x16x32_bf16 a[8:11], v[104:107], a[168:171], a[8:11]
    v_mfma_f32_16x16x32_bf16 a[40:43], v[104:107], a[172:175], a[40:43]
    buffer_load_dwordx4 v[176:179], v229, s[36:39], s58 offen
    s_add_u32 s58, s58, 8192
    v_mfma_f32_16x16x32_bf16 a[72:75], v[104:107], a[176:179], a[72:75]
    v_mfma_f32_16x16x32_bf16 a[104:107], v[104:107], a[180:183], a[104:107]
    v_mfma_f32_16x16x32_bf16 v[12:15], v[108:111], a[156:159], v[12:15]
    v_perm_b32 v104, v197, v193, s92
    v_perm_b32 v105, v205, v201, s92
    v_mfma_f32_16x16x32_bf16 v[44:47], v[108:111], a[160:163], v[44:47]
    v_perm_b32 v106, v213, v209, s92
    v_perm_b32 v107, v221, v217, s92
    v_mfma_f32_16x16x32_bf16 v[76:79], v[108:111], a[164:167], v[76:79]
    buffer_load_dwordx4 v[180:183], v229, s[36:39], s58 offen
    s_add_u32 s58, s58, 8192
    v_mfma_f32_16x16x32_bf16 a[12:15], v[108:111], a[168:171], a[12:15]
    v_mfma_f32_16x16x32_bf16 a[44:47], v[108:111], a[172:175], a[44:47]
    v_mfma_f32_16x16x32_bf16 a[76:79], v[108:111], a[176:179], a[76:79]
    v_mfma_f32_16x16x32_bf16 a[108:111], v[108:111], a[180:183], a[108:111]
    v_mfma_f32_16x16x32_bf16 v[16:19], v[112:115], a[156:159], v[16:19]
    v_perm_b32 v108, v197, v193, s93
    v_perm_b32 v109, v205, v201, s93
    v_mfma_f32_16x16x32_bf16 v[48:51], v[112:115], a[160:163], v[48:51]
    v_perm_b32 v110, v213, v209, s93
    v_perm_b32 v111, v221, v217, s93
    v_mfma_f32_16x16x32_bf16 v[80:83], v[112:115], a[164:167], v[80:83]
    buffer_load_dwordx4 v[184:187], v229, s[36:39], s58 offen
    s_add_u32 s58, s58, 8192
    v_mfma_f32_16x16x32_bf16 a[16:19], v[112:115], a[168:171], a[16:19]
    v_mfma_f32_16x16x32_bf16 a[48:51], v[112:115], a[172:175], a[48:51]
    v_mfma_f32_16x16x32_bf16 a[80:83], v[112:115], a[176:179], a[80:83]
    s_waitcnt vmcnt(15)
    s_barrier
    buffer_load_dwordx4 v[188:191], v229, s[36:39], s58 offen
    s_add_u32 s58, s58, 204800
    s_cmp_ge_u32 s58, 4718592
    s_cselect_b32 s58, 0, s58
    v_mfma_f32_16x16x32_bf16 a[112:115], v[112:115], a[180:183], a[112:115]
    v_mfma_f32_16x16x32_bf16 v[20:23], v[116:119], a[156:159], v[20:23]
    v_perm_b32 v112, v198, v194, s92
    v_perm_b32 v113, v206, v202, s92
    v_mfma_f32_16x16x32_bf16 v[52:55], v[116:119], a[160:163], v[52:55]
    ds_read_b128 a[128:131], v230 offset:0
    v_perm_b32 v114, v214, v210, s92
    v_perm_b32 v115, v222, v218, s92
    v_mfma_f32_16x16x32_bf16 v[84:87], v[116:119], a[164:167], v[84:87]
    v_mfma_f32_16x16x32_bf16 a[20:23], v[116:119], a[168:171], a[20:23]
    ds_read_b128 a[132:135], v230 offset:2048
    s_add_u32 m0, s57, 14336
    s_mov_b32 s61, s59
    buffer_load_dwordx4 v236, s[40:43], s61 offen offset:0 lds
    v_mfma_f32_16x16x32_bf16 a[52:55], v[116:119], a[172:175], a[52:55]
    v_mfma_f32_16x16x32_bf16 a[84:87], v[116:119], a[176:179], a[84:87]
    ds_read_b128 a[136:139], v230 offset:4096
    v_mfma_f32_16x16x32_bf16 a[116:119], v[116:119], a[180:183], a[116:119]
    v_mfma_f32_16x16x32_bf16 v[24:27], v[120:123], a[156:159], v[24:27]
    ds_read_b128 a[140:143], v230 offset:6144
    v_perm_b32 v116, v198, v194, s93
    v_perm_b32 v117, v206, v202, s93
    v_mfma_f32_16x16x32_bf16 v[56:59], v[120:123], a[160:163], v[56:59]
    v_perm_b32 v118, v214, v210, s93
    v_perm_b32 v119, v222, v218, s93
    v_mfma_f32_16x16x32_bf16 v[88:91], v[120:123], a[164:167], v[88:91]
    ds_read_b128 a[144:147], v230 offset:8192
    buffer_load_dwordx4 v237, s[40:43], s61 offen offset:1024 lds
    v_mfma_f32_16x16x32_bf16 a[24:27], v[120:123], a[168:171], a[24:27]
    v_mfma_f32_16x16x32_bf16 a[56:59], v[120:123], a[172:175], a[56:59]
    ds_read_b128 a[148:151], v230 offset:10240
    v_mfma_f32_16x16x32_bf16 a[88:91], v[120:123], a[176:179], a[88:91]
    v_mfma_f32_16x16x32_bf16 a[120:123], v[120:123], a[180:183], a[120:123]
    ds_read_b128 a[152:155], v230 offset:12288
    buffer_load_dwordx4 v238, s[40:43], s61 offen offset:2048 lds
    v_mfma_f32_16x16x32_bf16 v[28:31], v[124:127], a[156:159], v[28:31]
    v_perm_b32 v120, v199, v195, s92
    v_perm_b32 v121, v207, v203, s92
    v_mfma_f32_16x16x32_bf16 v[60:63], v[124:127], a[160:163], v[60:63]
    v_perm_b32 v122, v215, v211, s92
    v_perm_b32 v123, v223, v219, s92
    v_mfma_f32_16x16x32_bf16 v[92:95], v[124:127], a[164:167], v[92:95]
    v_mfma_f32_16x16x32_bf16 a[28:31], v[124:127], a[168:171], a[28:31]
    v_mfma_f32_16x16x32_bf16 a[60:63], v[124:127], a[172:175], a[60:63]
    buffer_load_dwordx4 v239, s[40:43], s61 offen offset:3072 lds
    s_add_u32 s59, s59, 128
    s_cmp_ge_u32 s59, 1152
    s_cselect_b32 s59, 0, s59
    v_mfma_f32_16x16x32_bf16 a[92:95], v[124:127], a[176:179], a[92:95]
    v_mfma_f32_16x16x32_bf16 a[124:127], v[124:127], a[180:183], a[124:127]
    s_waitcnt lgkmcnt(0)
    v_mfma_f32_16x16x32_bf16 v[0:3], v[96:99], a[128:131], v[0:3]
    v_perm_b32 v124, v199, v195, s93
    v_perm_b32 v125, v207, v203, s93
    v_mfma_f32_16x16x32_bf16 v[32:35], v[96:99], a[132:135], v[32:35]
    v_perm_b32 v126, v215, v211, s93
    v_perm_b32 v127, v223, v219, s93
    v_mfma_f32_16x16x32_bf16 v[64:67], v[96:99], a[136:139], v[64:67]
    v_subrev_u32 v227, 9, v248
    v_min_u32 v248, v227, v248
    v_lshl_add_u32 v227, v248, 7, v244
    v_add_u32 v248, 3, v248
    buffer_load_dword v231, v227, s[40:43], 0 offen
    v_mfma_f32_16x16x32_bf16 a[0:3], v[96:99], a[140:143], a[0:3]
    v_mfma_f32_16x16x32_bf16 a[32:35], v[96:99], a[144:147], a[32:35]
    v_mfma_f32_16x16x32_bf16 a[64:67], v[96:99], a[148:151], a[64:67]
    v_mfma_f32_16x16x32_bf16 a[96:99], v[96:99], a[152:155], a[96:99]
    s_waitcnt vmcnt(13)
    v_mfma_f32_16x16x32_bf16 v[4:7], v[100:103], a[128:131], v[4:7]
    v_perm_b32 v96, v132, v128, s92
    v_perm_b32 v97, v140, v136, s92
    v_mfma_f32_16x16x32_bf16 v[36:39], v[100:103], a[132:135], v[36:39]
    v_perm_b32 v98, v148, v144, s92
    v_perm_b32 v99, v156, v152, s92
    v_mfma_f32_16x16x32_bf16 v[68:71], v[100:103], a[136:139], v[68:71]
    buffer_load_dwordx4 v[192:195], v229, s[36:39], s58 offen
    s_add_u32 s58, s58, 8192
    v_mfma_f32_16x16x32_bf16 a[4:7], v[100:103], a[140:143], a[4:7]
    v_mfma_f32_16x16x32_bf16 a[36:39], v[100:103], a[144:147], a[36:39]
    v_mfma_f32_16x16x32_bf16 a[68:71], v[100:103], a[148:151], a[68:71]
    buffer_load_dwordx4 v[196:199], v229, s[36:39], s58 offen
    s_add_u32 s58, s58, 8192
    v_mfma_f32_16x16x32_bf16 a[100:103], v[100:103], a[152:155], a[100:103]
    v_mfma_f32_16x16x32_bf16 v[8:11], v[104:107], a[128:131], v[8:11]
    v_perm_b32 v100, v132, v128, s93
    v_perm_b32 v101, v140, v136, s93
    v_mfma_f32_16x16x32_bf16 v[40:43], v[104:107], a[132:135], v[40:43]
    v_perm_b32 v102, v148, v144, s93
    v_perm_b32 v103, v156, v152, s93
    v_mfma_f32_16x16x32_bf16 v[72:75], v[104:107], a[136:139], v[72:75]
    v_mfma_f32_16x16x32_bf16 a[8:11], v[104:107], a[140:143], a[8:11]
    buffer_load_dwordx4 v[200:203], v229, s[36:39], s58 offen
    s_add_u32 s58, s58, 8192
    v_mfma_f32_16x16x32_bf16 a[40:43], v[104:107], a[144:147], a[40:43]
    v_mfma_f32_16x16x32_bf16 a[72:75], v[104:107], a[148:151], a[72:75]
    v_mfma_f32_16x16x32_bf16 a[104:107], v[104:107], a[152:155], a[104:107]
    v_mfma_f32_16x16x32_bf16 v[12:15], v[108:111], a[128:131], v[12:15]
    v_perm_b32 v104, v133, v129, s92
    v_perm_b32 v105, v141, v137, s92
    v_mfma_f32_16x16x32_bf16 v[44:47], v[108:111], a[132:135], v[44:47]
    v_perm_b32 v106, v149, v145, s92
    v_perm_b32 v107, v157, v153, s92
    v_mfma_f32_16x16x32_bf16 v[76:79], v[108:111], a[136:139], v[76:79]
    buffer_load_dwordx4 v[204:207], v229, s[36:39], s58 offen
    s_add_u32 s58, s58, 8192
    v_mfma_f32_16x16x32_bf16 a[12:15], v[108:111], a[140:143], a[12:15]
    v_mfma_f32_16x16x32_bf16 a[44:47], v[108:111], a[144:147], a[44:47]
    v_mfma_f32_16x16x32_bf16 a[76:79], v[108:111], a[148:151], a[76:79]
    v_mfma_f32_16x16x32_bf16 a[108:111], v[108:111], a[152:155], a[108:111]
    buffer_load_dwordx4 v[208:211], v229, s[36:39], s58 offen
    s_add_u32 s58, s58, 8192
    v_mfma_f32_16x16x32_bf16 v[16:19], v[112:115], a[128:131], v[16:19]
    v_perm_b32 v108, v133, v129, s93
    v_perm_b32 v109, v141, v137, s93
    v_mfma_f32_16x16x32_bf16 v[48:51], v[112:115], a[132:135], v[48:51]
    v_perm_b32 v110, v149, v145, s93
    v_perm_b32 v111, v157, v153, s93
    v_mfma_f32_16x16x32_bf16 v[80:83], v[112:115], a[136:139], v[80:83]
    v_mfma_f32_16x16x32_bf16 a[16:19], v[112:115], a[140:143], a[16:19]
    v_mfma_f32_16x16x32_bf16 a[48:51], v[112:115], a[144:147], a[48:51]
    buffer_load_dwordx4 v[212:215], v229, s[36:39], s58 offen
    s_add_u32 s58, s58, 8192
    v_mfma_f32_16x16x32_bf16 a[80:83], v[112:115], a[148:151], a[80:83]
    v_mfma_f32_16x16x32_bf16 a[112:115], v[112:115], a[152:155], a[112:115]
    v_mfma_f32_16x16x32_bf16 v[20:23], v[116:119], a[128:131], v[20:23]
    v_perm_b32 v112, v134, v130, s92
    v_perm_b32 v113, v142, v138, s92
    v_mfma_f32_16x16x32_bf16 v[52:55], v[116:119], a[132:135], v[52:55]
    ds_read_b128 a[156:159], v232 offset:0
    v_perm_b32 v114, v150, v146, s92
    v_perm_b32 v115, v158, v154, s92
    v_mfma_f32_16x16x32_bf16 v[84:87], v[116:119], a[136:139], v[84:87]
    buffer_load_dwordx4 v[216:219], v229, s[36:39], s58 offen
    s_add_u32 s58, s58, 8192
    v_mfma_f32_16x16x32_bf16 a[20:23], v[116:119], a[140:143], a[20:23]
    ds_read_b128 a[160:163], v232 offset:2048
    v_mfma_f32_16x16x32_bf16 a[52:55], v[116:119], a[144:147], a[52:55]
    v_mfma_f32_16x16x32_bf16 a[84:87], v[116:119], a[148:151], a[84:87]
    ds_read_b128 a[164:167], v232 offset:4096
    v_mfma_f32_16x16x32_bf16 a[116:119], v[116:119], a[152:155], a[116:119]
    v_mfma_f32_16x16x32_bf16 v[24:27], v[120:123], a[128:131], v[24:27]
    ds_read_b128 a[168:171], v232 offset:6144
    v_perm_b32 v116, v134, v130, s93
    v_perm_b32 v117, v142, v138, s93
    v_mfma_f32_16x16x32_bf16 v[56:59], v[120:123], a[132:135], v[56:59]
    v_perm_b32 v118, v150, v146, s93
    v_perm_b32 v119, v158, v154, s93
    v_mfma_f32_16x16x32_bf16 v[88:91], v[120:123], a[136:139], v[88:91]
    ds_read_b128 a[172:175], v232 offset:8192
    buffer_load_dwordx4 v[220:223], v229, s[36:39], s58 offen
    s_add_u32 s58, s58, 204800
    s_cmp_ge_u32 s58, 4718592
    s_cselect_b32 s58, 0, s58
    v_mfma_f32_16x16x32_bf16 a[24:27], v[120:123], a[140:143], a[24:27]
    v_mfma_f32_16x16x32_bf16 a[56:59], v[120:123], a[144:147], a[56:59]
    ds_read_b128 a[176:179], v232 offset:10240
    v_mfma_f32_16x16x32_bf16 a[88:91], v[120:123], a[148:151], a[88:91]
    v_mfma_f32_16x16x32_bf16 a[120:123], v[120:123], a[152:155], a[120:123]
    ds_read_b128 a[180:183], v232 offset:12288
    v_mfma_f32_16x16x32_bf16 v[28:31], v[124:127], a[128:131], v[28:31]
    v_perm_b32 v120, v135, v131, s92
    v_perm_b32 v121, v143, v139, s92
    v_mfma_f32_16x16x32_bf16 v[60:63], v[124:127], a[132:135], v[60:63]
    v_perm_b32 v122, v151, v147, s92
    v_perm_b32 v123, v159, v155, s92
    v_mfma_f32_16x16x32_bf16 v[92:95], v[124:127], a[136:139], v[92:95]
    v_mfma_f32_16x16x32_bf16 a[28:31], v[124:127], a[140:143], a[28:31]
    v_mfma_f32_16x16x32_bf16 a[60:63], v[124:127], a[144:147], a[60:63]
    v_mfma_f32_16x16x32_bf16 a[92:95], v[124:127], a[148:151], a[92:95]
    v_mfma_f32_16x16x32_bf16 a[124:127], v[124:127], a[152:155], a[124:127]
    s_waitcnt lgkmcnt(0)
    v_mfma_f32_16x16x32_bf16 v[0:3], v[96:99], a[156:159], v[0:3]
    v_perm_b32 v124, v135, v131, s93
    v_perm_b32 v125, v143, v139, s93
    v_mfma_f32_16x16x32_bf16 v[32:35], v[96:99], a[160:163], v[32:35]
    v_perm_b32 v126, v151, v147, s93
    v_perm_b32 v127, v159, v155, s93
    v_mfma_f32_16x16x32_bf16 v[64:67], v[96:99], a[164:167], v[64:67]
    buffer_load_dwordx4 v[128:131], v229, s[36:39], s58 offen
    s_add_u32 s58, s58, 8192
    v_mfma_f32_16x16x32_bf16 a[0:3], v[96:99], a[168:171], a[0:3]
    v_mfma_f32_16x16x32_bf16 a[32:35], v[96:99], a[172:175], a[32:35]
    v_mfma_f32_16x16x32_bf16 a[64:67], v[96:99], a[176:179], a[64:67]
    v_mfma_f32_16x16x32_bf16 a[96:99], v[96:99], a[180:183], a[96:99]
    s_waitcnt vmcnt(14)
    buffer_load_dwordx4 v[132:135], v229, s[36:39], s58 offen
    s_add_u32 s58, s58, 8192
    v_mfma_f32_16x16x32_bf16 v[4:7], v[100:103], a[156:159], v[4:7]
    v_perm_b32 v96, v164, v160, s92
    v_perm_b32 v97, v172, v168, s92
    v_mfma_f32_16x16x32_bf16 v[36:39], v[100:103], a[160:163], v[36:39]
    v_perm_b32 v98, v180, v176, s92
    v_perm_b32 v99, v188, v184, s92
    v_mfma_f32_16x16x32_bf16 v[68:71], v[100:103], a[164:167], v[68:71]
    v_mfma_f32_16x16x32_bf16 a[4:7], v[100:103], a[168:171], a[4:7]
    buffer_load_dwordx4 v[136:139], v229, s[36:39], s58 offen
    s_add_u32 s58, s58, 8192
    v_mfma_f32_16x16x32_bf16 a[36:39], v[100:103], a[172:175], a[36:39]
    v_mfma_f32_16x16x32_bf16 a[68:71], v[100:103], a[176:179], a[68:71]
    v_mfma_f32_16x16x32_bf16 a[100:103], v[100:103], a[180:183], a[100:103]
    v_mfma_f32_16x16x32_bf16 v[8:11], v[104:107], a[156:159], v[8:11]
    v_perm_b32 v100, v164, v160, s93
    v_perm_b32 v101, v172, v168, s93
    v_mfma_f32_16x16x32_bf16 v[40:43], v[104:107], a[160:163], v[40:43]
    v_perm_b32 v102, v180, v176, s93
    v_perm_b32 v103, v188, v184, s93
    v_mfma_f32_16x16x32_bf16 v[72:75], v[104:107], a[164:167], v[72:75]
    buffer_load_dwordx4 v[140:143], v229, s[36:39], s58 offen
    s_add_u32 s58, s58, 8192
    v_mfma_f32_16x16x32_bf16 a[8:11], v[104:107], a[168:171], a[8:11]
    v_mfma_f32_16x16x32_bf16 a[40:43], v[104:107], a[172:175], a[40:43]
    v_mfma_f32_16x16x32_bf16 a[72:75], v[104:107], a[176:179], a[72:75]
    buffer_load_dwordx4 v[144:147], v229, s[36:39], s58 offen
    s_add_u32 s58, s58, 8192
    v_mfma_f32_16x16x32_bf16 a[104:107], v[104:107], a[180:183], a[104:107]
    v_mfma_f32_16x16x32_bf16 v[12:15], v[108:111], a[156:159], v[12:15]
    v_perm_b32 v104, v165, v161, s92
    v_perm_b32 v105, v173, v169, s92
    v_mfma_f32_16x16x32_bf16 v[44:47], v[108:111], a[160:163], v[44:47]
    v_perm_b32 v106, v181, v177, s92
    v_perm_b32 v107, v189, v185, s92
    v_mfma_f32_16x16x32_bf16 v[76:79], v[108:111], a[164:167], v[76:79]
    v_mfma_f32_16x16x32_bf16 a[12:15], v[108:111], a[168:171], a[12:15]
    buffer_load_dwordx4 v[148:151], v229, s[36:39], s58 offen
    s_add_u32 s58, s58, 8192
    v_mfma_f32_16x16x32_bf16 a[44:47], v[108:111], a[172:175], a[44:47]
    v_mfma_f32_16x16x32_bf16 a[76:79], v[108:111], a[176:179], a[76:79]
    v_mfma_f32_16x16x32_bf16 a[108:111], v[108:111], a[180:183], a[108:111]
    v_mfma_f32_16x16x32_bf16 v[16:19], v[112:115], a[156:159], v[16:19]
    v_perm_b32 v108, v165, v161, s93
    v_perm_b32 v109, v173, v169, s93
    v_mfma_f32_16x16x32_bf16 v[48:51], v[112:115], a[160:163], v[48:51]
    v_perm_b32 v110, v181, v177, s93
    v_perm_b32 v111, v189, v185, s93
    v_mfma_f32_16x16x32_bf16 v[80:83], v[112:115], a[164:167], v[80:83]
    buffer_load_dwordx4 v[152:155], v229, s[36:39], s58 offen
    s_add_u32 s58, s58, 8192
    v_mfma_f32_16x16x32_bf16 a[16:19], v[112:115], a[168:171], a[16:19]
    v_mfma_f32_16x16x32_bf16 a[48:51], v[112:115], a[172:175], a[48:51]
    v_mfma_f32_16x16x32_bf16 a[80:83], v[112:115], a[176:179], a[80:83]
    s_waitcnt vmcnt(16)
    s_barrier
    v_mfma_f32_16x16x32_bf16 a[112:115], v[112:115], a[180:183], a[112:115]
    buffer_load_dwordx4 v[156:159], v229, s[36:39], s58 offen
    s_add_u32 s58, s58, 204800
    s_cmp_ge_u32 s58, 4718592
    s_cselect_b32 s58, 0, s58
    v_mfma_f32_16x16x32_bf16 v[20:23], v[116:119], a[156:159], v[20:23]
    v_perm_b32 v112, v166, v162, s92
    v_perm_b32 v113, v174, v170, s92
    v_mfma_f32_16x16x32_bf16 v[52:55], v[116:119], a[160:163], v[52:55]
    ds_read_b128 a[128:131], v230 offset:14336
    v_perm_b32 v114, v182, v178, s92
    v_perm_b32 v115, v190, v186, s92
    v_mfma_f32_16x16x32_bf16 v[84:87], v[116:119], a[164:167], v[84:87]
    v_mfma_f32_16x16x32_bf16 a[20:23], v[116:119], a[168:171], a[20:23]
    ds_read_b128 a[132:135], v230 offset:16384
    v_mfma_f32_16x16x32_bf16 a[52:55], v[116:119], a[172:175], a[52:55]
    s_add_u32 m0, s57, 0
    s_mov_b32 s61, s59
    buffer_load_dwordx4 v236, s[40:43], s61 offen offset:0 lds
    v_mfma_f32_16x16x32_bf16 a[84:87], v[116:119], a[176:179], a[84:87]
    ds_read_b128 a[136:139], v230 offset:18432
    v_mfma_f32_16x16x32_bf16 a[116:119], v[116:119], a[180:183], a[116:119]
    v_mfma_f32_16x16x32_bf16 v[24:27], v[120:123], a[156:159], v[24:27]
    ds_read_b128 a[140:143], v230 offset:20480
    v_perm_b32 v116, v166, v162, s93
    v_perm_b32 v117, v174, v170, s93
    v_mfma_f32_16x16x32_bf16 v[56:59], v[120:123], a[160:163], v[56:59]
    v_perm_b32 v118, v182, v178, s93
    v_perm_b32 v119, v190, v186, s93
    v_mfma_f32_16x16x32_bf16 v[88:91], v[120:123], a[164:167], v[88:91]
    ds_read_b128 a[144:147], v230 offset:22528
    buffer_load_dwordx4 v237, s[40:43], s61 offen offset:1024 lds
    v_mfma_f32_16x16x32_bf16 a[24:27], v[120:123], a[168:171], a[24:27]
    v_mfma_f32_16x16x32_bf16 a[56:59], v[120:123], a[172:175], a[56:59]
    ds_read_b128 a[148:151], v230 offset:24576
    v_mfma_f32_16x16x32_bf16 a[88:91], v[120:123], a[176:179], a[88:91]
    v_mfma_f32_16x16x32_bf16 a[120:123], v[120:123], a[180:183], a[120:123]
    ds_read_b128 a[152:155], v230 offset:26624
    v_mfma_f32_16x16x32_bf16 v[28:31], v[124:127], a[156:159], v[28:31]
    v_perm_b32 v120, v167, v163, s92
    v_perm_b32 v121, v175, v171, s92
    v_mfma_f32_16x16x32_bf16 v[60:63], v[124:127], a[160:163], v[60:63]
    v_perm_b32 v122, v183, v179, s92
    v_perm_b32 v123, v191, v187, s92
    v_mfma_f32_16x16x32_bf16 v[92:95], v[124:127], a[164:167], v[92:95]
    buffer_load_dwordx4 v238, s[40:43], s61 offen offset:2048 lds
    v_mfma_f32_16x16x32_bf16 a[28:31], v[124:127], a[168:171], a[28:31]
    v_mfma_f32_16x16x32_bf16 a[60:63], v[124:127], a[172:175], a[60:63]
    v_mfma_f32_16x16x32_bf16 a[92:95], v[124:127], a[176:179], a[92:95]
    buffer_load_dwordx4 v239, s[40:43], s61 offen offset:3072 lds
    s_add_u32 s59, s59, 128
    s_cmp_ge_u32 s59, 1152
    s_cselect_b32 s59, 0, s59
    v_mfma_f32_16x16x32_bf16 a[124:127], v[124:127], a[180:183], a[124:127]
    s_waitcnt lgkmcnt(0)
    v_mfma_f32_16x16x32_bf16 v[0:3], v[96:99], a[128:131], v[0:3]
    v_perm_b32 v124, v167, v163, s93
    v_perm_b32 v125, v175, v171, s93
    v_mfma_f32_16x16x32_bf16 v[32:35], v[96:99], a[132:135], v[32:35]
    v_perm_b32 v126, v183, v179, s93
    v_perm_b32 v127, v191, v187, s93
    v_mfma_f32_16x16x32_bf16 v[64:67], v[96:99], a[136:139], v[64:67]
    v_mfma_f32_16x16x32_bf16 a[0:3], v[96:99], a[140:143], a[0:3]
    buffer_load_dwordx4 v[160:163], v229, s[36:39], s58 offen
    s_add_u32 s58, s58, 8192
    v_mfma_f32_16x16x32_bf16 a[32:35], v[96:99], a[144:147], a[32:35]
    v_mfma_f32_16x16x32_bf16 a[64:67], v[96:99], a[148:151], a[64:67]
    v_mfma_f32_16x16x32_bf16 a[96:99], v[96:99], a[152:155], a[96:99]
    s_waitcnt vmcnt(13)
    v_mfma_f32_16x16x32_bf16 v[4:7], v[100:103], a[128:131], v[4:7]
    v_perm_b32 v96, v196, v192, s92
    v_perm_b32 v97, v204, v200, s92
    v_mfma_f32_16x16x32_bf16 v[36:39], v[100:103], a[132:135], v[36:39]
    v_perm_b32 v98, v212, v208, s92
    v_perm_b32 v99, v220, v216, s92
    v_mfma_f32_16x16x32_bf16 v[68:71], v[100:103], a[136:139], v[68:71]
    buffer_load_dwordx4 v[164:167], v229, s[36:39], s58 offen
    s_add_u32 s58, s58, 8192
    v_mfma_f32_16x16x32_bf16 a[4:7], v[100:103], a[140:143], a[4:7]
    v_mfma_f32_16x16x32_bf16 a[36:39], v[100:103], a[144:147], a[36:39]
    v_mfma_f32_16x16x32_bf16 a[68:71], v[100:103], a[148:151], a[68:71]
    v_mfma_f32_16x16x32_bf16 a[100:103], v[100:103], a[152:155], a[100:103]
    buffer_load_dwordx4 v[168:171], v229, s[36:39], s58 offen
    s_add_u32 s58, s58, 8192
    v_mfma_f32_16x16x32_bf16 v[8:11], v[104:107], a[128:131], v[8:11]
    v_perm_b32 v100, v196, v192, s93
    v_perm_b32 v101, v204, v200, s93
    v_mfma_f32_16x16x32_bf16 v[40:43], v[104:107], a[132:135], v[40:43]
    v_perm_b32 v102, v212, v208, s93
    v_perm_b32 v103, v220, v216, s93
    v_mfma_f32_16x16x32_bf16 v[72:75], v[104:107], a[136:139], v[72:75]
    v_mfma_f32_16x16x32_bf16 a[8:11], v[104:107], a[140:143], a[8:11]
    v_mfma_f32_16x16x32_bf16 a[40:43], v[104:107], a[144:147], a[40:43]
    buffer_load_dwordx4 v[172:175], v229, s[36:39], s58 offen
    s_add_u32 s58, s58, 8192
    v_mfma_f32_16x16x32_bf16 a[72:75], v[104:107], a[148:151], a[72:75]
    v_mfma_f32_16x16x32_bf16 a[104:107], v[104:107], a[152:155], a[104:107]
    v_mfma_f32_16x16x32_bf16 v[12:15], v[108:111], a[128:131], v[12:15]
    v_perm_b32 v104, v197, v193, s92
    v_perm_b32 v105, v205, v201, s92
    v_mfma_f32_16x16x32_bf16 v[44:47], v[108:111], a[132:135], v[44:47]
    v_perm_b32 v106, v213, v209, s92
    v_perm_b32 v107, v221, v217, s92
    v_mfma_f32_16x16x32_bf16 v[76:79], v[108:111], a[136:139], v[76:79]
    buffer_load_dwordx4 v[176:179], v229, s[36:39], s58 offen
    s_add_u32 s58, s58, 8192
    v_mfma_f32_16x16x32_bf16 a[12:15], v[108:111], a[140:143], a[12:15]
    v_mfma_f32_16x16x32_bf16 a[44:47], v[108:111], a[144:147], a[44:47]
    v_mfma_f32_16x16x32_bf16 a[76:79], v[108:111], a[148:151], a[76:79]
    v_mfma_f32_16x16x32_bf16 a[108:111], v[108:111], a[152:155], a[108:111]
    v_mfma_f32_16x16x32_bf16 v[16:19], v[112:115], a[128:131], v[16:19]
    v_perm_b32 v108, v197, v193, s93
    v_perm_b32 v109, v205, v201, s93
    v_mfma_f32_16x16x32_bf16 v[48:51], v[112:115], a[132:135], v[48:51]
    v_perm_b32 v110, v213, v209, s93
    v_perm_b32 v111, v221, v217, s93
    v_mfma_f32_16x16x32_bf16 v[80:83], v[112:115], a[136:139], v[80:83]
    buffer_load_dwordx4 v[180:183], v229, s[36:39], s58 offen
    s_add_u32 s58, s58, 8192
    v_mfma_f32_16x16x32_bf16 a[16:19], v[112:115], a[140:143], a[16:19]
    v_mfma_f32_16x16x32_bf16 a[48:51], v[112:115], a[144:147], a[48:51]
    v_mfma_f32_16x16x32_bf16 a[80:83], v[112:115], a[148:151], a[80:83]
    buffer_load_dwordx4 v[184:187], v229, s[36:39], s58 offen
    s_add_u32 s58, s58, 8192
    v_mfma_f32_16x16x32_bf16 a[112:115], v[112:115], a[152:155], a[112:115]
    v_mfma_f32_16x16x32_bf16 v[20:23], v[116:119], a[128:131], v[20:23]
    v_perm_b32 v112, v198, v194, s92
    v_perm_b32 v113, v206, v202, s92
    v_mfma_f32_16x16x32_bf16 v[52:55], v[116:119], a[132:135], v[52:55]
    ds_read_b128 a[156:159], v232 offset:14336
    v_perm_b32 v114, v214, v210, s92
    v_perm_b32 v115, v222, v218, s92
    v_mfma_f32_16x16x32_bf16 v[84:87], v[116:119], a[136:139], v[84:87]
    v_mfma_f32_16x16x32_bf16 a[20:23], v[116:119], a[140:143], a[20:23]
    ds_read_b128 a[160:163], v232 offset:16384
    buffer_load_dwordx4 v[188:191], v229, s[36:39], s58 offen
    s_add_u32 s58, s58, 204800
    s_cmp_ge_u32 s58, 4718592
    s_cselect_b32 s58, 0, s58
    v_mfma_f32_16x16x32_bf16 a[52:55], v[116:119], a[144:147], a[52:55]
    v_mfma_f32_16x16x32_bf16 a[84:87], v[116:119], a[148:151], a[84:87]
    ds_read_b128 a[164:167], v232 offset:18432
    v_mfma_f32_16x16x32_bf16 a[116:119], v[116:119], a[152:155], a[116:119]
    v_mfma_f32_16x16x32_bf16 v[24:27], v[120:123], a[128:131], v[24:27]
    ds_read_b128 a[168:171], v232 offset:20480
    v_perm_b32 v116, v198, v194, s93
    v_perm_b32 v117, v206, v202, s93
    v_mfma_f32_16x16x32_bf16 v[56:59], v[120:123], a[132:135], v[56:59]
    v_perm_b32 v118, v214, v210, s93
    v_perm_b32 v119, v222, v218, s93
    v_mfma_f32_16x16x32_bf16 v[88:91], v[120:123], a[136:139], v[88:91]
    ds_read_b128 a[172:175], v232 offset:22528
    v_mfma_f32_16x16x32_bf16 a[24:27], v[120:123], a[140:143], a[24:27]
    v_mfma_f32_16x16x32_bf16 a[56:59], v[120:123], a[144:147], a[56:59]
    ds_read_b128 a[176:179], v232 offset:24576
    v_mfma_f32_16x16x32_bf16 a[88:91], v[120:123], a[148:151], a[88:91]
    v_mfma_f32_16x16x32_bf16 a[120:123], v[120:123], a[152:155], a[120:123]
    ds_read_b128 a[180:183], v232 offset:26624
    v_mfma_f32_16x16x32_bf16 v[28:31], v[124:127], a[128:131], v[28:31]
    v_perm_b32 v120, v199, v195, s92
    v_perm_b32 v121, v207, v203, s92
    v_mfma_f32_16x16x32_bf16 v[60:63], v[124:127], a[132:135], v[60:63]
    v_perm_b32 v122, v215, v211, s92
    v_perm_b32 v123, v223, v219, s92
    v_mfma_f32_16x16x32_bf16 v[92:95], v[124:127], a[136:139], v[92:95]
    v_mfma_f32_16x16x32_bf16 a[28:31], v[124:127], a[140:143], a[28:31]
    v_mfma_f32_16x16x32_bf16 a[60:63], v[124:127], a[144:147], a[60:63]
    v_mfma_f32_16x16x32_bf16 a[92:95], v[124:127], a[148:151], a[92:95]
    v_mfma_f32_16x16x32_bf16 a[124:127], v[124:127], a[152:155], a[124:127]
    s_waitcnt lgkmcnt(0)
    v_mfma_f32_16x16x32_bf16 v[0:3], v[96:99], a[156:159], v[0:3]
    v_perm_b32 v124, v199, v195, s93
    v_perm_b32 v125, v207, v203, s93
    v_mfma_f32_16x16x32_bf16 v[32:35], v[96:99], a[160:163], v[32:35]
    v_perm_b32 v126, v215, v211, s93
    v_perm_b32 v127, v223, v219, s93
    v_mfma_f32_16x16x32_bf16 v[64:67], v[96:99], a[164:167], v[64:67]
    buffer_load_dwordx4 v[192:195], v229, s[36:39], s58 offen
    s_add_u32 s58, s58, 8192
    v_mfma_f32_16x16x32_bf16 a[0:3], v[96:99], a[168:171], a[0:3]
    v_mfma_f32_16x16x32_bf16 a[32:35], v[96:99], a[172:175], a[32:35]
    v_mfma_f32_16x16x32_bf16 a[64:67], v[96:99], a[176:179], a[64:67]
    v_mfma_f32_16x16x32_bf16 a[96:99], v[96:99], a[180:183], a[96:99]
    s_waitcnt vmcnt(13)
    buffer_load_dwordx4 v[196:199], v229, s[36:39], s58 offen
    s_add_u32 s58, s58, 8192
    v_mfma_f32_16x16x32_bf16 v[4:7], v[100:103], a[156:159], v[4:7]
    v_perm_b32 v96, v132, v128, s92
    v_perm_b32 v97, v140, v136, s92
    v_mfma_f32_16x16x32_bf16 v[36:39], v[100:103], a[160:163], v[36:39]
    v_perm_b32 v98, v148, v144, s92
    v_perm_b32 v99, v156, v152, s92
    v_mfma_f32_16x16x32_bf16 v[68:71], v[100:103], a[164:167], v[68:71]
    v_mfma_f32_16x16x32_bf16 a[4:7], v[100:103], a[168:171], a[4:7]
    buffer_load_dwordx4 v[200:203], v229, s[36:39], s58 offen
    s_add_u32 s58, s58, 8192
    v_mfma_f32_16x16x32_bf16 a[36:39], v[100:103], a[172:175], a[36:39]
    v_mfma_f32_16x16x32_bf16 a[68:71], v[100:103], a[176:179], a[68:71]
    v_mfma_f32_16x16x32_bf16 a[100:103], v[100:103], a[180:183], a[100:103]
    v_mfma_f32_16x16x32_bf16 v[8:11], v[104:107], a[156:159], v[8:11]
    v_perm_b32 v100, v132, v128, s93
    v_perm_b32 v101, v140, v136, s93
    v_mfma_f32_16x16x32_bf16 v[40:43], v[104:107], a[160:163], v[40:43]
    v_perm_b32 v102, v148, v144, s93
    v_perm_b32 v103, v156, v152, s93
    v_mfma_f32_16x16x32_bf16 v[72:75], v[104:107], a[164:167], v[72:75]
    buffer_load_dwordx4 v[204:207], v229, s[36:39], s58 offen
    s_add_u32 s58, s58, 8192
    v_mfma_f32_16x16x32_bf16 a[8:11], v[104:107], a[168:171], a[8:11]
    v_mfma_f32_16x16x32_bf16 a[40:43], v[104:107], a[172:175], a[40:43]
    buffer_load_dwordx4 v[208:211], v229, s[36:39], s58 offen
    s_add_u32 s58, s58, 8192
    v_mfma_f32_16x16x32_bf16 a[72:75], v[104:107], a[176:179], a[72:75]
    v_mfma_f32_16x16x32_bf16 a[104:107], v[104:107], a[180:183], a[104:107]
    v_mfma_f32_16x16x32_bf16 v[12:15], v[108:111], a[156:159], v[12:15]
    v_perm_b32 v104, v133, v129, s92
    v_perm_b32 v105, v141, v137, s92
    v_mfma_f32_16x16x32_bf16 v[44:47], v[108:111], a[160:163], v[44:47]
    v_perm_b32 v106, v149, v145, s92
    v_perm_b32 v107, v157, v153, s92
    v_mfma_f32_16x16x32_bf16 v[76:79], v[108:111], a[164:167], v[76:79]
    buffer_load_dwordx4 v[212:215], v229, s[36:39], s58 offen
    s_add_u32 s58, s58, 8192
    v_mfma_f32_16x16x32_bf16 a[12:15], v[108:111], a[168:171], a[12:15]
    v_mfma_f32_16x16x32_bf16 a[44:47], v[108:111], a[172:175], a[44:47]
    v_mfma_f32_16x16x32_bf16 a[76:79], v[108:111], a[176:179], a[76:79]
    buffer_load_dwordx4 v[216:219], v229, s[36:39], s58 offen
    s_add_u32 s58, s58, 8192
    v_mfma_f32_16x16x32_bf16 a[108:111], v[108:111], a[180:183], a[108:111]
    v_mfma_f32_16x16x32_bf16 v[16:19], v[112:115], a[156:159], v[16:19]
    v_perm_b32 v108, v133, v129, s93
    v_perm_b32 v109, v141, v137, s93
    v_mfma_f32_16x16x32_bf16 v[48:51], v[112:115], a[160:163], v[48:51]
    v_perm_b32 v110, v149, v145, s93
    v_perm_b32 v111, v157, v153, s93
    v_mfma_f32_16x16x32_bf16 v[80:83], v[112:115], a[164:167], v[80:83]
    buffer_load_dwordx4 v[220:223], v229, s[36:39], s58 offen
    s_add_u32 s58, s58, 204800
    s_cmp_ge_u32 s58, 4718592
    s_cselect_b32 s58, 0, s58
    v_mfma_f32_16x16x32_bf16 a[16:19], v[112:115], a[168:171], a[16:19]
    v_mfma_f32_16x16x32_bf16 a[48:51], v[112:115], a[172:175], a[48:51]
    v_mfma_f32_16x16x32_bf16 a[80:83], v[112:115], a[176:179], a[80:83]
    s_waitcnt vmcnt(16)
    s_barrier
    v_mfma_f32_16x16x32_bf16 a[112:115], v[112:115], a[180:183], a[112:115]
    s_add_u32 m0, s57, 14336
    s_mov_b32 s61, s59
    buffer_load_dwordx4 v236, s[40:43], s61 offen offset:0 lds
    v_mfma_f32_16x16x32_bf16 v[20:23], v[116:119], a[156:159], v[20:23]
    v_perm_b32 v112, v134, v130, s92
    v_perm_b32 v113, v142, v138, s92
    v_mfma_f32_16x16x32_bf16 v[52:55], v[116:119], a[160:163], v[52:55]
    ds_read_b128 a[128:131], v230 offset:0
    v_perm_b32 v114, v150, v146, s92
    v_perm_b32 v115, v158, v154, s92
    v_mfma_f32_16x16x32_bf16 v[84:87], v[116:119], a[164:167], v[84:87]
    v_mfma_f32_16x16x32_bf16 a[20:23], v[116:119], a[168:171], a[20:23]
    ds_read_b128 a[132:135], v230 offset:2048
    buffer_load_dwordx4 v237, s[40:43], s61 offen offset:1024 lds
    v_mfma_f32_16x16x32_bf16 a[52:55], v[116:119], a[172:175], a[52:55]
    v_mfma_f32_16x16x32_bf16 a[84:87], v[116:119], a[176:179], a[84:87]
    ds_read_b128 a[136:139], v230 offset:4096
    v_mfma_f32_16x16x32_bf16 a[116:119], v[116:119], a[180:183], a[116:119]
    v_mfma_f32_16x16x32_bf16 v[24:27], v[120:123], a[156:159], v[24:27]
    ds_read_b128 a[140:143], v230 offset:6144
    v_perm_b32 v116, v134, v130, s93
    v_perm_b32 v117, v142, v138, s93
    v_mfma_f32_16x16x32_bf16 v[56:59], v[120:123], a[160:163], v[56:59]
    v_perm_b32 v118, v150, v146, s93
    v_perm_b32 v119, v158, v154, s93
    v_mfma_f32_16x16x32_bf16 v[88:91], v[120:123], a[164:167], v[88:91]
    ds_read_b128 a[144:147], v230 offset:8192
    buffer_load_dwordx4 v238, s[40:43], s61 offen offset:2048 lds
    v_mfma_f32_16x16x32_bf16 a[24:27], v[120:123], a[168:171], a[24:27]
    v_mfma_f32_16x16x32_bf16 a[56:59], v[120:123], a[172:175], a[56:59]
    ds_read_b128 a[148:151], v230 offset:10240
    buffer_load_dwordx4 v239, s[40:43], s61 offen offset:3072 lds
    s_add_u32 s59, s59, 128
    s_cmp_ge_u32 s59, 1152
    s_cselect_b32 s59, 0, s59
    v_mfma_f32_16x16x32_bf16 a[88:91], v[120:123], a[176:179], a[88:91]
    v_mfma_f32_16x16x32_bf16 a[120:123], v[120:123], a[180:183], a[120:123]
    ds_read_b128 a[152:155], v230 offset:12288
    v_mfma_f32_16x16x32_bf16 v[28:31], v[124:127], a[156:159], v[28:31]
    v_perm_b32 v120, v135, v131, s92
    v_perm_b32 v121, v143, v139, s92
    v_mfma_f32_16x16x32_bf16 v[60:63], v[124:127], a[160:163], v[60:63]
    v_perm_b32 v122, v151, v147, s92
    v_perm_b32 v123, v159, v155, s92
    v_mfma_f32_16x16x32_bf16 v[92:95], v[124:127], a[164:167], v[92:95]
    s_mov_b32 m0, s67
    s_cmp_lt_u32 s66, 16
    s_cselect_b32 s50, 135168, 0
    buffer_load_dwordx4 v240, s[48:51], s62 offen offset:0 nt lds
    v_mfma_f32_16x16x32_bf16 a[28:31], v[124:127], a[168:171], a[28:31]
    v_mfma_f32_16x16x32_bf16 a[60:63], v[124:127], a[172:175], a[60:63]
    v_mfma_f32_16x16x32_bf16 a[92:95], v[124:127], a[176:179], a[92:95]
    v_mfma_f32_16x16x32_bf16 a[124:127], v[124:127], a[180:183], a[124:127]
    s_waitcnt lgkmcnt(0)
    v_mfma_f32_16x16x32_bf16 v[0:3], v[96:99], a[128:131], v[0:3]
    v_perm_b32 v124, v135, v131, s93
    v_perm_b32 v125, v143, v139, s93
    v_mfma_f32_16x16x32_bf16 v[32:35], v[96:99], a[132:135], v[32:35]
    v_perm_b32 v126, v151, v147, s93
    v_perm_b32 v127, v159, v155, s93
    v_mfma_f32_16x16x32_bf16 v[64:67], v[96:99], a[136:139], v[64:67]
    v_mfma_f32_16x16x32_bf16 a[0:3], v[96:99], a[140:143], a[0:3]
    v_mfma_f32_16x16x32_bf16 a[32:35], v[96:99], a[144:147], a[32:35]
    v_mfma_f32_16x16x32_bf16 a[64:67], v[96:99], a[148:151], a[64:67]
    s_add_u32 s62, s62, 1024
    s_and_b32 s62, s62, 0x1ffff
    buffer_load_dwordx4 v241, s[48:51], s62 offen offset:1056 nt lds
    v_mfma_f32_16x16x32_bf16 a[96:99], v[96:99], a[152:155], a[96:99]
    s_waitcnt vmcnt(14)
    v_mfma_f32_16x16x32_bf16 v[4:7], v[100:103], a[128:131], v[4:7]
    v_perm_b32 v96, v164, v160, s92
    v_perm_b32 v97, v172, v168, s92
    v_mfma_f32_16x16x32_bf16 v[36:39], v[100:103], a[132:135], v[36:39]
    v_perm_b32 v98, v180, v176, s92
    v_perm_b32 v99, v188, v184, s92
    v_mfma_f32_16x16x32_bf16 v[68:71], v[100:103], a[136:139], v[68:71]
    v_mfma_f32_16x16x32_bf16 a[4:7], v[100:103], a[140:143], a[4:7]
    v_mfma_f32_16x16x32_bf16 a[36:39], v[100:103], a[144:147], a[36:39]
    v_mfma_f32_16x16x32_bf16 a[68:71], v[100:103], a[148:151], a[68:71]
    v_mfma_f32_16x16x32_bf16 a[100:103], v[100:103], a[152:155], a[100:103]
    v_mfma_f32_16x16x32_bf16 v[8:11], v[104:107], a[128:131], v[8:11]
    v_perm_b32 v100, v164, v160, s93
    v_perm_b32 v101, v172, v168, s93
    v_mfma_f32_16x16x32_bf16 v[40:43], v[104:107], a[132:135], v[40:43]
    v_perm_b32 v102, v180, v176, s93
    v_perm_b32 v103, v188, v184, s93
    v_mfma_f32_16x16x32_bf16 v[72:75], v[104:107], a[136:139], v[72:75]
    s_add_u32 s62, s62, 1024
    s_and_b32 s62, s62, 0x1ffff
    buffer_load_dwordx4 v242, s[48:51], s62 offen offset:2112 nt lds
    v_mfma_f32_16x16x32_bf16 a[8:11], v[104:107], a[140:143], a[8:11]
    v_mfma_f32_16x16x32_bf16 a[40:43], v[104:107], a[144:147], a[40:43]
    v_mfma_f32_16x16x32_bf16 a[72:75], v[104:107], a[148:151], a[72:75]
    v_mfma_f32_16x16x32_bf16 a[104:107], v[104:107], a[152:155], a[104:107]
    v_mfma_f32_16x16x32_bf16 v[12:15], v[108:111], a[128:131], v[12:15]
    v_perm_b32 v104, v165, v161, s92
    v_perm_b32 v105, v173, v169, s92
    v_mfma_f32_16x16x32_bf16 v[44:47], v[108:111], a[132:135], v[44:47]
    v_perm_b32 v106, v181, v177, s92
    v_perm_b32 v107, v189, v185, s92
    v_mfma_f32_16x16x32_bf16 v[76:79], v[108:111], a[136:139], v[76:79]
    v_mfma_f32_16x16x32_bf16 a[12:15], v[108:111], a[140:143], a[12:15]
    v_mfma_f32_16x16x32_bf16 a[44:47], v[108:111], a[144:147], a[44:47]
    s_add_u32 s62, s62, 1024
    s_and_b32 s62, s62, 0x1ffff
    buffer_load_dwordx4 v243, s[48:51], s62 offen offset:3168 nt lds
    v_mfma_f32_16x16x32_bf16 a[76:79], v[108:111], a[148:151], a[76:79]
    v_mfma_f32_16x16x32_bf16 a[108:111], v[108:111], a[152:155], a[108:111]
    v_mfma_f32_16x16x32_bf16 v[16:19], v[112:115], a[128:131], v[16:19]
    v_perm_b32 v108, v165, v161, s93
    v_perm_b32 v109, v173, v169, s93
    v_mfma_f32_16x16x32_bf16 v[48:51], v[112:115], a[132:135], v[48:51]
    v_perm_b32 v110, v181, v177, s93
    v_perm_b32 v111, v189, v185, s93
    v_mfma_f32_16x16x32_bf16 v[80:83], v[112:115], a[136:139], v[80:83]
    v_mfma_f32_16x16x32_bf16 a[16:19], v[112:115], a[140:143], a[16:19]
    v_mfma_f32_16x16x32_bf16 a[48:51], v[112:115], a[144:147], a[48:51]
    v_mfma_f32_16x16x32_bf16 a[80:83], v[112:115], a[148:151], a[80:83]
    v_mfma_f32_16x16x32_bf16 a[112:115], v[112:115], a[152:155], a[112:115]
    v_mfma_f32_16x16x32_bf16 v[20:23], v[116:119], a[128:131], v[20:23]
    v_perm_b32 v112, v166, v162, s92
    v_perm_b32 v113, v174, v170, s92
    v_mfma_f32_16x16x32_bf16 v[52:55], v[116:119], a[132:135], v[52:55]
    ds_read_b128 a[156:159], v232 offset:0
    v_perm_b32 v114, v182, v178, s92
    v_perm_b32 v115, v190, v186, s92
    v_mfma_f32_16x16x32_bf16 v[84:87], v[116:119], a[136:139], v[84:87]
    s_add_u32 s62, s62, 1024
    s_and_b32 s62, s62, 0x1ffff
    s_add_u32 m0, s67, 4224
    s_nop 0
    buffer_load_dwordx4 v240, s[48:51], s62 offen offset:0 nt lds
    v_mfma_f32_16x16x32_bf16 a[20:23], v[116:119], a[140:143], a[20:23]
    ds_read_b128 a[160:163], v232 offset:2048
    v_mfma_f32_16x16x32_bf16 a[52:55], v[116:119], a[144:147], a[52:55]
    v_mfma_f32_16x16x32_bf16 a[84:87], v[116:119], a[148:151], a[84:87]
    ds_read_b128 a[164:167], v232 offset:4096
    v_mfma_f32_16x16x32_bf16 a[116:119], v[116:119], a[152:155], a[116:119]
    v_mfma_f32_16x16x32_bf16 v[24:27], v[120:123], a[128:131], v[24:27]
    ds_read_b128 a[168:171], v232 offset:6144
    v_perm_b32 v116, v166, v162, s93
    v_perm_b32 v117, v174, v170, s93
    v_mfma_f32_16x16x32_bf16 v[56:59], v[120:123], a[132:135], v[56:59]
    v_perm_b32 v118, v182, v178, s93
    v_perm_b32 v119, v190, v186, s93
    v_mfma_f32_16x16x32_bf16 v[88:91], v[120:123], a[136:139], v[88:91]
    ds_read_b128 a[172:175], v232 offset:8192
    v_mfma_f32_16x16x32_bf16 a[24:27], v[120:123], a[140:143], a[24:27]
    s_add_u32 s62, s62, 1024
    s_and_b32 s62, s62, 0x1ffff
    buffer_load_dwordx4 v241, s[48:51], s62 offen offset:1056 nt lds
    v_mfma_f32_16x16x32_bf16 a[56:59], v[120:123], a[144:147], a[56:59]
    ds_read_b128 a[176:179], v232 offset:10240
    v_mfma_f32_16x16x32_bf16 a[88:91], v[120:123], a[148:151], a[88:91]
    v_mfma_f32_16x16x32_bf16 a[120:123], v[120:123], a[152:155], a[120:123]
    ds_read_b128 a[180:183], v232 offset:12288
    v_mfma_f32_16x16x32_bf16 v[28:31], v[124:127], a[128:131], v[28:31]
    v_perm_b32 v120, v167, v163, s92
    v_perm_b32 v121, v175, v171, s92
    v_mfma_f32_16x16x32_bf16 v[60:63], v[124:127], a[132:135], v[60:63]
    v_perm_b32 v122, v183, v179, s92
    v_perm_b32 v123, v191, v187, s92
    v_mfma_f32_16x16x32_bf16 v[92:95], v[124:127], a[136:139], v[92:95]
    v_mfma_f32_16x16x32_bf16 a[28:31], v[124:127], a[140:143], a[28:31]
    v_mfma_f32_16x16x32_bf16 a[60:63], v[124:127], a[144:147], a[60:63]
    v_mfma_f32_16x16x32_bf16 a[92:95], v[124:127], a[148:151], a[92:95]
    v_mfma_f32_16x16x32_bf16 a[124:127], v[124:127], a[152:155], a[124:127]
    s_waitcnt lgkmcnt(0)
    s_add_u32 s62, s62, 1024
    s_and_b32 s62, s62, 0x1ffff
    buffer_load_dwordx4 v242, s[48:51], s62 offen offset:2112 nt lds
    v_mfma_f32_16x16x32_bf16 v[0:3], v[96:99], a[156:159], v[0:3]
    v_perm_b32 v124, v167, v163, s93
    v_perm_b32 v125, v175, v171, s93
    v_mfma_f32_16x16x32_bf16 v[32:35], v[96:99], a[160:163], v[32:35]
    v_perm_b32 v126, v183, v179, s93
    v_perm_b32 v127, v191, v187, s93
    v_mfma_f32_16x16x32_bf16 v[64:67], v[96:99], a[164:167], v[64:67]
    v_mfma_f32_16x16x32_bf16 a[0:3], v[96:99], a[168:171], a[0:3]
    v_mfma_f32_16x16x32_bf16 a[32:35], v[96:99], a[172:175], a[32:35]
    v_mfma_f32_16x16x32_bf16 a[64:67], v[96:99], a[176:179], a[64:67]
    v_mfma_f32_16x16x32_bf16 a[96:99], v[96:99], a[180:183], a[96:99]
    s_waitcnt vmcnt(11)
    v_mfma_f32_16x16x32_bf16 v[4:7], v[100:103], a[156:159], v[4:7]
    v_perm_b32 v96, v196, v192, s92
    v_perm_b32 v97, v204, v200, s92
    v_mfma_f32_16x16x32_bf16 v[36:39], v[100:103], a[160:163], v[36:39]
    v_perm_b32 v98, v212, v208, s92
    v_perm_b32 v99, v220, v216, s92
    v_mfma_f32_16x16x32_bf16 v[68:71], v[100:103], a[164:167], v[68:71]
    s_add_u32 s62, s62, 1024
    s_and_b32 s62, s62, 0x1ffff
    buffer_load_dwordx4 v243, s[48:51], s62 offen offset:3168 nt lds
    s_add_u32 s62, s62, 1024
    s_and_b32 s62, s62, 0x1ffff
    s_add_u32 s66, s66, 1
    s_add_u32 s67, s67, 33792
    s_cmp_eq_u32 s67, s68
    s_cselect_b32 s3, 135168, 0
    s_sub_u32 s67, s67, s3
    v_mfma_f32_16x16x32_bf16 a[4:7], v[100:103], a[168:171], a[4:7]
    v_mfma_f32_16x16x32_bf16 a[36:39], v[100:103], a[172:175], a[36:39]
    v_mfma_f32_16x16x32_bf16 a[68:71], v[100:103], a[176:179], a[68:71]
    v_mfma_f32_16x16x32_bf16 a[100:103], v[100:103], a[180:183], a[100:103]
    v_mfma_f32_16x16x32_bf16 v[8:11], v[104:107], a[156:159], v[8:11]
    v_perm_b32 v100, v196, v192, s93
    v_perm_b32 v101, v204, v200, s93
    v_mfma_f32_16x16x32_bf16 v[40:43], v[104:107], a[160:163], v[40:43]
    v_perm_b32 v102, v212, v208, s93
    v_perm_b32 v103, v220, v216, s93
    v_mfma_f32_16x16x32_bf16 v[72:75], v[104:107], a[164:167], v[72:75]
    buffer_load_dwordx4 v[128:131], v229, s[36:39], s58 offen
    s_add_u32 s58, s58, 8192
    v_mfma_f32_16x16x32_bf16 a[8:11], v[104:107], a[168:171], a[8:11]
    v_mfma_f32_16x16x32_bf16 a[40:43], v[104:107], a[172:175], a[40:43]
    buffer_load_dwordx4 v[132:135], v229, s[36:39], s58 offen
    s_add_u32 s58, s58, 8192
    v_mfma_f32_16x16x32_bf16 a[72:75], v[104:107], a[176:179], a[72:75]
    v_mfma_f32_16x16x32_bf16 a[104:107], v[104:107], a[180:183], a[104:107]
    v_mfma_f32_16x16x32_bf16 v[12:15], v[108:111], a[156:159], v[12:15]
    v_perm_b32 v104, v197, v193, s92
    v_perm_b32 v105, v205, v201, s92
    v_mfma_f32_16x16x32_bf16 v[44:47], v[108:111], a[160:163], v[44:47]
    v_perm_b32 v106, v213, v209, s92
    v_perm_b32 v107, v221, v217, s92
    v_mfma_f32_16x16x32_bf16 v[76:79], v[108:111], a[164:167], v[76:79]
    buffer_load_dwordx4 v[136:139], v229, s[36:39], s58 offen
    s_add_u32 s58, s58, 8192
    v_mfma_f32_16x16x32_bf16 a[12:15], v[108:111], a[168:171], a[12:15]
    v_mfma_f32_16x16x32_bf16 a[44:47], v[108:111], a[172:175], a[44:47]
    v_mfma_f32_16x16x32_bf16 a[76:79], v[108:111], a[176:179], a[76:79]
    buffer_load_dwordx4 v[140:143], v229, s[36:39], s58 offen
    s_add_u32 s58, s58, 8192
    v_mfma_f32_16x16x32_bf16 a[108:111], v[108:111], a[180:183], a[108:111]
    v_mfma_f32_16x16x32_bf16 v[16:19], v[112:115], a[156:159], v[16:19]
    v_perm_b32 v108, v197, v193, s93
    v_perm_b32 v109, v205, v201, s93
    v_mfma_f32_16x16x32_bf16 v[48:51], v[112:115], a[160:163], v[48:51]
    v_perm_b32 v110, v213, v209, s93
    v_perm_b32 v111, v221, v217, s93
    v_mfma_f32_16x16x32_bf16 v[80:83], v[112:115], a[164:167], v[80:83]
    buffer_load_dwordx4 v[144:147], v229, s[36:39], s58 offen
    s_add_u32 s58, s58, 8192
    v_mfma_f32_16x16x32_bf16 a[16:19], v[112:115], a[168:171], a[16:19]
    v_mfma_f32_16x16x32_bf16 a[48:51], v[112:115], a[172:175], a[48:51]
    v_mfma_f32_16x16x32_bf16 a[80:83], v[112:115], a[176:179], a[80:83]
    s_waitcnt vmcnt(13)
    s_barrier
    v_mfma_f32_16x16x32_bf16 a[112:115], v[112:115], a[180:183], a[112:115]
    buffer_load_dwordx4 v[148:151], v229, s[36:39], s58 offen
    s_add_u32 s58, s58, 8192
    v_mfma_f32_16x16x32_bf16 v[20:23], v[116:119], a[156:159], v[20:23]
    v_perm_b32 v112, v198, v194, s92
    v_perm_b32 v113, v206, v202, s92
    v_mfma_f32_16x16x32_bf16 v[52:55], v[116:119], a[160:163], v[52:55]
    ds_read_b128 a[128:131], v230 offset:14336
    v_perm_b32 v114, v214, v210, s92
    v_perm_b32 v115, v222, v218, s92
    v_mfma_f32_16x16x32_bf16 v[84:87], v[116:119], a[164:167], v[84:87]
    v_mfma_f32_16x16x32_bf16 a[20:23], v[116:119], a[168:171], a[20:23]
    ds_read_b128 a[132:135], v230 offset:16384
    buffer_load_dwordx4 v[152:155], v229, s[36:39], s58 offen
    s_add_u32 s58, s58, 8192
    v_mfma_f32_16x16x32_bf16 a[52:55], v[116:119], a[172:175], a[52:55]
    v_mfma_f32_16x16x32_bf16 a[84:87], v[116:119], a[176:179], a[84:87]
    ds_read_b128 a[136:139], v230 offset:18432
    v_mfma_f32_16x16x32_bf16 a[116:119], v[116:119], a[180:183], a[116:119]
    v_mfma_f32_16x16x32_bf16 v[24:27], v[120:123], a[156:159], v[24:27]
    ds_read_b128 a[140:143], v230 offset:20480
    v_perm_b32 v116, v198, v194, s93
    v_perm_b32 v117, v206, v202, s93
    v_mfma_f32_16x16x32_bf16 v[56:59], v[120:123], a[160:163], v[56:59]
    v_perm_b32 v118, v214, v210, s93
    v_perm_b32 v119, v222, v218, s93
    v_mfma_f32_16x16x32_bf16 v[88:91], v[120:123], a[164:167], v[88:91]
    ds_read_b128 a[144:147], v230 offset:22528
    buffer_load_dwordx4 v[156:159], v229, s[36:39], s58 offen
    s_add_u32 s58, s58, 204800
    s_cmp_ge_u32 s58, 4718592
    s_cselect_b32 s58, 0, s58
    v_mfma_f32_16x16x32_bf16 a[24:27], v[120:123], a[168:171], a[24:27]
    v_mfma_f32_16x16x32_bf16 a[56:59], v[120:123], a[172:175], a[56:59]
    ds_read_b128 a[148:151], v230 offset:24576
    buffer_load_dwordx4 v[160:163], v229, s[36:39], s58 offen
    s_add_u32 s58, s58, 8192
    v_mfma_f32_16x16x32_bf16 a[88:91], v[120:123], a[176:179], a[88:91]
    v_mfma_f32_16x16x32_bf16 a[120:123], v[120:123], a[180:183], a[120:123]
    ds_read_b128 a[152:155], v230 offset:26624
    v_mfma_f32_16x16x32_bf16 v[28:31], v[124:127], a[156:159], v[28:31]
    v_perm_b32 v120, v199, v195, s92
    v_perm_b32 v121, v207, v203, s92
    v_mfma_f32_16x16x32_bf16 v[60:63], v[124:127], a[160:163], v[60:63]
    v_perm_b32 v122, v215, v211, s92
    v_perm_b32 v123, v223, v219, s92
    v_mfma_f32_16x16x32_bf16 v[92:95], v[124:127], a[164:167], v[92:95]
    buffer_load_dwordx4 v[164:167], v229, s[36:39], s58 offen
    s_add_u32 s58, s58, 8192
    v_mfma_f32_16x16x32_bf16 a[28:31], v[124:127], a[168:171], a[28:31]
    v_mfma_f32_16x16x32_bf16 a[60:63], v[124:127], a[172:175], a[60:63]
    v_mfma_f32_16x16x32_bf16 a[92:95], v[124:127], a[176:179], a[92:95]
    buffer_load_dwordx4 v[168:171], v229, s[36:39], s58 offen
    s_add_u32 s58, s58, 8192
    v_mfma_f32_16x16x32_bf16 a[124:127], v[124:127], a[180:183], a[124:127]
    s_waitcnt lgkmcnt(0)
    v_mfma_f32_16x16x32_bf16 v[0:3], v[96:99], a[128:131], v[0:3]
    v_perm_b32 v124, v199, v195, s93
    v_perm_b32 v125, v207, v203, s93
    v_mfma_f32_16x16x32_bf16 v[32:35], v[96:99], a[132:135], v[32:35]
    v_perm_b32 v126, v215, v211, s93
    v_perm_b32 v127, v223, v219, s93
    v_mfma_f32_16x16x32_bf16 v[64:67], v[96:99], a[136:139], v[64:67]
    buffer_load_dwordx4 v[172:175], v229, s[36:39], s58 offen
    s_add_u32 s58, s58, 8192
    v_mfma_f32_16x16x32_bf16 a[0:3], v[96:99], a[140:143], a[0:3]
    v_mfma_f32_16x16x32_bf16 a[32:35], v[96:99], a[144:147], a[32:35]
    v_mfma_f32_16x16x32_bf16 a[64:67], v[96:99], a[148:151], a[64:67]
    v_mfma_f32_16x16x32_bf16 a[96:99], v[96:99], a[152:155], a[96:99]
    s_waitcnt vmcnt(4)
    buffer_load_dwordx4 v[176:179], v229, s[36:39], s58 offen
    s_add_u32 s58, s58, 8192
    v_mfma_f32_16x16x32_bf16 v[4:7], v[100:103], a[128:131], v[4:7]
    v_perm_b32 v96, v132, v128, s92
    v_perm_b32 v97, v140, v136, s92
    v_mfma_f32_16x16x32_bf16 v[36:39], v[100:103], a[132:135], v[36:39]
    v_perm_b32 v98, v148, v144, s92
    v_perm_b32 v99, v156, v152, s92
    v_mfma_f32_16x16x32_bf16 v[68:71], v[100:103], a[136:139], v[68:71]
    v_mfma_f32_16x16x32_bf16 a[4:7], v[100:103], a[140:143], a[4:7]
    buffer_load_dwordx4 v[180:183], v229, s[36:39], s58 offen
    s_add_u32 s58, s58, 8192
    v_mfma_f32_16x16x32_bf16 a[36:39], v[100:103], a[144:147], a[36:39]
    v_mfma_f32_16x16x32_bf16 a[68:71], v[100:103], a[148:151], a[68:71]
    v_mfma_f32_16x16x32_bf16 a[100:103], v[100:103], a[152:155], a[100:103]
    v_mfma_f32_16x16x32_bf16 v[8:11], v[104:107], a[128:131], v[8:11]
    v_perm_b32 v100, v132, v128, s93
    v_perm_b32 v101, v140, v136, s93
    v_mfma_f32_16x16x32_bf16 v[40:43], v[104:107], a[132:135], v[40:43]
    v_perm_b32 v102, v148, v144, s93
    v_perm_b32 v103, v156, v152, s93
    v_mfma_f32_16x16x32_bf16 v[72:75], v[104:107], a[136:139], v[72:75]
    buffer_load_dwordx4 v[184:187], v229, s[36:39], s58 offen
    s_add_u32 s58, s58, 8192
    v_mfma_f32_16x16x32_bf16 a[8:11], v[104:107], a[140:143], a[8:11]
    v_mfma_f32_16x16x32_bf16 a[40:43], v[104:107], a[144:147], a[40:43]
    buffer_load_dwordx4 v[188:191], v229, s[36:39], s58 offen
    s_add_u32 s58, s58, 204800
    s_cmp_ge_u32 s58, 4718592
    s_cselect_b32 s58, 0, s58
    v_mfma_f32_16x16x32_bf16 a[72:75], v[104:107], a[148:151], a[72:75]
    v_mfma_f32_16x16x32_bf16 a[104:107], v[104:107], a[152:155], a[104:107]
    v_mfma_f32_16x16x32_bf16 v[12:15], v[108:111], a[128:131], v[12:15]
    v_perm_b32 v104, v133, v129, s92
    v_perm_b32 v105, v141, v137, s92
    v_mfma_f32_16x16x32_bf16 v[44:47], v[108:111], a[132:135], v[44:47]
    v_perm_b32 v106, v149, v145, s92
    v_perm_b32 v107, v157, v153, s92
    v_mfma_f32_16x16x32_bf16 v[76:79], v[108:111], a[136:139], v[76:79]
    s_add_u32 m0, s57, 0
    s_mov_b32 s61, s59
    buffer_load_dwordx4 v236, s[40:43], s61 offen offset:0 lds
    v_mfma_f32_16x16x32_bf16 a[12:15], v[108:111], a[140:143], a[12:15]
    v_mfma_f32_16x16x32_bf16 a[44:47], v[108:111], a[144:147], a[44:47]
    v_mfma_f32_16x16x32_bf16 a[76:79], v[108:111], a[148:151], a[76:79]
    buffer_load_dwordx4 v237, s[40:43], s61 offen offset:1024 lds
    v_mfma_f32_16x16x32_bf16 a[108:111], v[108:111], a[152:155], a[108:111]
    v_mfma_f32_16x16x32_bf16 v[16:19], v[112:115], a[128:131], v[16:19]
    v_perm_b32 v108, v133, v129, s93
    v_perm_b32 v109, v141, v137, s93
    v_mfma_f32_16x16x32_bf16 v[48:51], v[112:115], a[132:135], v[48:51]
    v_perm_b32 v110, v149, v145, s93
    v_perm_b32 v111, v157, v153, s93
    v_mfma_f32_16x16x32_bf16 v[80:83], v[112:115], a[136:139], v[80:83]
    buffer_load_dwordx4 v238, s[40:43], s61 offen offset:2048 lds
    v_mfma_f32_16x16x32_bf16 a[16:19], v[112:115], a[140:143], a[16:19]
    v_mfma_f32_16x16x32_bf16 a[48:51], v[112:115], a[144:147], a[48:51]
    v_mfma_f32_16x16x32_bf16 a[80:83], v[112:115], a[148:151], a[80:83]
    v_mfma_f32_16x16x32_bf16 a[112:115], v[112:115], a[152:155], a[112:115]
    buffer_load_dwordx4 v239, s[40:43], s61 offen offset:3072 lds
    s_add_u32 s59, s59, 128
    s_cmp_ge_u32 s59, 1152
    s_cselect_b32 s59, 0, s59
    v_mfma_f32_16x16x32_bf16 v[20:23], v[116:119], a[128:131], v[20:23]
    v_perm_b32 v112, v134, v130, s92
    v_perm_b32 v113, v142, v138, s92
    v_mfma_f32_16x16x32_bf16 v[52:55], v[116:119], a[132:135], v[52:55]
    ds_read_b128 a[156:159], v232 offset:14336
    v_perm_b32 v114, v150, v146, s92
    v_perm_b32 v115, v158, v154, s92
    v_mfma_f32_16x16x32_bf16 v[84:87], v[116:119], a[136:139], v[84:87]
    v_mfma_f32_16x16x32_bf16 a[20:23], v[116:119], a[140:143], a[20:23]
    ds_read_b128 a[160:163], v232 offset:16384
    buffer_load_dwordx4 v[192:195], v229, s[36:39], s58 offen
    s_add_u32 s58, s58, 8192
    v_mfma_f32_16x16x32_bf16 a[52:55], v[116:119], a[144:147], a[52:55]
    v_mfma_f32_16x16x32_bf16 a[84:87], v[116:119], a[148:151], a[84:87]
    ds_read_b128 a[164:167], v232 offset:18432
    v_mfma_f32_16x16x32_bf16 a[116:119], v[116:119], a[152:155], a[116:119]
    v_mfma_f32_16x16x32_bf16 v[24:27], v[120:123], a[128:131], v[24:27]
    ds_read_b128 a[168:171], v232 offset:20480
    v_perm_b32 v116, v134, v130, s93
    v_perm_b32 v117, v142, v138, s93
    v_mfma_f32_16x16x32_bf16 v[56:59], v[120:123], a[132:135], v[56:59]
    v_perm_b32 v118, v150, v146, s93
    v_perm_b32 v119, v158, v154, s93
    v_mfma_f32_16x16x32_bf16 v[88:91], v[120:123], a[136:139], v[88:91]
    ds_read_b128 a[172:175], v232 offset:22528
    buffer_load_dwordx4 v[196:199], v229, s[36:39], s58 offen
    s_add_u32 s58, s58, 8192
    v_mfma_f32_16x16x32_bf16 a[24:27], v[120:123], a[140:143], a[24:27]
    v_mfma_f32_16x16x32_bf16 a[56:59], v[120:123], a[144:147], a[56:59]
    ds_read_b128 a[176:179], v232 offset:24576
    buffer_load_dwordx4 v[200:203], v229, s[36:39], s58 offen
    s_add_u32 s58, s58, 8192
    v_mfma_f32_16x16x32_bf16 a[88:91], v[120:123], a[148:151], a[88:91]
    v_mfma_f32_16x16x32_bf16 a[120:123], v[120:123], a[152:155], a[120:123]
    ds_read_b128 a[180:183], v232 offset:26624
    v_mfma_f32_16x16x32_bf16 v[28:31], v[124:127], a[128:131], v[28:31]
    v_perm_b32 v120, v135, v131, s92
    v_perm_b32 v121, v143, v139, s92
    v_mfma_f32_16x16x32_bf16 v[60:63], v[124:127], a[132:135], v[60:63]
    v_perm_b32 v122, v151, v147, s92
    v_perm_b32 v123, v159, v155, s92
    v_mfma_f32_16x16x32_bf16 v[92:95], v[124:127], a[136:139], v[92:95]
    buffer_load_dwordx4 v[204:207], v229, s[36:39], s58 offen
    s_add_u32 s58, s58, 8192
    v_mfma_f32_16x16x32_bf16 a[28:31], v[124:127], a[140:143], a[28:31]
    v_mfma_f32_16x16x32_bf16 a[60:63], v[124:127], a[144:147], a[60:63]
    v_mfma_f32_16x16x32_bf16 a[92:95], v[124:127], a[148:151], a[92:95]
    buffer_load_dwordx4 v[208:211], v229, s[36:39], s58 offen
    s_add_u32 s58, s58, 8192
    v_mfma_f32_16x16x32_bf16 a[124:127], v[124:127], a[152:155], a[124:127]
    s_waitcnt lgkmcnt(0)
    v_mfma_f32_16x16x32_bf16 v[0:3], v[96:99], a[156:159], v[0:3]
    v_perm_b32 v124, v135, v131, s93
    v_perm_b32 v125, v143, v139, s93
    v_mfma_f32_16x16x32_bf16 v[32:35], v[96:99], a[160:163], v[32:35]
    v_perm_b32 v126, v151, v147, s93
    v_perm_b32 v127, v159, v155, s93
    v_mfma_f32_16x16x32_bf16 v[64:67], v[96:99], a[164:167], v[64:67]
    buffer_load_dwordx4 v[212:215], v229, s[36:39], s58 offen
    s_add_u32 s58, s58, 8192
    v_mfma_f32_16x16x32_bf16 a[0:3], v[96:99], a[168:171], a[0:3]
    v_mfma_f32_16x16x32_bf16 a[32:35], v[96:99], a[172:175], a[32:35]
    v_mfma_f32_16x16x32_bf16 a[64:67], v[96:99], a[176:179], a[64:67]
    v_mfma_f32_16x16x32_bf16 a[96:99], v[96:99], a[180:183], a[96:99]
    s_waitcnt vmcnt(10)
    buffer_load_dwordx4 v[216:219], v229, s[36:39], s58 offen
    s_add_u32 s58, s58, 8192
    v_mfma_f32_16x16x32_bf16 v[4:7], v[100:103], a[156:159], v[4:7]
    v_perm_b32 v96, v164, v160, s92
    v_perm_b32 v97, v172, v168, s92
    v_mfma_f32_16x16x32_bf16 v[36:39], v[100:103], a[160:163], v[36:39]
    v_perm_b32 v98, v180, v176, s92
    v_perm_b32 v99, v188, v184, s92
    v_mfma_f32_16x16x32_bf16 v[68:71], v[100:103], a[164:167], v[68:71]
    v_mfma_f32_16x16x32_bf16 a[4:7], v[100:103], a[168:171], a[4:7]
    buffer_load_dwordx4 v[220:223], v229, s[36:39], s58 offen
    s_add_u32 s58, s58, 204800
    s_cmp_ge_u32 s58, 4718592
    s_cselect_b32 s58, 0, s58
    v_mfma_f32_16x16x32_bf16 a[36:39], v[100:103], a[172:175], a[36:39]
    v_mfma_f32_16x16x32_bf16 a[68:71], v[100:103], a[176:179], a[68:71]
    v_mfma_f32_16x16x32_bf16 a[100:103], v[100:103], a[180:183], a[100:103]
    v_mfma_f32_16x16x32_bf16 v[8:11], v[104:107], a[156:159], v[8:11]
    v_perm_b32 v100, v164, v160, s93
    v_perm_b32 v101, v172, v168, s93
    v_mfma_f32_16x16x32_bf16 v[40:43], v[104:107], a[160:163], v[40:43]
    v_perm_b32 v102, v180, v176, s93
    v_perm_b32 v103, v188, v184, s93
    v_mfma_f32_16x16x32_bf16 v[72:75], v[104:107], a[164:167], v[72:75]
    s_mov_b32 m0, s67
    s_cmp_lt_u32 s66, 16
    s_cselect_b32 s50, 135168, 0
    buffer_load_dwordx4 v240, s[48:51], s62 offen offset:0 nt lds
    v_mfma_f32_16x16x32_bf16 a[8:11], v[104:107], a[168:171], a[8:11]
    v_mfma_f32_16x16x32_bf16 a[40:43], v[104:107], a[172:175], a[40:43]
    v_mfma_f32_16x16x32_bf16 a[72:75], v[104:107], a[176:179], a[72:75]
    v_mfma_f32_16x16x32_bf16 a[104:107], v[104:107], a[180:183], a[104:107]
    v_mfma_f32_16x16x32_bf16 v[12:15], v[108:111], a[156:159], v[12:15]
    v_perm_b32 v104, v165, v161, s92
    v_perm_b32 v105, v173, v169, s92
    v_mfma_f32_16x16x32_bf16 v[44:47], v[108:111], a[160:163], v[44:47]
    v_perm_b32 v106, v181, v177, s92
    v_perm_b32 v107, v189, v185, s92
    v_mfma_f32_16x16x32_bf16 v[76:79], v[108:111], a[164:167], v[76:79]
    v_mfma_f32_16x16x32_bf16 a[12:15], v[108:111], a[168:171], a[12:15]
    v_mfma_f32_16x16x32_bf16 a[44:47], v[108:111], a[172:175], a[44:47]
    s_add_u32 s62, s62, 1024
    s_and_b32 s62, s62, 0x1ffff
    buffer_load_dwordx4 v241, s[48:51], s62 offen offset:1056 nt lds
    v_mfma_f32_16x16x32_bf16 a[76:79], v[108:111], a[176:179], a[76:79]
    v_mfma_f32_16x16x32_bf16 a[108:111], v[108:111], a[180:183], a[108:111]
    v_mfma_f32_16x16x32_bf16 v[16:19], v[112:115], a[156:159], v[16:19]
    v_perm_b32 v108, v165, v161, s93
    v_perm_b32 v109, v173, v169, s93
    v_mfma_f32_16x16x32_bf16 v[48:51], v[112:115], a[160:163], v[48:51]
    v_perm_b32 v110, v181, v177, s93
    v_perm_b32 v111, v189, v185, s93
    v_mfma_f32_16x16x32_bf16 v[80:83], v[112:115], a[164:167], v[80:83]
    v_mfma_f32_16x16x32_bf16 a[16:19], v[112:115], a[168:171], a[16:19]
    v_mfma_f32_16x16x32_bf16 a[48:51], v[112:115], a[172:175], a[48:51]
    v_mfma_f32_16x16x32_bf16 a[80:83], v[112:115], a[176:179], a[80:83]
    s_waitcnt vmcnt(10)
    s_barrier
    v_mfma_f32_16x16x32_bf16 a[112:115], v[112:115], a[180:183], a[112:115]
    v_mfma_f32_16x16x32_bf16 v[20:23], v[116:119], a[156:159], v[20:23]
    v_perm_b32 v112, v166, v162, s92
    v_perm_b32 v113, v174, v170, s92
    v_mfma_f32_16x16x32_bf16 v[52:55], v[116:119], a[160:163], v[52:55]
    ds_read_b128 a[128:131], v230 offset:0
    v_perm_b32 v114, v182, v178, s92
    v_perm_b32 v115, v190, v186, s92
    v_mfma_f32_16x16x32_bf16 v[84:87], v[116:119], a[164:167], v[84:87]
    s_add_u32 s62, s62, 1024
    s_and_b32 s62, s62, 0x1ffff
    buffer_load_dwordx4 v242, s[48:51], s62 offen offset:2112 nt lds
    v_mfma_f32_16x16x32_bf16 a[20:23], v[116:119], a[168:171], a[20:23]
    ds_read_b128 a[132:135], v230 offset:2048
    v_mfma_f32_16x16x32_bf16 a[52:55], v[116:119], a[172:175], a[52:55]
    v_mfma_f32_16x16x32_bf16 a[84:87], v[116:119], a[176:179], a[84:87]
    ds_read_b128 a[136:139], v230 offset:4096
    v_mfma_f32_16x16x32_bf16 a[116:119], v[116:119], a[180:183], a[116:119]
    v_mfma_f32_16x16x32_bf16 v[24:27], v[120:123], a[156:159], v[24:27]
    ds_read_b128 a[140:143], v230 offset:6144
    v_perm_b32 v116, v166, v162, s93
    v_perm_b32 v117, v174, v170, s93
    v_mfma_f32_16x16x32_bf16 v[56:59], v[120:123], a[160:163], v[56:59]
    v_perm_b32 v118, v182, v178, s93
    v_perm_b32 v119, v190, v186, s93
    v_mfma_f32_16x16x32_bf16 v[88:91], v[120:123], a[164:167], v[88:91]
    ds_read_b128 a[144:147], v230 offset:8192
    v_mfma_f32_16x16x32_bf16 a[24:27], v[120:123], a[168:171], a[24:27]
    s_add_u32 s62, s62, 1024
    s_and_b32 s62, s62, 0x1ffff
    buffer_load_dwordx4 v243, s[48:51], s62 offen offset:3168 nt lds
    v_mfma_f32_16x16x32_bf16 a[56:59], v[120:123], a[172:175], a[56:59]
    ds_read_b128 a[148:151], v230 offset:10240
    v_mfma_f32_16x16x32_bf16 a[88:91], v[120:123], a[176:179], a[88:91]
    v_mfma_f32_16x16x32_bf16 a[120:123], v[120:123], a[180:183], a[120:123]
    ds_read_b128 a[152:155], v230 offset:12288
    v_mfma_f32_16x16x32_bf16 v[28:31], v[124:127], a[156:159], v[28:31]
    v_perm_b32 v120, v167, v163, s92
    v_perm_b32 v121, v175, v171, s92
    v_mfma_f32_16x16x32_bf16 v[60:63], v[124:127], a[160:163], v[60:63]
    v_perm_b32 v122, v183, v179, s92
    v_perm_b32 v123, v191, v187, s92
    v_mfma_f32_16x16x32_bf16 v[92:95], v[124:127], a[164:167], v[92:95]
    v_mfma_f32_16x16x32_bf16 a[28:31], v[124:127], a[168:171], a[28:31]
    v_mfma_f32_16x16x32_bf16 a[60:63], v[124:127], a[172:175], a[60:63]
    v_mfma_f32_16x16x32_bf16 a[92:95], v[124:127], a[176:179], a[92:95]
    v_mfma_f32_16x16x32_bf16 a[124:127], v[124:127], a[180:183], a[124:127]
    s_waitcnt lgkmcnt(0)
    s_add_u32 s62, s62, 1024
    s_and_b32 s62, s62, 0x1ffff
    s_add_u32 m0, s67, 4224
    s_nop 0
    buffer_load_dwordx4 v240, s[48:51], s62 offen offset:0 nt lds
    v_mfma_f32_16x16x32_bf16 v[0:3], v[96:99], a[128:131], v[0:3]
    v_perm_b32 v124, v167, v163, s93
    v_perm_b32 v125, v175, v171, s93
    v_mfma_f32_16x16x32_bf16 v[32:35], v[96:99], a[132:135], v[32:35]
    v_perm_b32 v126, v183, v179, s93
    v_perm_b32 v127, v191, v187, s93
    v_mfma_f32_16x16x32_bf16 v[64:67], v[96:99], a[136:139], v[64:67]
    v_mfma_f32_16x16x32_bf16 a[0:3], v[96:99], a[140:143], a[0:3]
    v_mfma_f32_16x16x32_bf16 a[32:35], v[96:99], a[144:147], a[32:35]
    v_mfma_f32_16x16x32_bf16 a[64:67], v[96:99], a[148:151], a[64:67]
    v_mfma_f32_16x16x32_bf16 a[96:99], v[96:99], a[152:155], a[96:99]
    s_waitcnt vmcnt(5)
    v_mfma_f32_16x16x32_bf16 v[4:7], v[100:103], a[128:131], v[4:7]
    v_perm_b32 v96, v196, v192, s92
    v_perm_b32 v97, v204, v200, s92
    v_mfma_f32_16x16x32_bf16 v[36:39], v[100:103], a[132:135], v[36:39]
    v_perm_b32 v98, v212, v208, s92
    v_perm_b32 v99, v220, v216, s92
    v_mfma_f32_16x16x32_bf16 v[68:71], v[100:103], a[136:139], v[68:71]
    s_add_u32 s62, s62, 1024
    s_and_b32 s62, s62, 0x1ffff
    buffer_load_dwordx4 v241, s[48:51], s62 offen offset:1056 nt lds
    v_mfma_f32_16x16x32_bf16 a[4:7], v[100:103], a[140:143], a[4:7]
    v_mfma_f32_16x16x32_bf16 a[36:39], v[100:103], a[144:147], a[36:39]
    v_mfma_f32_16x16x32_bf16 a[68:71], v[100:103], a[148:151], a[68:71]
    v_mfma_f32_16x16x32_bf16 a[100:103], v[100:103], a[152:155], a[100:103]
    v_mfma_f32_16x16x32_bf16 v[8:11], v[104:107], a[128:131], v[8:11]
    v_perm_b32 v100, v196, v192, s93
    v_perm_b32 v101, v204, v200, s93
    v_mfma_f32_16x16x32_bf16 v[40:43], v[104:107], a[132:135], v[40:43]
    v_perm_b32 v102, v212, v208, s93
    v_perm_b32 v103, v220, v216, s93
    v_mfma_f32_16x16x32_bf16 v[72:75], v[104:107], a[136:139], v[72:75]
    v_mfma_f32_16x16x32_bf16 a[8:11], v[104:107], a[140:143], a[8:11]
    v_mfma_f32_16x16x32_bf16 a[40:43], v[104:107], a[144:147], a[40:43]
    v_mfma_f32_16x16x32_bf16 a[72:75], v[104:107], a[148:151], a[72:75]
    s_add_u32 s62, s62, 1024
    s_and_b32 s62, s62, 0x1ffff
    buffer_load_dwordx4 v242, s[48:51], s62 offen offset:2112 nt lds
    v_mfma_f32_16x16x32_bf16 a[104:107], v[104:107], a[152:155], a[104:107]
    v_mfma_f32_16x16x32_bf16 v[12:15], v[108:111], a[128:131], v[12:15]
    v_perm_b32 v104, v197, v193, s92
    v_perm_b32 v105, v205, v201, s92
    v_mfma_f32_16x16x32_bf16 v[44:47], v[108:111], a[132:135], v[44:47]
    v_perm_b32 v106, v213, v209, s92
    v_perm_b32 v107, v221, v217, s92
    v_mfma_f32_16x16x32_bf16 v[76:79], v[108:111], a[136:139], v[76:79]
    v_mfma_f32_16x16x32_bf16 a[12:15], v[108:111], a[140:143], a[12:15]
    v_mfma_f32_16x16x32_bf16 a[44:47], v[108:111], a[144:147], a[44:47]
    v_mfma_f32_16x16x32_bf16 a[76:79], v[108:111], a[148:151], a[76:79]
    v_mfma_f32_16x16x32_bf16 a[108:111], v[108:111], a[152:155], a[108:111]
    v_mfma_f32_16x16x32_bf16 v[16:19], v[112:115], a[128:131], v[16:19]
    v_perm_b32 v108, v197, v193, s93
    v_perm_b32 v109, v205, v201, s93
    v_mfma_f32_16x16x32_bf16 v[48:51], v[112:115], a[132:135], v[48:51]
    v_perm_b32 v110, v213, v209, s93
    v_perm_b32 v111, v221, v217, s93
    v_mfma_f32_16x16x32_bf16 v[80:83], v[112:115], a[136:139], v[80:83]
    s_add_u32 s62, s62, 1024
    s_and_b32 s62, s62, 0x1ffff
    buffer_load_dwordx4 v243, s[48:51], s62 offen offset:3168 nt lds
    s_add_u32 s62, s62, 1024
    s_and_b32 s62, s62, 0x1ffff
    s_add_u32 s66, s66, 1
    s_add_u32 s67, s67, 33792
    s_cmp_eq_u32 s67, s68
    s_cselect_b32 s3, 135168, 0
    s_sub_u32 s67, s67, s3
    v_mfma_f32_16x16x32_bf16 a[16:19], v[112:115], a[140:143], a[16:19]
    v_mfma_f32_16x16x32_bf16 a[48:51], v[112:115], a[144:147], a[48:51]
    v_mfma_f32_16x16x32_bf16 a[80:83], v[112:115], a[148:151], a[80:83]
    v_mfma_f32_16x16x32_bf16 a[112:115], v[112:115], a[152:155], a[112:115]
    s_mov_b32 m0, s67
    s_cmp_lt_u32 s66, 16
    s_cselect_b32 s50, 135168, 0
    buffer_load_dwordx4 v240, s[48:51], s62 offen offset:0 nt lds
    v_mfma_f32_16x16x32_bf16 v[20:23], v[116:119], a[128:131], v[20:23]
    v_perm_b32 v112, v198, v194, s92
    v_perm_b32 v113, v206, v202, s92
    v_mfma_f32_16x16x32_bf16 v[52:55], v[116:119], a[132:135], v[52:55]
    ds_read_b128 a[156:159], v232 offset:0
    v_perm_b32 v114, v214, v210, s92
    v_perm_b32 v115, v222, v218, s92
    v_mfma_f32_16x16x32_bf16 v[84:87], v[116:119], a[136:139], v[84:87]
    v_mfma_f32_16x16x32_bf16 a[20:23], v[116:119], a[140:143], a[20:23]
    ds_read_b128 a[160:163], v232 offset:2048
    v_mfma_f32_16x16x32_bf16 a[52:55], v[116:119], a[144:147], a[52:55]
    v_mfma_f32_16x16x32_bf16 a[84:87], v[116:119], a[148:151], a[84:87]
    ds_read_b128 a[164:167], v232 offset:4096
    v_mfma_f32_16x16x32_bf16 a[116:119], v[116:119], a[152:155], a[116:119]
    v_mfma_f32_16x16x32_bf16 v[24:27], v[120:123], a[128:131], v[24:27]
    ds_read_b128 a[168:171], v232 offset:6144
    v_perm_b32 v116, v198, v194, s93
    v_perm_b32 v117, v206, v202, s93
    v_mfma_f32_16x16x32_bf16 v[56:59], v[120:123], a[132:135], v[56:59]
    v_perm_b32 v118, v214, v210, s93
    v_perm_b32 v119, v222, v218, s93
    v_mfma_f32_16x16x32_bf16 v[88:91], v[120:123], a[136:139], v[88:91]
    ds_read_b128 a[172:175], v232 offset:8192
    s_add_u32 s62, s62, 1024
    s_and_b32 s62, s62, 0x1ffff
    buffer_load_dwordx4 v241, s[48:51], s62 offen offset:1056 nt lds
    v_mfma_f32_16x16x32_bf16 a[24:27], v[120:123], a[140:143], a[24:27]
    v_mfma_f32_16x16x32_bf16 a[56:59], v[120:123], a[144:147], a[56:59]
    ds_read_b128 a[176:179], v232 offset:10240
    v_mfma_f32_16x16x32_bf16 a[88:91], v[120:123], a[148:151], a[88:91]
    v_mfma_f32_16x16x32_bf16 a[120:123], v[120:123], a[152:155], a[120:123]
    ds_read_b128 a[180:183], v232 offset:12288
    v_mfma_f32_16x16x32_bf16 v[28:31], v[124:127], a[128:131], v[28:31]
    v_perm_b32 v120, v199, v195, s92
    v_perm_b32 v121, v207, v203, s92
    v_mfma_f32_16x16x32_bf16 v[60:63], v[124:127], a[132:135], v[60:63]
    v_perm_b32 v122, v215, v211, s92
    v_perm_b32 v123, v223, v219, s92
    v_mfma_f32_16x16x32_bf16 v[92:95], v[124:127], a[136:139], v[92:95]
    v_mfma_f32_16x16x32_bf16 a[28:31], v[124:127], a[140:143], a[28:31]
    v_mfma_f32_16x16x32_bf16 a[60:63], v[124:127], a[144:147], a[60:63]
    v_mfma_f32_16x16x32_bf16 a[92:95], v[124:127], a[148:151], a[92:95]
    s_add_u32 s62, s62, 1024
    s_and_b32 s62, s62, 0x1ffff
    buffer_load_dwordx4 v242, s[48:51], s62 offen offset:2112 nt lds
    v_mfma_f32_16x16x32_bf16 a[124:127], v[124:127], a[152:155], a[124:127]
    s_waitcnt lgkmcnt(0)
    v_mfma_f32_16x16x32_bf16 v[0:3], v[96:99], a[156:159], v[0:3]
    v_perm_b32 v124, v199, v195, s93
    v_perm_b32 v125, v207, v203, s93
    v_mfma_f32_16x16x32_bf16 v[32:35], v[96:99], a[160:163], v[32:35]
    v_perm_b32 v126, v215, v211, s93
    v_perm_b32 v127, v223, v219, s93
    v_mfma_f32_16x16x32_bf16 v[64:67], v[96:99], a[164:167], v[64:67]
    v_mfma_f32_16x16x32_bf16 a[0:3], v[96:99], a[168:171], a[0:3]
    v_mfma_f32_16x16x32_bf16 a[32:35], v[96:99], a[172:175], a[32:35]
    v_mfma_f32_16x16x32_bf16 a[64:67], v[96:99], a[176:179], a[64:67]
    v_mfma_f32_16x16x32_bf16 a[96:99], v[96:99], a[180:183], a[96:99]
    v_mfma_f32_16x16x32_bf16 v[4:7], v[100:103], a[156:159], v[4:7]
    v_mfma_f32_16x16x32_bf16 v[36:39], v[100:103], a[160:163], v[36:39]
    s_add_u32 s62, s62, 1024
    s_and_b32 s62, s62, 0x1ffff
    buffer_load_dwordx4 v243, s[48:51], s62 offen offset:3168 nt lds
    v_mfma_f32_16x16x32_bf16 v[68:71], v[100:103], a[164:167], v[68:71]
    v_mfma_f32_16x16x32_bf16 a[4:7], v[100:103], a[168:171], a[4:7]
    v_mfma_f32_16x16x32_bf16 a[36:39], v[100:103], a[172:175], a[36:39]
    v_mfma_f32_16x16x32_bf16 a[68:71], v[100:103], a[176:179], a[68:71]
    v_mfma_f32_16x16x32_bf16 a[100:103], v[100:103], a[180:183], a[100:103]
    v_mfma_f32_16x16x32_bf16 v[8:11], v[104:107], a[156:159], v[8:11]
    v_mfma_f32_16x16x32_bf16 v[40:43], v[104:107], a[160:163], v[40:43]
    v_mfma_f32_16x16x32_bf16 v[72:75], v[104:107], a[164:167], v[72:75]
    v_mfma_f32_16x16x32_bf16 a[8:11], v[104:107], a[168:171], a[8:11]
    v_mfma_f32_16x16x32_bf16 a[40:43], v[104:107], a[172:175], a[40:43]
    s_add_u32 s62, s62, 1024
    s_and_b32 s62, s62, 0x1ffff
    s_add_u32 m0, s67, 4224
    s_nop 0
    buffer_load_dwordx4 v240, s[48:51], s62 offen offset:0 nt lds
    v_mfma_f32_16x16x32_bf16 a[72:75], v[104:107], a[176:179], a[72:75]
    v_mfma_f32_16x16x32_bf16 a[104:107], v[104:107], a[180:183], a[104:107]
    v_mfma_f32_16x16x32_bf16 v[12:15], v[108:111], a[156:159], v[12:15]
    v_mfma_f32_16x16x32_bf16 v[44:47], v[108:111], a[160:163], v[44:47]
    v_mfma_f32_16x16x32_bf16 v[76:79], v[108:111], a[164:167], v[76:79]
    v_mfma_f32_16x16x32_bf16 a[12:15], v[108:111], a[168:171], a[12:15]
    v_mfma_f32_16x16x32_bf16 a[44:47], v[108:111], a[172:175], a[44:47]
    v_mfma_f32_16x16x32_bf16 a[76:79], v[108:111], a[176:179], a[76:79]
    v_mfma_f32_16x16x32_bf16 a[108:111], v[108:111], a[180:183], a[108:111]
    v_mfma_f32_16x16x32_bf16 v[16:19], v[112:115], a[156:159], v[16:19]
    s_add_u32 s62, s62, 1024
    s_and_b32 s62, s62, 0x1ffff
    buffer_load_dwordx4 v241, s[48:51], s62 offen offset:1056 nt lds
    v_mfma_f32_16x16x32_bf16 v[48:51], v[112:115], a[160:163], v[48:51]
    v_mfma_f32_16x16x32_bf16 v[80:83], v[112:115], a[164:167], v[80:83]
    v_mfma_f32_16x16x32_bf16 a[16:19], v[112:115], a[168:171], a[16:19]
    v_mfma_f32_16x16x32_bf16 a[48:51], v[112:115], a[172:175], a[48:51]
    v_mfma_f32_16x16x32_bf16 a[80:83], v[112:115], a[176:179], a[80:83]
    v_mfma_f32_16x16x32_bf16 a[112:115], v[112:115], a[180:183], a[112:115]
    v_mfma_f32_16x16x32_bf16 v[20:23], v[116:119], a[156:159], v[20:23]
    v_mfma_f32_16x16x32_bf16 v[52:55], v[116:119], a[160:163], v[52:55]
    v_mfma_f32_16x16x32_bf16 v[84:87], v[116:119], a[164:167], v[84:87]
    v_mfma_f32_16x16x32_bf16 a[20:23], v[116:119], a[168:171], a[20:23]
    s_add_u32 s62, s62, 1024
    s_and_b32 s62, s62, 0x1ffff
    buffer_load_dwordx4 v242, s[48:51], s62 offen offset:2112 nt lds
    v_mfma_f32_16x16x32_bf16 a[52:55], v[116:119], a[172:175], a[52:55]
    v_mfma_f32_16x16x32_bf16 a[84:87], v[116:119], a[176:179], a[84:87]
    v_mfma_f32_16x16x32_bf16 a[116:119], v[116:119], a[180:183], a[116:119]
    v_mfma_f32_16x16x32_bf16 v[24:27], v[120:123], a[156:159], v[24:27]
    v_mfma_f32_16x16x32_bf16 v[56:59], v[120:123], a[160:163], v[56:59]
    v_mfma_f32_16x16x32_bf16 v[88:91], v[120:123], a[164:167], v[88:91]
    v_mfma_f32_16x16x32_bf16 a[24:27], v[120:123], a[168:171], a[24:27]
    v_mfma_f32_16x16x32_bf16 a[56:59], v[120:123], a[172:175], a[56:59]
    v_mfma_f32_16x16x32_bf16 a[88:91], v[120:123], a[176:179], a[88:91]
    v_mfma_f32_16x16x32_bf16 a[120:123], v[120:123], a[180:183], a[120:123]
    s_add_u32 s62, s62, 1024
    s_and_b32 s62, s62, 0x1ffff
    buffer_load_dwordx4 v243, s[48:51], s62 offen offset:3168 nt lds
    s_add_u32 s62, s62, 1024
    s_and_b32 s62, s62, 0x1ffff
    s_add_u32 s66, s66, 1
    s_add_u32 s67, s67, 33792
    s_cmp_eq_u32 s67, s68
    s_cselect_b32 s3, 135168, 0
    s_sub_u32 s67, s67, s3
    v_mfma_f32_16x16x32_bf16 v[28:31], v[124:127], a[156:159], v[28:31]
    v_mfma_f32_16x16x32_bf16 v[60:63], v[124:127], a[160:163], v[60:63]
    v_mfma_f32_16x16x32_bf16 v[92:95], v[124:127], a[164:167], v[92:95]
    v_mfma_f32_16x16x32_bf16 a[28:31], v[124:127], a[168:171], a[28:31]
    v_mfma_f32_16x16x32_bf16 a[60:63], v[124:127], a[172:175], a[60:63]
    v_mfma_f32_16x16x32_bf16 a[92:95], v[124:127], a[176:179], a[92:95]
    v_mfma_f32_16x16x32_bf16 a[124:127], v[124:127], a[180:183], a[124:127]
    buffer_load_dword v231, v249, s[16:19], s22 offen
    v_pk_mul_f32 v[0:1], v[0:1], s[64:65]
    v_pk_mul_f32 v[2:3], v[2:3], s[64:65]
    v_pk_mul_f32 v[4:5], v[4:5], s[64:65]
    v_pk_mul_f32 v[6:7], v[6:7], s[64:65]
    v_pk_mul_f32 v[8:9], v[8:9], s[64:65]
    v_pk_mul_f32 v[10:11], v[10:11], s[64:65]
    v_pk_mul_f32 v[12:13], v[12:13], s[64:65]
    v_pk_mul_f32 v[14:15], v[14:15], s[64:65]
    v_pk_mul_f32 v[16:17], v[16:17], s[64:65]
    v_pk_mul_f32 v[18:19], v[18:19], s[64:65]
    v_pk_mul_f32 v[20:21], v[20:21], s[64:65]
    v_pk_mul_f32 v[22:23], v[22:23], s[64:65]
    v_pk_mul_f32 v[24:25], v[24:25], s[64:65]
    v_pk_mul_f32 v[26:27], v[26:27], s[64:65]
    v_pk_mul_f32 v[28:29], v[28:29], s[64:65]
    v_pk_mul_f32 v[30:31], v[30:31], s[64:65]
    v_cvt_pk_bf16_f32 v96, v0, v4
    v_cvt_pk_bf16_f32 v97, v8, v12
    v_cvt_pk_bf16_f32 v98, v16, v20
    v_cvt_pk_bf16_f32 v99, v24, v28
    v_cvt_pk_bf16_f32 v100, v1, v5
    v_cvt_pk_bf16_f32 v101, v9, v13
    v_cvt_pk_bf16_f32 v102, v17, v21
    v_cvt_pk_bf16_f32 v103, v25, v29
    v_cvt_pk_bf16_f32 v104, v2, v6
    v_cvt_pk_bf16_f32 v105, v10, v14
    v_cvt_pk_bf16_f32 v106, v18, v22
    v_cvt_pk_bf16_f32 v107, v26, v30
    v_cvt_pk_bf16_f32 v108, v3, v7
    v_cvt_pk_bf16_f32 v109, v11, v15
    v_cvt_pk_bf16_f32 v110, v19, v23
    v_cvt_pk_bf16_f32 v111, v27, v31
    v_pk_mul_f32 v[32:33], v[32:33], s[64:65]
    v_pk_mul_f32 v[34:35], v[34:35], s[64:65]
    v_pk_mul_f32 v[36:37], v[36:37], s[64:65]
    v_pk_mul_f32 v[38:39], v[38:39], s[64:65]
    v_pk_mul_f32 v[40:41], v[40:41], s[64:65]
    v_pk_mul_f32 v[42:43], v[42:43], s[64:65]
    v_pk_mul_f32 v[44:45], v[44:45], s[64:65]
    v_pk_mul_f32 v[46:47], v[46:47], s[64:65]
    v_pk_mul_f32 v[48:49], v[48:49], s[64:65]
    v_pk_mul_f32 v[50:51], v[50:51], s[64:65]
    v_pk_mul_f32 v[52:53], v[52:53], s[64:65]
    v_pk_mul_f32 v[54:55], v[54:55], s[64:65]
    v_pk_mul_f32 v[56:57], v[56:57], s[64:65]
    v_pk_mul_f32 v[58:59], v[58:59], s[64:65]
    v_pk_mul_f32 v[60:61], v[60:61], s[64:65]
    v_pk_mul_f32 v[62:63], v[62:63], s[64:65]
    v_cvt_pk_bf16_f32 v112, v32, v36
    v_cvt_pk_bf16_f32 v113, v40, v44
    v_cvt_pk_bf16_f32 v114, v48, v52
    v_cvt_pk_bf16_f32 v115, v56, v60
    v_cvt_pk_bf16_f32 v116, v33, v37
    v_cvt_pk_bf16_f32 v117, v41, v45
    v_cvt_pk_bf16_f32 v118, v49, v53
    v_cvt_pk_bf16_f32 v119, v57, v61
    v_cvt_pk_bf16_f32 v120, v34, v38
    v_cvt_pk_bf16_f32 v121, v42, v46
    v_cvt_pk_bf16_f32 v122, v50, v54
    v_cvt_pk_bf16_f32 v123, v58, v62
    v_cvt_pk_bf16_f32 v124, v35, v39
    v_cvt_pk_bf16_f32 v125, v43, v47
    v_cvt_pk_bf16_f32 v126, v51, v55
    v_cvt_pk_bf16_f32 v127, v59, v63
    v_pk_mul_f32 v[64:65], v[64:65], s[64:65]
    v_pk_mul_f32 v[66:67], v[66:67], s[64:65]
    v_pk_mul_f32 v[68:69], v[68:69], s[64:65]
    v_pk_mul_f32 v[70:71], v[70:71], s[64:65]
    v_pk_mul_f32 v[72:73], v[72:73], s[64:65]
    v_pk_mul_f32 v[74:75], v[74:75], s[64:65]
    v_pk_mul_f32 v[76:77], v[76:77], s[64:65]
    v_pk_mul_f32 v[78:79], v[78:79], s[64:65]
    v_pk_mul_f32 v[80:81], v[80:81], s[64:65]
    v_pk_mul_f32 v[82:83], v[82:83], s[64:65]
    v_pk_mul_f32 v[84:85], v[84:85], s[64:65]
    v_pk_mul_f32 v[86:87], v[86:87], s[64:65]
    v_pk_mul_f32 v[88:89], v[88:89], s[64:65]
    v_pk_mul_f32 v[90:91], v[90:91], s[64:65]
    v_pk_mul_f32 v[92:93], v[92:93], s[64:65]
    v_pk_mul_f32 v[94:95], v[94:95], s[64:65]
    v_cvt_pk_bf16_f32 v128, v64, v68
    v_cvt_pk_bf16_f32 v129, v72, v76
    v_cvt_pk_bf16_f32 v130, v80, v84
    v_cvt_pk_bf16_f32 v131, v88, v92
    v_cvt_pk_bf16_f32 v132, v65, v69
    v_cvt_pk_bf16_f32 v133, v73, v77
    v_cvt_pk_bf16_f32 v134, v81, v85
    v_cvt_pk_bf16_f32 v135, v89, v93
    v_cvt_pk_bf16_f32 v136, v66, v70
    v_cvt_pk_bf16_f32 v137, v74, v78
    v_cvt_pk_bf16_f32 v138, v82, v86
    v_cvt_pk_bf16_f32 v139, v90, v94
    v_cvt_pk_bf16_f32 v140, v67, v71
    v_cvt_pk_bf16_f32 v141, v75, v79
    v_cvt_pk_bf16_f32 v142, v83, v87
    v_cvt_pk_bf16_f32 v143, v91, v95
    v_accvgpr_read_b32 v0, a0
    v_accvgpr_read_b32 v1, a1
    v_accvgpr_read_b32 v2, a2
    v_accvgpr_read_b32 v3, a3
    v_accvgpr_read_b32 v4, a4
    v_accvgpr_read_b32 v5, a5
    v_accvgpr_read_b32 v6, a6
    v_accvgpr_read_b32 v7, a7
    v_accvgpr_read_b32 v8, a8
    v_accvgpr_read_b32 v9, a9
    v_accvgpr_read_b32 v10, a10
    v_accvgpr_read_b32 v11, a11
    v_accvgpr_read_b32 v12, a12
    v_accvgpr_read_b32 v13, a13
    v_accvgpr_read_b32 v14, a14
    v_accvgpr_read_b32 v15, a15
    v_accvgpr_read_b32 v16, a16
    v_accvgpr_read_b32 v17, a17
    v_accvgpr_read_b32 v18, a18
    v_accvgpr_read_b32 v19, a19
    v_accvgpr_read_b32 v20, a20
    v_accvgpr_read_b32 v21, a21
    v_accvgpr_read_b32 v22, a22
    v_accvgpr_read_b32 v23, a23
    v_accvgpr_read_b32 v24, a24
    v_accvgpr_read_b32 v25, a25
    v_accvgpr_read_b32 v26, a26
    v_accvgpr_read_b32 v27, a27
    v_accvgpr_read_b32 v28, a28
    v_accvgpr_read_b32 v29, a29
    v_accvgpr_read_b32 v30, a30
    v_accvgpr_read_b32 v31, a31
    v_pk_mul_f32 v[0:1], v[0:1], s[64:65]
    v_pk_mul_f32 v[2:3], v[2:3], s[64:65]
    v_pk_mul_f32 v[4:5], v[4:5], s[64:65]
    v_pk_mul_f32 v[6:7], v[6:7], s[64:65]
    v_pk_mul_f32 v[8:9], v[8:9], s[64:65]
    v_pk_mul_f32 v[10:11], v[10:11], s[64:65]
    v_pk_mul_f32 v[12:13], v[12:13], s[64:65]
    v_pk_mul_f32 v[14:15], v[14:15], s[64:65]
    v_pk_mul_f32 v[16:17], v[16:17], s[64:65]
    v_pk_mul_f32 v[18:19], v[18:19], s[64:65]
    v_pk_mul_f32 v[20:21], v[20:21], s[64:65]
    v_pk_mul_f32 v[22:23], v[22:23], s[64:65]
    v_pk_mul_f32 v[24:25], v[24:25], s[64:65]
    v_pk_mul_f32 v[26:27], v[26:27], s[64:65]
    v_pk_mul_f32 v[28:29], v[28:29], s[64:65]
    v_pk_mul_f32 v[30:31], v[30:31], s[64:65]
    v_cvt_pk_bf16_f32 v144, v0, v4
    v_cvt_pk_bf16_f32 v145, v8, v12
    v_cvt_pk_bf16_f32 v146, v16, v20
    v_cvt_pk_bf16_f32 v147, v24, v28
    v_cvt_pk_bf16_f32 v148, v1, v5
    v_cvt_pk_bf16_f32 v149, v9, v13
    v_cvt_pk_bf16_f32 v150, v17, v21
    v_cvt_pk_bf16_f32 v151, v25, v29
    v_cvt_pk_bf16_f32 v152, v2, v6
    v_cvt_pk_bf16_f32 v153, v10, v14
    v_cvt_pk_bf16_f32 v154, v18, v22
    v_cvt_pk_bf16_f32 v155, v26, v30
    v_cvt_pk_bf16_f32 v156, v3, v7
    v_cvt_pk_bf16_f32 v157, v11, v15
    v_cvt_pk_bf16_f32 v158, v19, v23
    v_cvt_pk_bf16_f32 v159, v27, v31
    v_accvgpr_read_b32 v32, a32
    v_accvgpr_read_b32 v33, a33
    v_accvgpr_read_b32 v34, a34
    v_accvgpr_read_b32 v35, a35
    v_accvgpr_read_b32 v36, a36
    v_accvgpr_read_b32 v37, a37
    v_accvgpr_read_b32 v38, a38
    v_accvgpr_read_b32 v39, a39
    v_accvgpr_read_b32 v40, a40
    v_accvgpr_read_b32 v41, a41
    v_accvgpr_read_b32 v42, a42
    v_accvgpr_read_b32 v43, a43
    v_accvgpr_read_b32 v44, a44
    v_accvgpr_read_b32 v45, a45
    v_accvgpr_read_b32 v46, a46
    v_accvgpr_read_b32 v47, a47
    v_accvgpr_read_b32 v48, a48
    v_accvgpr_read_b32 v49, a49
    v_accvgpr_read_b32 v50, a50
    v_accvgpr_read_b32 v51, a51
    v_accvgpr_read_b32 v52, a52
    v_accvgpr_read_b32 v53, a53
    v_accvgpr_read_b32 v54, a54
    v_accvgpr_read_b32 v55, a55
    v_accvgpr_read_b32 v56, a56
    v_accvgpr_read_b32 v57, a57
    v_accvgpr_read_b32 v58, a58
    v_accvgpr_read_b32 v59, a59
    v_accvgpr_read_b32 v60, a60
    v_accvgpr_read_b32 v61, a61
    v_accvgpr_read_b32 v62, a62
    v_accvgpr_read_b32 v63, a63
    v_pk_mul_f32 v[32:33], v[32:33], s[64:65]
    v_pk_mul_f32 v[34:35], v[34:35], s[64:65]
    v_pk_mul_f32 v[36:37], v[36:37], s[64:65]
    v_pk_mul_f32 v[38:39], v[38:39], s[64:65]
    v_pk_mul_f32 v[40:41], v[40:41], s[64:65]
    v_pk_mul_f32 v[42:43], v[42:43], s[64:65]
    v_pk_mul_f32 v[44:45], v[44:45], s[64:65]
    v_pk_mul_f32 v[46:47], v[46:47], s[64:65]
    v_pk_mul_f32 v[48:49], v[48:49], s[64:65]
    v_pk_mul_f32 v[50:51], v[50:51], s[64:65]
    v_pk_mul_f32 v[52:53], v[52:53], s[64:65]
    v_pk_mul_f32 v[54:55], v[54:55], s[64:65]
    v_pk_mul_f32 v[56:57], v[56:57], s[64:65]
    v_pk_mul_f32 v[58:59], v[58:59], s[64:65]
    v_pk_mul_f32 v[60:61], v[60:61], s[64:65]
    v_pk_mul_f32 v[62:63], v[62:63], s[64:65]
    v_cvt_pk_bf16_f32 v160, v32, v36
    v_cvt_pk_bf16_f32 v161, v40, v44
    v_cvt_pk_bf16_f32 v162, v48, v52
    v_cvt_pk_bf16_f32 v163, v56, v60
    v_cvt_pk_bf16_f32 v164, v33, v37
    v_cvt_pk_bf16_f32 v165, v41, v45
    v_cvt_pk_bf16_f32 v166, v49, v53
    v_cvt_pk_bf16_f32 v167, v57, v61
    v_cvt_pk_bf16_f32 v168, v34, v38
    v_cvt_pk_bf16_f32 v169, v42, v46
    v_cvt_pk_bf16_f32 v170, v50, v54
    v_cvt_pk_bf16_f32 v171, v58, v62
    v_cvt_pk_bf16_f32 v172, v35, v39
    v_cvt_pk_bf16_f32 v173, v43, v47
    v_cvt_pk_bf16_f32 v174, v51, v55
    v_cvt_pk_bf16_f32 v175, v59, v63
    v_accvgpr_read_b32 v64, a64
    v_accvgpr_read_b32 v65, a65
    v_accvgpr_read_b32 v66, a66
    v_accvgpr_read_b32 v67, a67
    v_accvgpr_read_b32 v68, a68
    v_accvgpr_read_b32 v69, a69
    v_accvgpr_read_b32 v70, a70
    v_accvgpr_read_b32 v71, a71
    v_accvgpr_read_b32 v72, a72
    v_accvgpr_read_b32 v73, a73
    v_accvgpr_read_b32 v74, a74
    v_accvgpr_read_b32 v75, a75
    v_accvgpr_read_b32 v76, a76
    v_accvgpr_read_b32 v77, a77
    v_accvgpr_read_b32 v78, a78
    v_accvgpr_read_b32 v79, a79
    v_accvgpr_read_b32 v80, a80
    v_accvgpr_read_b32 v81, a81
    v_accvgpr_read_b32 v82, a82
    v_accvgpr_read_b32 v83, a83
    v_accvgpr_read_b32 v84, a84
    v_accvgpr_read_b32 v85, a85
    v_accvgpr_read_b32 v86, a86
    v_accvgpr_read_b32 v87, a87
    v_accvgpr_read_b32 v88, a88
    v_accvgpr_read_b32 v89, a89
    v_accvgpr_read_b32 v90, a90
    v_accvgpr_read_b32 v91, a91
    v_accvgpr_read_b32 v92, a92
    v_accvgpr_read_b32 v93, a93
    v_accvgpr_read_b32 v94, a94
    v_accvgpr_read_b32 v95, a95
    v_pk_mul_f32 v[64:65], v[64:65], s[64:65]
    v_pk_mul_f32 v[66:67], v[66:67], s[64:65]
    v_pk_mul_f32 v[68:69], v[68:69], s[64:65]
    v_pk_mul_f32 v[70:71], v[70:71], s[64:65]
    v_pk_mul_f32 v[72:73], v[72:73], s[64:65]
    v_pk_mul_f32 v[74:75], v[74:75], s[64:65]
    v_pk_mul_f32 v[76:77], v[76:77], s[64:65]
    v_pk_mul_f32 v[78:79], v[78:79], s[64:65]
    v_pk_mul_f32 v[80:81], v[80:81], s[64:65]
    v_pk_mul_f32 v[82:83], v[82:83], s[64:65]
    v_pk_mul_f32 v[84:85], v[84:85], s[64:65]
    v_pk_mul_f32 v[86:87], v[86:87], s[64:65]
    v_pk_mul_f32 v[88:89], v[88:89], s[64:65]
    v_pk_mul_f32 v[90:91], v[90:91], s[64:65]
    v_pk_mul_f32 v[92:93], v[92:93], s[64:65]
    v_pk_mul_f32 v[94:95], v[94:95], s[64:65]
    v_cvt_pk_bf16_f32 v176, v64, v68
    v_cvt_pk_bf16_f32 v177, v72, v76
    v_cvt_pk_bf16_f32 v178, v80, v84
    v_cvt_pk_bf16_f32 v179, v88, v92
    v_cvt_pk_bf16_f32 v180, v65, v69
    v_cvt_pk_bf16_f32 v181, v73, v77
    v_cvt_pk_bf16_f32 v182, v81, v85
    v_cvt_pk_bf16_f32 v183, v89, v93
    v_cvt_pk_bf16_f32 v184, v66, v70
    v_cvt_pk_bf16_f32 v185, v74, v78
    v_cvt_pk_bf16_f32 v186, v82, v86
    v_cvt_pk_bf16_f32 v187, v90, v94
    v_cvt_pk_bf16_f32 v188, v67, v71
    v_cvt_pk_bf16_f32 v189, v75, v79
    v_cvt_pk_bf16_f32 v190, v83, v87
    v_cvt_pk_bf16_f32 v191, v91, v95
    v_accvgpr_read_b32 v0, a96
    v_accvgpr_read_b32 v1, a97
    v_accvgpr_read_b32 v2, a98
    v_accvgpr_read_b32 v3, a99
    v_accvgpr_read_b32 v4, a100
    v_accvgpr_read_b32 v5, a101
    v_accvgpr_read_b32 v6, a102
    v_accvgpr_read_b32 v7, a103
    v_accvgpr_read_b32 v8, a104
    v_accvgpr_read_b32 v9, a105
    v_accvgpr_read_b32 v10, a106
    v_accvgpr_read_b32 v11, a107
    v_accvgpr_read_b32 v12, a108
    v_accvgpr_read_b32 v13, a109
    v_accvgpr_read_b32 v14, a110
    v_accvgpr_read_b32 v15, a111
    v_accvgpr_read_b32 v16, a112
    v_accvgpr_read_b32 v17, a113
    v_accvgpr_read_b32 v18, a114
    v_accvgpr_read_b32 v19, a115
    v_accvgpr_read_b32 v20, a116
    v_accvgpr_read_b32 v21, a117
    v_accvgpr_read_b32 v22, a118
    v_accvgpr_read_b32 v23, a119
    v_accvgpr_read_b32 v24, a120
    v_accvgpr_read_b32 v25, a121
    v_accvgpr_read_b32 v26, a122
    v_accvgpr_read_b32 v27, a123
    v_accvgpr_read_b32 v28, a124
    v_accvgpr_read_b32 v29, a125
    v_accvgpr_read_b32 v30, a126
    v_accvgpr_read_b32 v31, a127
    v_pk_mul_f32 v[0:1], v[0:1], s[64:65]
    v_pk_mul_f32 v[2:3], v[2:3], s[64:65]
    v_pk_mul_f32 v[4:5], v[4:5], s[64:65]
    v_pk_mul_f32 v[6:7], v[6:7], s[64:65]
    v_pk_mul_f32 v[8:9], v[8:9], s[64:65]
    v_pk_mul_f32 v[10:11], v[10:11], s[64:65]
    v_pk_mul_f32 v[12:13], v[12:13], s[64:65]
    v_pk_mul_f32 v[14:15], v[14:15], s[64:65]
    v_pk_mul_f32 v[16:17], v[16:17], s[64:65]
    v_pk_mul_f32 v[18:19], v[18:19], s[64:65]
    v_pk_mul_f32 v[20:21], v[20:21], s[64:65]
    v_pk_mul_f32 v[22:23], v[22:23], s[64:65]
    v_pk_mul_f32 v[24:25], v[24:25], s[64:65]
    v_pk_mul_f32 v[26:27], v[26:27], s[64:65]
    v_pk_mul_f32 v[28:29], v[28:29], s[64:65]
    v_pk_mul_f32 v[30:31], v[30:31], s[64:65]
    v_cvt_pk_bf16_f32 v192, v0, v4
    v_cvt_pk_bf16_f32 v193, v8, v12
    v_cvt_pk_bf16_f32 v194, v16, v20
    v_cvt_pk_bf16_f32 v195, v24, v28
    v_cvt_pk_bf16_f32 v196, v1, v5
    v_cvt_pk_bf16_f32 v197, v9, v13
    v_cvt_pk_bf16_f32 v198, v17, v21
    v_cvt_pk_bf16_f32 v199, v25, v29
    v_cvt_pk_bf16_f32 v200, v2, v6
    v_cvt_pk_bf16_f32 v201, v10, v14
    v_cvt_pk_bf16_f32 v202, v18, v22
    v_cvt_pk_bf16_f32 v203, v26, v30
    v_cvt_pk_bf16_f32 v204, v3, v7
    v_cvt_pk_bf16_f32 v205, v11, v15
    v_cvt_pk_bf16_f32 v206, v19, v23
    v_cvt_pk_bf16_f32 v207, v27, v31
    s_lshl_b32 s3, s28, 4
    s_add_u32 s66, s66, s3
    s_mov_b32 s98, 4294899712
    s_mov_b32 s99, 0
    s_mul_i32 s3, s34, 1179648
    s_add_u32 s44, s6, s3
    s_addc_u32 s45, s7, 0
    s_mov_b32 s46, 1179648
    s_mul_i32 s3, s33, 288
    s_mul_i32 s4, s26, 72
    s_add_u32 s3, s3, s4
    v_add_u32 v244, s3, v224
    v_lshlrev_b32 v244, 7, v244
    v_mov_b32 v227, 0x40000000
    v_cmp_gt_u32 vcc, 36, v224
    s_nop 1
    v_cndmask_b32 v244, v227, v244, vcc
    s_movk_i32 s100, 4608
    v_mov_b32 v228, v249
    v_mov_b32 v248, 0
    v_mov_b32 v249, 0
    v_mov_b32 v250, 0
    v_mov_b32 v251, 0
    v_mov_b32 v252, 0
    v_mov_b32 v253, 0
    v_mov_b32 v254, 0
    s_barrier
    ds_read_b128 a[224:227], v245 offset:0
    ds_read_b128 a[228:231], v245 offset:32
    ds_read_b128 a[232:235], v245 offset:64
    s_waitcnt lgkmcnt(2)
    v_mfma_f32_16x16x32_bf16 v[0:3], a[224:227], v[96:99], 0
    ds_read_b128 a[236:239], v245 offset:96
    v_mfma_f32_16x16x32_bf16 v[12:15], a[224:227], v[112:115], 0
    v_mfma_f32_16x16x32_bf16 v[24:27], a[224:227], v[128:131], 0
    s_mov_b32 m0, s67
    v_mfma_f32_16x16x32_bf16 v[36:39], a[224:227], v[144:147], 0
    s_cmp_lt_u32 s66, 16
    s_cselect_b32 s50, 135168, 0
    v_mfma_f32_16x16x32_bf16 v[48:51], a[224:227], v[160:163], 0
    s_waitcnt vmcnt(3)
    buffer_load_dwordx4 v240, s[48:51], s62 offen offset:0 nt lds
    v_mfma_f32_16x16x32_bf16 v[60:63], a[224:227], v[176:179], 0
    s_add_u32 s62, s62, 1024
    v_mfma_f32_16x16x32_bf16 v[72:75], a[224:227], v[192:195], 0
    s_waitcnt lgkmcnt(2)
    v_mfma_f32_16x16x32_bf16 v[0:3], a[228:231], v[100:103], v[0:3]
    ds_read_b128 a[240:243], v245 offset:512
    v_mfma_f32_16x16x32_bf16 v[12:15], a[228:231], v[116:119], v[12:15]
    s_and_b32 s62, s62, 0x1ffff
    v_mfma_f32_16x16x32_bf16 v[24:27], a[228:231], v[132:135], v[24:27]
    s_waitcnt vmcnt(3)
    buffer_load_dwordx4 v241, s[48:51], s62 offen offset:1056 nt lds
    v_mfma_f32_16x16x32_bf16 v[36:39], a[228:231], v[148:151], v[36:39]
    s_add_u32 s62, s62, 1024
    v_mfma_f32_16x16x32_bf16 v[48:51], a[228:231], v[164:167], v[48:51]
    s_and_b32 s62, s62, 0x1ffff
    v_mfma_f32_16x16x32_bf16 v[60:63], a[228:231], v[180:183], v[60:63]
    v_mfma_f32_16x16x32_bf16 v[72:75], a[228:231], v[196:199], v[72:75]
    s_waitcnt lgkmcnt(2)
    v_mfma_f32_16x16x32_bf16 v[0:3], a[232:235], v[104:107], v[0:3]
    ds_read_b128 a[244:247], v245 offset:544
    v_mfma_f32_16x16x32_bf16 v[12:15], a[232:235], v[120:123], v[12:15]
    s_waitcnt vmcnt(3)
    buffer_load_dwordx4 v242, s[48:51], s62 offen offset:2112 nt lds
    v_mfma_f32_16x16x32_bf16 v[24:27], a[232:235], v[136:139], v[24:27]
    s_add_u32 s62, s62, 1024
    v_mfma_f32_16x16x32_bf16 v[36:39], a[232:235], v[152:155], v[36:39]
    s_and_b32 s62, s62, 0x1ffff
    v_mfma_f32_16x16x32_bf16 v[48:51], a[232:235], v[168:171], v[48:51]
    v_mfma_f32_16x16x32_bf16 v[60:63], a[232:235], v[184:187], v[60:63]
    v_mfma_f32_16x16x32_bf16 v[72:75], a[232:235], v[200:203], v[72:75]
    s_waitcnt lgkmcnt(2)
    v_mfma_f32_16x16x32_bf16 v[0:3], a[236:239], v[108:111], v[0:3]
    ds_read_b128 a[248:251], v245 offset:576
    v_mfma_f32_16x16x32_bf16 v[12:15], a[236:239], v[124:127], v[12:15]
    s_waitcnt vmcnt(3)
    buffer_load_dwordx4 v243, s[48:51], s62 offen offset:3168 nt lds
    v_mfma_f32_16x16x32_bf16 v[24:27], a[236:239], v[140:143], v[24:27]
    s_add_u32 s62, s62, 1024
    v_mfma_f32_16x16x32_bf16 v[36:39], a[236:239], v[156:159], v[36:39]
    s_and_b32 s62, s62, 0x1ffff
    v_mfma_f32_16x16x32_bf16 v[48:51], a[236:239], v[172:175], v[48:51]
    s_add_u32 m0, s67, 4224
    v_mfma_f32_16x16x32_bf16 v[60:63], a[236:239], v[188:191], v[60:63]
    v_mfma_f32_16x16x32_bf16 v[72:75], a[236:239], v[204:207], v[72:75]
    s_waitcnt lgkmcnt(2)
    v_mfma_f32_16x16x32_bf16 v[8:11], a[240:243], v[96:99], 0
    ds_read_b128 a[252:255], v245 offset:608
    v_exp_f32 v0, v0
    v_mfma_f32_16x16x32_bf16 v[20:23], a[240:243], v[112:115], 0
    s_waitcnt vmcnt(3)
    buffer_load_dwordx4 v240, s[48:51], s62 offen offset:0 nt lds
    v_exp_f32 v1, v1
    v_mfma_f32_16x16x32_bf16 v[32:35], a[240:243], v[128:131], 0
    s_add_u32 s62, s62, 1024
    v_exp_f32 v2, v2
    v_mfma_f32_16x16x32_bf16 v[44:47], a[240:243], v[144:147], 0
    s_and_b32 s62, s62, 0x1ffff
    v_exp_f32 v3, v3
    v_mfma_f32_16x16x32_bf16 v[56:59], a[240:243], v[160:163], 0
    s_waitcnt vmcnt(3)
    buffer_load_dwordx4 v241, s[48:51], s62 offen offset:1056 nt lds
    v_add_f32 v248, v248, v0
    v_add_f32 v248, v248, v1
    v_mfma_f32_16x16x32_bf16 v[68:71], a[240:243], v[176:179], 0
    s_add_u32 s62, s62, 1024
    v_add_f32 v248, v248, v2
    v_add_f32 v248, v248, v3
    v_mfma_f32_16x16x32_bf16 v[80:83], a[240:243], v[192:195], 0
    s_waitcnt vmcnt(14) lgkmcnt(0)
    s_barrier
    v_cvt_pk_bf16_f32 v0, v0, v1
    v_cvt_pk_bf16_f32 v1, v2, v3
    v_mfma_f32_16x16x32_bf16 v[8:11], a[244:247], v[100:103], v[8:11]
    ds_read_b128 a[224:227], v245 offset:33792
    v_exp_f32 v12, v12
    v_mfma_f32_16x16x32_bf16 v[20:23], a[244:247], v[116:119], v[20:23]
    s_and_b32 s62, s62, 0x1ffff
    v_exp_f32 v13, v13
    v_mfma_f32_16x16x32_bf16 v[32:35], a[244:247], v[132:135], v[32:35]
    v_exp_f32 v14, v14
    v_mfma_f32_16x16x32_bf16 v[44:47], a[244:247], v[148:151], v[44:47]
    s_waitcnt vmcnt(3)
    buffer_load_dwordx4 v242, s[48:51], s62 offen offset:2112 nt lds
    v_exp_f32 v15, v15
    v_mfma_f32_16x16x32_bf16 v[56:59], a[244:247], v[164:167], v[56:59]
    s_add_u32 s62, s62, 1024
    v_add_f32 v249, v249, v12
    v_add_f32 v249, v249, v13
    v_mfma_f32_16x16x32_bf16 v[68:71], a[244:247], v[180:183], v[68:71]
    s_and_b32 s62, s62, 0x1ffff
    v_add_f32 v249, v249, v14
    v_add_f32 v249, v249, v15
    v_mfma_f32_16x16x32_bf16 v[80:83], a[244:247], v[196:199], v[80:83]
    v_cvt_pk_bf16_f32 v12, v12, v13
    v_cvt_pk_bf16_f32 v13, v14, v15
    v_mfma_f32_16x16x32_bf16 v[8:11], a[248:251], v[104:107], v[8:11]
    ds_read_b128 a[228:231], v245 offset:33824
    v_exp_f32 v24, v24
    v_mfma_f32_16x16x32_bf16 v[20:23], a[248:251], v[120:123], v[20:23]
    v_exp_f32 v25, v25
    v_mfma_f32_16x16x32_bf16 v[32:35], a[248:251], v[136:139], v[32:35]
    s_waitcnt vmcnt(3)
    buffer_load_dwordx4 v243, s[48:51], s62 offen offset:3168 nt lds
    v_exp_f32 v26, v26
    v_mfma_f32_16x16x32_bf16 v[44:47], a[248:251], v[152:155], v[44:47]
    s_add_u32 s62, s62, 1024
    v_exp_f32 v27, v27
    v_mfma_f32_16x16x32_bf16 v[56:59], a[248:251], v[168:171], v[56:59]
    s_and_b32 s62, s62, 0x1ffff
    v_add_f32 v250, v250, v24
    v_add_f32 v250, v250, v25
    v_mfma_f32_16x16x32_bf16 v[68:71], a[248:251], v[184:187], v[68:71]
    s_add_u32 s66, s66, 1
    v_add_f32 v250, v250, v26
    v_add_f32 v250, v250, v27
    v_mfma_f32_16x16x32_bf16 v[80:83], a[248:251], v[200:203], v[80:83]
    v_cvt_pk_bf16_f32 v24, v24, v25
    v_cvt_pk_bf16_f32 v25, v26, v27
    v_mfma_f32_16x16x32_bf16 v[8:11], a[252:255], v[108:111], v[8:11]
    ds_read_b128 a[232:235], v245 offset:33856
    v_exp_f32 v36, v36
    v_mfma_f32_16x16x32_bf16 v[20:23], a[252:255], v[124:127], v[20:23]
    s_add_u32 s67, s67, 33792
    v_exp_f32 v37, v37
    v_mfma_f32_16x16x32_bf16 v[32:35], a[252:255], v[140:143], v[32:35]
    s_cmp_eq_u32 s67, s68
    s_cselect_b32 s3, 135168, 0
    v_exp_f32 v38, v38
    v_mfma_f32_16x16x32_bf16 v[44:47], a[252:255], v[156:159], v[44:47]
    s_sub_u32 s67, s67, s3
    v_exp_f32 v39, v39
    v_mfma_f32_16x16x32_bf16 v[56:59], a[252:255], v[172:175], v[56:59]
    v_add_f32 v251, v251, v36
    v_add_f32 v251, v251, v37
    v_mfma_f32_16x16x32_bf16 v[68:71], a[252:255], v[188:191], v[68:71]
    v_add_f32 v251, v251, v38
    v_add_f32 v251, v251, v39
    v_mfma_f32_16x16x32_bf16 v[80:83], a[252:255], v[204:207], v[80:83]
    s_waitcnt lgkmcnt(2)
    v_cvt_pk_bf16_f32 v36, v36, v37
    v_cvt_pk_bf16_f32 v37, v38, v39
    v_exp_f32 v48, v48
    v_exp_f32 v49, v49
    v_exp_f32 v50, v50
    v_exp_f32 v51, v51
    v_add_f32 v252, v252, v48
    v_add_f32 v252, v252, v49
    v_add_f32 v252, v252, v50
    v_add_f32 v252, v252, v51
    v_cvt_pk_bf16_f32 v48, v48, v49
    v_cvt_pk_bf16_f32 v49, v50, v51
    v_exp_f32 v60, v60
    v_exp_f32 v61, v61
    v_exp_f32 v62, v62
    v_exp_f32 v63, v63
    v_add_f32 v253, v253, v60
    v_add_f32 v253, v253, v61
    v_add_f32 v253, v253, v62
    v_add_f32 v253, v253, v63
    v_cvt_pk_bf16_f32 v60, v60, v61
    v_cvt_pk_bf16_f32 v61, v62, v63
    v_exp_f32 v72, v72
    v_exp_f32 v73, v73
    v_exp_f32 v74, v74
    v_exp_f32 v75, v75
    v_add_f32 v254, v254, v72
    v_add_f32 v254, v254, v73
    v_add_f32 v254, v254, v74
    v_add_f32 v254, v254, v75
    v_cvt_pk_bf16_f32 v72, v72, v73
    v_cvt_pk_bf16_f32 v73, v74, v75
    v_exp_f32 v8, v8
    v_exp_f32 v9, v9
    v_exp_f32 v10, v10
    v_exp_f32 v11, v11
    v_add_f32 v248, v248, v8
    v_add_f32 v248, v248, v9
    v_add_f32 v248, v248, v10
    v_add_f32 v248, v248, v11
    v_cvt_pk_bf16_f32 v2, v8, v9
    v_cvt_pk_bf16_f32 v3, v10, v11
    v_exp_f32 v20, v20
    v_exp_f32 v21, v21
    v_exp_f32 v22, v22
    v_exp_f32 v23, v23
    v_add_f32 v249, v249, v20
    v_add_f32 v249, v249, v21
    v_add_f32 v249, v249, v22
    v_add_f32 v249, v249, v23
    v_cvt_pk_bf16_f32 v14, v20, v21
    v_cvt_pk_bf16_f32 v15, v22, v23
    v_exp_f32 v32, v32
    v_exp_f32 v33, v33
    v_exp_f32 v34, v34
    v_exp_f32 v35, v35
    v_add_f32 v250, v250, v32
    v_add_f32 v250, v250, v33
    v_add_f32 v250, v250, v34
    v_add_f32 v250, v250, v35
    v_cvt_pk_bf16_f32 v26, v32, v33
    v_cvt_pk_bf16_f32 v27, v34, v35
    v_exp_f32 v44, v44
    v_exp_f32 v45, v45
    v_exp_f32 v46, v46
    v_exp_f32 v47, v47
    v_add_f32 v251, v251, v44
    v_add_f32 v251, v251, v45
    v_add_f32 v251, v251, v46
    v_add_f32 v251, v251, v47
    v_cvt_pk_bf16_f32 v38, v44, v45
    v_cvt_pk_bf16_f32 v39, v46, v47
    v_exp_f32 v56, v56
    v_exp_f32 v57, v57
    v_exp_f32 v58, v58
    v_exp_f32 v59, v59
    v_add_f32 v252, v252, v56
    v_add_f32 v252, v252, v57
    v_add_f32 v252, v252, v58
    v_add_f32 v252, v252, v59
    v_cvt_pk_bf16_f32 v50, v56, v57
    v_cvt_pk_bf16_f32 v51, v58, v59
    s_mul_i32 s3, s28, 17
    s_sub_u32 s66, s66, s3
    s_mul_i32 s3, s28, 101376
    s_add_u32 s67, s67, s3
    s_lshl_b32 s3, s28, 13
    s_sub_u32 s62, s62, s3
    s_and_b32 s62, s62, 0x1ffff
    v_mfma_f32_16x16x32_bf16 v[4:7], a[224:227], v[96:99], 0
    ds_read_b128 a[236:239], v245 offset:33888
    v_exp_f32 v68, v68
    v_mfma_f32_16x16x32_bf16 v[16:19], a[224:227], v[112:115], 0
    v_exp_f32 v69, v69
    v_mfma_f32_16x16x32_bf16 v[28:31], a[224:227], v[128:131], 0
    s_mov_b32 m0, s67
    v_exp_f32 v70, v70
    v_mfma_f32_16x16x32_bf16 v[40:43], a[224:227], v[144:147], 0
    s_cmp_lt_u32 s66, 16
    s_cselect_b32 s50, 135168, 0
    v_exp_f32 v71, v71
    v_mfma_f32_16x16x32_bf16 v[52:55], a[224:227], v[160:163], 0
    s_waitcnt vmcnt(3)
    buffer_load_dwordx4 v240, s[48:51], s62 offen offset:0 nt lds
    v_add_f32 v253, v253, v68
    v_add_f32 v253, v253, v69
    v_mfma_f32_16x16x32_bf16 v[64:67], a[224:227], v[176:179], 0
    s_add_u32 s62, s62, 1024
    v_add_f32 v253, v253, v70
    v_add_f32 v253, v253, v71
    v_mfma_f32_16x16x32_bf16 v[76:79], a[224:227], v[192:195], 0
    s_waitcnt lgkmcnt(2)
    v_cvt_pk_bf16_f32 v62, v68, v69
    v_cvt_pk_bf16_f32 v63, v70, v71
    v_mfma_f32_16x16x32_bf16 v[4:7], a[228:231], v[100:103], v[4:7]
    ds_read_b128 a[240:243], v245 offset:34304
    v_exp_f32 v80, v80
    v_mfma_f32_16x16x32_bf16 v[16:19], a[228:231], v[116:119], v[16:19]
    s_and_b32 s62, s62, 0x1ffff
    v_exp_f32 v81, v81
    v_mfma_f32_16x16x32_bf16 v[28:31], a[228:231], v[132:135], v[28:31]
    v_exp_f32 v82, v82
    v_mfma_f32_16x16x32_bf16 v[40:43], a[228:231], v[148:151], v[40:43]
    v_exp_f32 v83, v83
    v_mfma_f32_16x16x32_bf16 v[52:55], a[228:231], v[164:167], v[52:55]
    v_add_f32 v254, v254, v80
    v_add_f32 v254, v254, v81
    v_mfma_f32_16x16x32_bf16 v[64:67], a[228:231], v[180:183], v[64:67]
    v_add_f32 v254, v254, v82
    v_add_f32 v254, v254, v83
    v_mfma_f32_16x16x32_bf16 v[76:79], a[228:231], v[196:199], v[76:79]
    s_waitcnt lgkmcnt(2)
    v_cvt_pk_bf16_f32 v74, v80, v81
    v_cvt_pk_bf16_f32 v75, v82, v83
    v_mfma_f32_16x16x32_bf16 v[4:7], a[232:235], v[104:107], v[4:7]
    ds_read_b128 a[244:247], v245 offset:34336
    v_mfma_f32_16x16x32_bf16 v[16:19], a[232:235], v[120:123], v[16:19]
    v_mfma_f32_16x16x32_bf16 v[28:31], a[232:235], v[136:139], v[28:31]
    s_sub_u32 s98, 0, s98
    v_mfma_f32_16x16x32_bf16 v[40:43], a[232:235], v[152:155], v[40:43]
    s_waitcnt vmcnt(3)
    buffer_load_dwordx4 v241, s[48:51], s62 offen offset:1056 nt lds
    v_mfma_f32_16x16x32_bf16 v[52:55], a[232:235], v[168:171], v[52:55]
    s_add_u32 s62, s62, 1024
    v_mfma_f32_16x16x32_bf16 v[64:67], a[232:235], v[184:187], v[64:67]
    s_and_b32 s62, s62, 0x1ffff
    v_mfma_f32_16x16x32_bf16 v[76:79], a[232:235], v[200:203], v[76:79]
    s_waitcnt lgkmcnt(2)
    v_mfma_f32_16x16x32_bf16 v[4:7], a[236:239], v[108:111], v[4:7]
    ds_read_b128 a[248:251], v245 offset:34368
    v_mfma_f32_16x16x32_bf16 v[16:19], a[236:239], v[124:127], v[16:19]
    v_mfma_f32_16x16x32_bf16 v[28:31], a[236:239], v[140:143], v[28:31]
    v_mfma_f32_16x16x32_bf16 v[40:43], a[236:239], v[156:159], v[40:43]
    v_mfma_f32_16x16x32_bf16 v[52:55], a[236:239], v[172:175], v[52:55]
    v_mfma_f32_16x16x32_bf16 v[64:67], a[236:239], v[188:191], v[64:67]
    v_mfma_f32_16x16x32_bf16 v[76:79], a[236:239], v[204:207], v[76:79]
    s_waitcnt lgkmcnt(2)
    v_mfma_f32_16x16x32_bf16 v[8:11], a[240:243], v[96:99], 0
    ds_read_b128 a[252:255], v245 offset:34400
    v_exp_f32 v4, v4
    v_mfma_f32_16x16x32_bf16 v[20:23], a[240:243], v[112:115], 0
    v_exp_f32 v5, v5
    v_mfma_f32_16x16x32_bf16 v[32:35], a[240:243], v[128:131], 0
    s_waitcnt vmcnt(3)
    buffer_load_dwordx4 v242, s[48:51], s62 offen offset:2112 nt lds
    v_exp_f32 v6, v6
    v_mfma_f32_16x16x32_bf16 v[44:47], a[240:243], v[144:147], 0
    s_add_u32 s62, s62, 1024
    v_exp_f32 v7, v7
    v_mfma_f32_16x16x32_bf16 v[56:59], a[240:243], v[160:163], 0
    s_and_b32 s62, s62, 0x1ffff
    v_add_f32 v248, v248, v4
    v_add_f32 v248, v248, v5
    v_mfma_f32_16x16x32_bf16 v[68:71], a[240:243], v[176:179], 0
    v_add_f32 v248, v248, v6
    v_add_f32 v248, v248, v7
    v_mfma_f32_16x16x32_bf16 v[80:83], a[240:243], v[192:195], 0
    s_waitcnt lgkmcnt(2)
    v_cvt_pk_bf16_f32 v4, v4, v5
    v_cvt_pk_bf16_f32 v5, v6, v7
    v_mfma_f32_16x16x32_bf16 v[8:11], a[244:247], v[100:103], v[8:11]
    ds_read_b64_tr_b16 a[224:225], v246 offset:0
    v_exp_f32 v16, v16
    v_mfma_f32_16x16x32_bf16 v[20:23], a[244:247], v[116:119], v[20:23]
    ds_read_b64_tr_b16 a[226:227], v246 offset:512
    v_exp_f32 v17, v17
    v_mfma_f32_16x16x32_bf16 v[32:35], a[244:247], v[132:135], v[32:35]
    v_exp_f32 v18, v18
    v_mfma_f32_16x16x32_bf16 v[44:47], a[244:247], v[148:151], v[44:47]
    v_exp_f32 v19, v19
    v_mfma_f32_16x16x32_bf16 v[56:59], a[244:247], v[164:167], v[56:59]
    v_add_f32 v249, v249, v16
    v_add_f32 v249, v249, v17
    v_mfma_f32_16x16x32_bf16 v[68:71], a[244:247], v[180:183], v[68:71]
    v_add_f32 v249, v249, v18
    v_add_f32 v249, v249, v19
    v_mfma_f32_16x16x32_bf16 v[80:83], a[244:247], v[196:199], v[80:83]
    s_waitcnt lgkmcnt(3)
    v_cvt_pk_bf16_f32 v16, v16, v17
    v_cvt_pk_bf16_f32 v17, v18, v19
    v_mfma_f32_16x16x32_bf16 v[8:11], a[248:251], v[104:107], v[8:11]
    ds_read_b64_tr_b16 a[228:229], v246 offset:32
    v_exp_f32 v28, v28
    v_mfma_f32_16x16x32_bf16 v[20:23], a[248:251], v[120:123], v[20:23]
    ds_read_b64_tr_b16 a[230:231], v246 offset:544
    v_exp_f32 v29, v29
    v_mfma_f32_16x16x32_bf16 v[32:35], a[248:251], v[136:139], v[32:35]
    s_waitcnt vmcnt(3)
    buffer_load_dwordx4 v243, s[48:51], s62 offen offset:3168 nt lds
    v_exp_f32 v30, v30
    v_mfma_f32_16x16x32_bf16 v[44:47], a[248:251], v[152:155], v[44:47]
    s_add_u32 s62, s62, 1024
    v_exp_f32 v31, v31
    v_mfma_f32_16x16x32_bf16 v[56:59], a[248:251], v[168:171], v[56:59]
    s_and_b32 s62, s62, 0x1ffff
    v_add_f32 v250, v250, v28
    v_add_f32 v250, v250, v29
    v_mfma_f32_16x16x32_bf16 v[68:71], a[248:251], v[184:187], v[68:71]
    s_add_u32 m0, s67, 4224
    v_add_f32 v250, v250, v30
    v_add_f32 v250, v250, v31
    v_mfma_f32_16x16x32_bf16 v[80:83], a[248:251], v[200:203], v[80:83]
    s_waitcnt lgkmcnt(4)
    v_cvt_pk_bf16_f32 v28, v28, v29
    v_cvt_pk_bf16_f32 v29, v30, v31
    v_mfma_f32_16x16x32_bf16 v[8:11], a[252:255], v[108:111], v[8:11]
    ds_read_b64_tr_b16 a[232:233], v246 offset:64
    v_exp_f32 v40, v40
    v_mfma_f32_16x16x32_bf16 v[20:23], a[252:255], v[124:127], v[20:23]
    ds_read_b64_tr_b16 a[234:235], v246 offset:576
    v_exp_f32 v41, v41
    v_mfma_f32_16x16x32_bf16 v[32:35], a[252:255], v[140:143], v[32:35]
    v_exp_f32 v42, v42
    v_mfma_f32_16x16x32_bf16 v[44:47], a[252:255], v[156:159], v[44:47]
    v_exp_f32 v43, v43
    v_mfma_f32_16x16x32_bf16 v[56:59], a[252:255], v[172:175], v[56:59]
    v_add_f32 v251, v251, v40
    v_add_f32 v251, v251, v41
    v_mfma_f32_16x16x32_bf16 v[68:71], a[252:255], v[188:191], v[68:71]
    v_add_f32 v251, v251, v42
    v_add_f32 v251, v251, v43
    v_mfma_f32_16x16x32_bf16 v[80:83], a[252:255], v[204:207], v[80:83]
    s_waitcnt lgkmcnt(4)
    v_cvt_pk_bf16_f32 v40, v40, v41
    v_cvt_pk_bf16_f32 v41, v42, v43
    v_mfma_f32_16x16x32_bf16 a[0:3], a[224:227], v[0:3], 0
    ds_read_b64_tr_b16 a[236:237], v246 offset:96
    v_exp_f32 v52, v52
    v_mfma_f32_16x16x32_bf16 a[4:7], a[224:227], v[12:15], 0
    ds_read_b64_tr_b16 a[238:239], v246 offset:608
    v_exp_f32 v53, v53
    v_mfma_f32_16x16x32_bf16 a[8:11], a[224:227], v[24:27], 0
    s_waitcnt vmcnt(3)
    buffer_load_dwordx4 v240, s[48:51], s62 offen offset:0 nt lds
    v_exp_f32 v54, v54
    v_mfma_f32_16x16x32_bf16 a[12:15], a[224:227], v[36:39], 0
    s_add_u32 s62, s62, 1024
    v_exp_f32 v55, v55
    v_mfma_f32_16x16x32_bf16 a[16:19], a[224:227], v[48:51], 0
    s_and_b32 s62, s62, 0x1ffff
    v_add_f32 v252, v252, v52
    v_add_f32 v252, v252, v53
    v_mfma_f32_16x16x32_bf16 a[20:23], a[224:227], v[60:63], 0
    v_add_f32 v252, v252, v54
    v_add_f32 v252, v252, v55
    v_mfma_f32_16x16x32_bf16 a[24:27], a[224:227], v[72:75], 0
    s_waitcnt lgkmcnt(4)
    v_cvt_pk_bf16_f32 v52, v52, v53
    v_cvt_pk_bf16_f32 v53, v54, v55
    v_mfma_f32_16x16x32_bf16 a[28:31], a[228:231], v[0:3], 0
    ds_read_b64_tr_b16 a[240:241], v246 offset:128
    v_exp_f32 v64, v64
    v_mfma_f32_16x16x32_bf16 a[32:35], a[228:231], v[12:15], 0
    ds_read_b64_tr_b16 a[242:243], v246 offset:640
    v_exp_f32 v65, v65
    v_mfma_f32_16x16x32_bf16 a[36:39], a[228:231], v[24:27], 0
    v_exp_f32 v66, v66
    v_mfma_f32_16x16x32_bf16 a[40:43], a[228:231], v[36:39], 0
    v_exp_f32 v67, v67
    v_mfma_f32_16x16x32_bf16 a[44:47], a[228:231], v[48:51], 0
    v_add_f32 v253, v253, v64
    v_add_f32 v253, v253, v65
    v_mfma_f32_16x16x32_bf16 a[48:51], a[228:231], v[60:63], 0
    v_add_f32 v253, v253, v66
    v_add_f32 v253, v253, v67
    v_mfma_f32_16x16x32_bf16 a[52:55], a[228:231], v[72:75], 0
    s_waitcnt lgkmcnt(4)
    v_cvt_pk_bf16_f32 v64, v64, v65
    v_cvt_pk_bf16_f32 v65, v66, v67
    v_mfma_f32_16x16x32_bf16 a[56:59], a[232:235], v[0:3], 0
    ds_read_b64_tr_b16 a[244:245], v246 offset:160
    v_exp_f32 v76, v76
    v_mfma_f32_16x16x32_bf16 a[60:63], a[232:235], v[12:15], 0
    ds_read_b64_tr_b16 a[246:247], v246 offset:672
    v_exp_f32 v77, v77
    v_mfma_f32_16x16x32_bf16 a[64:67], a[232:235], v[24:27], 0
    s_waitcnt vmcnt(3)
    buffer_load_dwordx4 v241, s[48:51], s62 offen offset:1056 nt lds
    v_exp_f32 v78, v78
    v_mfma_f32_16x16x32_bf16 a[68:71], a[232:235], v[36:39], 0
    s_add_u32 s62, s62, 1024
    v_exp_f32 v79, v79
    v_mfma_f32_16x16x32_bf16 a[72:75], a[232:235], v[48:51], 0
    s_and_b32 s62, s62, 0x1ffff
    v_add_f32 v254, v254, v76
    v_add_f32 v254, v254, v77
    v_mfma_f32_16x16x32_bf16 a[76:79], a[232:235], v[60:63], 0
    v_add_f32 v254, v254, v78
    v_add_f32 v254, v254, v79
    v_mfma_f32_16x16x32_bf16 a[80:83], a[232:235], v[72:75], 0
    s_waitcnt lgkmcnt(4)
    v_cvt_pk_bf16_f32 v76, v76, v77
    v_cvt_pk_bf16_f32 v77, v78, v79
    v_mfma_f32_16x16x32_bf16 a[84:87], a[236:239], v[0:3], 0
    ds_read_b64_tr_b16 a[248:249], v246 offset:192
    v_exp_f32 v8, v8
    v_mfma_f32_16x16x32_bf16 a[88:91], a[236:239], v[12:15], 0
    ds_read_b64_tr_b16 a[250:251], v246 offset:704
    v_exp_f32 v9, v9
    v_mfma_f32_16x16x32_bf16 a[92:95], a[236:239], v[24:27], 0
    v_exp_f32 v10, v10
    v_mfma_f32_16x16x32_bf16 a[96:99], a[236:239], v[36:39], 0
    v_exp_f32 v11, v11
    v_mfma_f32_16x16x32_bf16 a[100:103], a[236:239], v[48:51], 0
    v_add_f32 v248, v248, v8
    v_add_f32 v248, v248, v9
    v_mfma_f32_16x16x32_bf16 a[104:107], a[236:239], v[60:63], 0
    s_waitcnt vmcnt(3)
    buffer_load_dwordx4 v242, s[48:51], s62 offen offset:2112 nt lds
    v_add_f32 v248, v248, v10
    v_add_f32 v248, v248, v11
    v_mfma_f32_16x16x32_bf16 a[108:111], a[236:239], v[72:75], 0
    s_waitcnt lgkmcnt(4)
    v_cvt_pk_bf16_f32 v6, v8, v9
    v_cvt_pk_bf16_f32 v7, v10, v11
    v_mfma_f32_16x16x32_bf16 a[112:115], a[240:243], v[0:3], 0
    ds_read_b64_tr_b16 a[252:253], v246 offset:224
    v_exp_f32 v20, v20
    v_mfma_f32_16x16x32_bf16 a[116:119], a[240:243], v[12:15], 0
    ds_read_b64_tr_b16 a[254:255], v246 offset:736
    v_exp_f32 v21, v21
    v_mfma_f32_16x16x32_bf16 a[120:123], a[240:243], v[24:27], 0
    s_add_u32 s62, s62, 1024
    v_exp_f32 v22, v22
    v_mfma_f32_16x16x32_bf16 a[124:127], a[240:243], v[36:39], 0
    s_and_b32 s62, s62, 0x1ffff
    v_exp_f32 v23, v23
    v_mfma_f32_16x16x32_bf16 a[128:131], a[240:243], v[48:51], 0
    v_add_f32 v249, v249, v20
    v_add_f32 v249, v249, v21
    v_mfma_f32_16x16x32_bf16 a[132:135], a[240:243], v[60:63], 0
    v_add_f32 v249, v249, v22
    v_add_f32 v249, v249, v23
    v_mfma_f32_16x16x32_bf16 a[136:139], a[240:243], v[72:75], 0
    s_waitcnt vmcnt(15) lgkmcnt(0)
    s_barrier
    v_add_u32 v245, s98, v245
    v_cvt_pk_bf16_f32 v18, v20, v21
    v_cvt_pk_bf16_f32 v19, v22, v23
    v_mfma_f32_16x16x32_bf16 a[140:143], a[244:247], v[0:3], 0
    ds_read_b128 a[224:227], v245 offset:0
    v_exp_f32 v32, v32
    v_mfma_f32_16x16x32_bf16 a[144:147], a[244:247], v[12:15], 0
    v_exp_f32 v33, v33
    v_mfma_f32_16x16x32_bf16 a[148:151], a[244:247], v[24:27], 0
    v_exp_f32 v34, v34
    v_mfma_f32_16x16x32_bf16 a[152:155], a[244:247], v[36:39], 0
    v_exp_f32 v35, v35
    v_mfma_f32_16x16x32_bf16 a[156:159], a[244:247], v[48:51], 0
    v_add_f32 v250, v250, v32
    v_add_f32 v250, v250, v33
    v_mfma_f32_16x16x32_bf16 a[160:163], a[244:247], v[60:63], 0
    s_waitcnt vmcnt(3)
    buffer_load_dwordx4 v243, s[48:51], s62 offen offset:3168 nt lds
    v_add_f32 v250, v250, v34
    v_add_f32 v250, v250, v35
    v_mfma_f32_16x16x32_bf16 a[164:167], a[244:247], v[72:75], 0
    v_cvt_pk_bf16_f32 v30, v32, v33
    v_cvt_pk_bf16_f32 v31, v34, v35
    v_mfma_f32_16x16x32_bf16 a[168:171], a[248:251], v[0:3], 0
    ds_read_b128 a[228:231], v245 offset:32
    v_exp_f32 v44, v44
    v_mfma_f32_16x16x32_bf16 a[172:175], a[248:251], v[12:15], 0
    s_add_u32 s62, s62, 1024
    v_exp_f32 v45, v45
    v_mfma_f32_16x16x32_bf16 a[176:179], a[248:251], v[24:27], 0
    s_and_b32 s62, s62, 0x1ffff
    v_exp_f32 v46, v46
    v_mfma_f32_16x16x32_bf16 a[180:183], a[248:251], v[36:39], 0
    s_add_u32 s66, s66, 1
    v_exp_f32 v47, v47
    v_mfma_f32_16x16x32_bf16 a[184:187], a[248:251], v[48:51], 0
    s_add_u32 s67, s67, 33792
    v_add_f32 v251, v251, v44
    v_add_f32 v251, v251, v45
    v_mfma_f32_16x16x32_bf16 a[188:191], a[248:251], v[60:63], 0
    s_cmp_eq_u32 s67, s68
    s_cselect_b32 s3, 135168, 0
    v_add_f32 v251, v251, v46
    v_add_f32 v251, v251, v47
    v_mfma_f32_16x16x32_bf16 a[192:195], a[248:251], v[72:75], 0
    v_cvt_pk_bf16_f32 v42, v44, v45
    v_cvt_pk_bf16_f32 v43, v46, v47
    v_mfma_f32_16x16x32_bf16 a[196:199], a[252:255], v[0:3], 0
    ds_read_b128 a[232:235], v245 offset:64
    v_exp_f32 v56, v56
    v_mfma_f32_16x16x32_bf16 a[200:203], a[252:255], v[12:15], 0
    s_sub_u32 s67, s67, s3
    v_exp_f32 v57, v57
    v_mfma_f32_16x16x32_bf16 a[204:207], a[252:255], v[24:27], 0
    v_exp_f32 v58, v58
    v_mfma_f32_16x16x32_bf16 a[208:211], a[252:255], v[36:39], 0
    v_exp_f32 v59, v59
    v_mfma_f32_16x16x32_bf16 a[212:215], a[252:255], v[48:51], 0
    v_add_f32 v252, v252, v56
    v_add_f32 v252, v252, v57
    v_mfma_f32_16x16x32_bf16 a[216:219], a[252:255], v[60:63], 0
    v_add_f32 v252, v252, v58
    v_add_f32 v252, v252, v59
    v_mfma_f32_16x16x32_bf16 a[220:223], a[252:255], v[72:75], 0
    s_waitcnt lgkmcnt(2)
    v_cvt_pk_bf16_f32 v54, v56, v57
    v_cvt_pk_bf16_f32 v55, v58, v59
L_loop:
    v_mfma_f32_16x16x32_bf16 v[0:3], a[224:227], v[96:99], 0
    ds_read_b128 a[236:239], v245 offset:96
    v_exp_f32 v68, v68
    v_mfma_f32_16x16x32_bf16 v[12:15], a[224:227], v[112:115], 0
    v_exp_f32 v69, v69
    v_mfma_f32_16x16x32_bf16 v[24:27], a[224:227], v[128:131], 0
    s_mov_b32 m0, s67
    v_exp_f32 v70, v70
    v_mfma_f32_16x16x32_bf16 v[36:39], a[224:227], v[144:147], 0
    s_cmp_lt_u32 s66, 16
    s_cselect_b32 s50, 135168, 0
    v_exp_f32 v71, v71
    v_mfma_f32_16x16x32_bf16 v[48:51], a[224:227], v[160:163], 0
    s_waitcnt vmcnt(3)
    buffer_load_dwordx4 v240, s[48:51], s62 offen offset:0 nt lds
    v_add_f32 v253, v253, v68
    v_add_f32 v253, v253, v69
    v_mfma_f32_16x16x32_bf16 v[60:63], a[224:227], v[176:179], 0
    s_add_u32 s62, s62, 1024
    v_add_f32 v253, v253, v70
    v_add_f32 v253, v253, v71
    v_mfma_f32_16x16x32_bf16 v[72:75], a[224:227], v[192:195], 0
    s_waitcnt lgkmcnt(2)
    v_cvt_pk_bf16_f32 v66, v68, v69
    v_cvt_pk_bf16_f32 v67, v70, v71
    v_mfma_f32_16x16x32_bf16 v[0:3], a[228:231], v[100:103], v[0:3]
    ds_read_b128 a[240:243], v245 offset:512
    v_exp_f32 v80, v80
    v_mfma_f32_16x16x32_bf16 v[12:15], a[228:231], v[116:119], v[12:15]
    s_and_b32 s62, s62, 0x1ffff
    v_exp_f32 v81, v81
    v_mfma_f32_16x16x32_bf16 v[24:27], a[228:231], v[132:135], v[24:27]
    v_exp_f32 v82, v82
    v_mfma_f32_16x16x32_bf16 v[36:39], a[228:231], v[148:151], v[36:39]
    v_exp_f32 v83, v83
    v_mfma_f32_16x16x32_bf16 v[48:51], a[228:231], v[164:167], v[48:51]
    v_add_f32 v254, v254, v80
    v_add_f32 v254, v254, v81
    v_mfma_f32_16x16x32_bf16 v[60:63], a[228:231], v[180:183], v[60:63]
    v_add_f32 v254, v254, v82
    v_add_f32 v254, v254, v83
    v_mfma_f32_16x16x32_bf16 v[72:75], a[228:231], v[196:199], v[72:75]
    s_waitcnt lgkmcnt(2)
    v_cvt_pk_bf16_f32 v78, v80, v81
    v_cvt_pk_bf16_f32 v79, v82, v83
    v_mfma_f32_16x16x32_bf16 v[0:3], a[232:235], v[104:107], v[0:3]
    ds_read_b128 a[244:247], v245 offset:544
    v_mfma_f32_16x16x32_bf16 v[12:15], a[232:235], v[120:123], v[12:15]
    v_mfma_f32_16x16x32_bf16 v[24:27], a[232:235], v[136:139], v[24:27]
    v_mfma_f32_16x16x32_bf16 v[36:39], a[232:235], v[152:155], v[36:39]
    s_waitcnt vmcnt(3)
    buffer_load_dwordx4 v241, s[48:51], s62 offen offset:1056 nt lds
    v_mfma_f32_16x16x32_bf16 v[48:51], a[232:235], v[168:171], v[48:51]
    s_add_u32 s62, s62, 1024
    v_mfma_f32_16x16x32_bf16 v[60:63], a[232:235], v[184:187], v[60:63]
    s_and_b32 s62, s62, 0x1ffff
    v_mfma_f32_16x16x32_bf16 v[72:75], a[232:235], v[200:203], v[72:75]
    s_waitcnt lgkmcnt(2)
    v_mfma_f32_16x16x32_bf16 v[0:3], a[236:239], v[108:111], v[0:3]
    ds_read_b128 a[248:251], v245 offset:576
    v_mfma_f32_16x16x32_bf16 v[12:15], a[236:239], v[124:127], v[12:15]
    v_mfma_f32_16x16x32_bf16 v[24:27], a[236:239], v[140:143], v[24:27]
    v_mfma_f32_16x16x32_bf16 v[36:39], a[236:239], v[156:159], v[36:39]
    v_mfma_f32_16x16x32_bf16 v[48:51], a[236:239], v[172:175], v[48:51]
    v_mfma_f32_16x16x32_bf16 v[60:63], a[236:239], v[188:191], v[60:63]
    v_mfma_f32_16x16x32_bf16 v[72:75], a[236:239], v[204:207], v[72:75]
    s_waitcnt lgkmcnt(2)
    v_mfma_f32_16x16x32_bf16 v[8:11], a[240:243], v[96:99], 0
    ds_read_b128 a[252:255], v245 offset:608
    v_exp_f32 v0, v0
    v_mfma_f32_16x16x32_bf16 v[20:23], a[240:243], v[112:115], 0
    v_exp_f32 v1, v1
    v_mfma_f32_16x16x32_bf16 v[32:35], a[240:243], v[128:131], 0
    s_waitcnt vmcnt(3)
    buffer_load_dwordx4 v242, s[48:51], s62 offen offset:2112 nt lds
    v_exp_f32 v2, v2
    v_mfma_f32_16x16x32_bf16 v[44:47], a[240:243], v[144:147], 0
    s_add_u32 s62, s62, 1024
    v_exp_f32 v3, v3
    v_mfma_f32_16x16x32_bf16 v[56:59], a[240:243], v[160:163], 0
    s_and_b32 s62, s62, 0x1ffff
    v_add_f32 v248, v248, v0
    v_add_f32 v248, v248, v1
    v_mfma_f32_16x16x32_bf16 v[68:71], a[240:243], v[176:179], 0
    v_add_f32 v248, v248, v2
    v_add_f32 v248, v248, v3
    v_mfma_f32_16x16x32_bf16 v[80:83], a[240:243], v[192:195], 0
    s_waitcnt lgkmcnt(2)
    v_cvt_pk_bf16_f32 v0, v0, v1
    v_cvt_pk_bf16_f32 v1, v2, v3
    v_mfma_f32_16x16x32_bf16 v[8:11], a[244:247], v[100:103], v[8:11]
    ds_read_b64_tr_b16 a[224:225], v246 offset:33792
    v_exp_f32 v12, v12
    v_mfma_f32_16x16x32_bf16 v[20:23], a[244:247], v[116:119], v[20:23]
    ds_read_b64_tr_b16 a[226:227], v246 offset:34304
    v_exp_f32 v13, v13
    v_mfma_f32_16x16x32_bf16 v[32:35], a[244:247], v[132:135], v[32:35]
    v_exp_f32 v14, v14
    v_mfma_f32_16x16x32_bf16 v[44:47], a[244:247], v[148:151], v[44:47]
    v_exp_f32 v15, v15
    v_mfma_f32_16x16x32_bf16 v[56:59], a[244:247], v[164:167], v[56:59]
    v_add_f32 v249, v249, v12
    v_add_f32 v249, v249, v13
    v_mfma_f32_16x16x32_bf16 v[68:71], a[244:247], v[180:183], v[68:71]
    v_add_f32 v249, v249, v14
    v_add_f32 v249, v249, v15
    v_mfma_f32_16x16x32_bf16 v[80:83], a[244:247], v[196:199], v[80:83]
    s_waitcnt lgkmcnt(3)
    v_cvt_pk_bf16_f32 v12, v12, v13
    v_cvt_pk_bf16_f32 v13, v14, v15
    v_mfma_f32_16x16x32_bf16 v[8:11], a[248:251], v[104:107], v[8:11]
    ds_read_b64_tr_b16 a[228:229], v246 offset:33824
    v_exp_f32 v24, v24
    v_mfma_f32_16x16x32_bf16 v[20:23], a[248:251], v[120:123], v[20:23]
    ds_read_b64_tr_b16 a[230:231], v246 offset:34336
    v_exp_f32 v25, v25
    v_mfma_f32_16x16x32_bf16 v[32:35], a[248:251], v[136:139], v[32:35]
    s_waitcnt vmcnt(3)
    buffer_load_dwordx4 v243, s[48:51], s62 offen offset:3168 nt lds
    v_exp_f32 v26, v26
    v_mfma_f32_16x16x32_bf16 v[44:47], a[248:251], v[152:155], v[44:47]
    s_add_u32 s62, s62, 1024
    v_exp_f32 v27, v27
    v_mfma_f32_16x16x32_bf16 v[56:59], a[248:251], v[168:171], v[56:59]
    s_and_b32 s62, s62, 0x1ffff
    v_add_f32 v250, v250, v24
    v_add_f32 v250, v250, v25
    v_mfma_f32_16x16x32_bf16 v[68:71], a[248:251], v[184:187], v[68:71]
    s_add_u32 m0, s67, 4224
    v_add_f32 v250, v250, v26
    v_add_f32 v250, v250, v27
    v_mfma_f32_16x16x32_bf16 v[80:83], a[248:251], v[200:203], v[80:83]
    s_waitcnt lgkmcnt(4)
    v_cvt_pk_bf16_f32 v24, v24, v25
    v_cvt_pk_bf16_f32 v25, v26, v27
    v_mfma_f32_16x16x32_bf16 v[8:11], a[252:255], v[108:111], v[8:11]
    ds_read_b64_tr_b16 a[232:233], v246 offset:33856
    v_exp_f32 v36, v36
    v_mfma_f32_16x16x32_bf16 v[20:23], a[252:255], v[124:127], v[20:23]
    ds_read_b64_tr_b16 a[234:235], v246 offset:34368
    v_exp_f32 v37, v37
    v_mfma_f32_16x16x32_bf16 v[32:35], a[252:255], v[140:143], v[32:35]
    v_exp_f32 v38, v38
    v_mfma_f32_16x16x32_bf16 v[44:47], a[252:255], v[156:159], v[44:47]
    v_exp_f32 v39, v39
    v_mfma_f32_16x16x32_bf16 v[56:59], a[252:255], v[172:175], v[56:59]
    v_add_f32 v251, v251, v36
    v_add_f32 v251, v251, v37
    v_mfma_f32_16x16x32_bf16 v[68:71], a[252:255], v[188:191], v[68:71]
    v_add_f32 v251, v251, v38
    v_add_f32 v251, v251, v39
    v_mfma_f32_16x16x32_bf16 v[80:83], a[252:255], v[204:207], v[80:83]
    s_waitcnt lgkmcnt(4)
    v_cvt_pk_bf16_f32 v36, v36, v37
    v_cvt_pk_bf16_f32 v37, v38, v39
    v_mfma_f32_16x16x32_bf16 a[0:3], a[224:227], v[4:7], a[0:3]
    ds_read_b64_tr_b16 a[236:237], v246 offset:33888
    v_exp_f32 v48, v48
    v_mfma_f32_16x16x32_bf16 a[4:7], a[224:227], v[16:19], a[4:7]
    ds_read_b64_tr_b16 a[238:239], v246 offset:34400
    v_exp_f32 v49, v49
    v_mfma_f32_16x16x32_bf16 a[8:11], a[224:227], v[28:31], a[8:11]
    s_waitcnt vmcnt(3)
    buffer_load_dwordx4 v240, s[48:51], s62 offen offset:0 nt lds
    v_exp_f32 v50, v50
    v_mfma_f32_16x16x32_bf16 a[12:15], a[224:227], v[40:43], a[12:15]
    s_add_u32 s62, s62, 1024
    v_exp_f32 v51, v51
    v_mfma_f32_16x16x32_bf16 a[16:19], a[224:227], v[52:55], a[16:19]
    s_and_b32 s62, s62, 0x1ffff
    v_add_f32 v252, v252, v48
    v_add_f32 v252, v252, v49
    v_mfma_f32_16x16x32_bf16 a[20:23], a[224:227], v[64:67], a[20:23]
    v_add_f32 v252, v252, v50
    v_add_f32 v252, v252, v51
    v_mfma_f32_16x16x32_bf16 a[24:27], a[224:227], v[76:79], a[24:27]
    s_waitcnt lgkmcnt(4)
    v_cvt_pk_bf16_f32 v48, v48, v49
    v_cvt_pk_bf16_f32 v49, v50, v51
    v_mfma_f32_16x16x32_bf16 a[28:31], a[228:231], v[4:7], a[28:31]
    ds_read_b64_tr_b16 a[240:241], v246 offset:33920
    v_exp_f32 v60, v60
    v_mfma_f32_16x16x32_bf16 a[32:35], a[228:231], v[16:19], a[32:35]
    ds_read_b64_tr_b16 a[242:243], v246 offset:34432
    v_exp_f32 v61, v61
    v_mfma_f32_16x16x32_bf16 a[36:39], a[228:231], v[28:31], a[36:39]
    v_exp_f32 v62, v62
    v_mfma_f32_16x16x32_bf16 a[40:43], a[228:231], v[40:43], a[40:43]
    v_exp_f32 v63, v63
    v_mfma_f32_16x16x32_bf16 a[44:47], a[228:231], v[52:55], a[44:47]
    v_add_f32 v253, v253, v60
    v_add_f32 v253, v253, v61
    v_mfma_f32_16x16x32_bf16 a[48:51], a[228:231], v[64:67], a[48:51]
    v_add_f32 v253, v253, v62
    v_add_f32 v253, v253, v63
    v_mfma_f32_16x16x32_bf16 a[52:55], a[228:231], v[76:79], a[52:55]
    s_waitcnt lgkmcnt(4)
    v_cvt_pk_bf16_f32 v60, v60, v61
    v_cvt_pk_bf16_f32 v61, v62, v63
    v_mfma_f32_16x16x32_bf16 a[56:59], a[232:235], v[4:7], a[56:59]
    ds_read_b64_tr_b16 a[244:245], v246 offset:33952
    v_exp_f32 v72, v72
    v_mfma_f32_16x16x32_bf16 a[60:63], a[232:235], v[16:19], a[60:63]
    ds_read_b64_tr_b16 a[246:247], v246 offset:34464
    v_exp_f32 v73, v73
    v_mfma_f32_16x16x32_bf16 a[64:67], a[232:235], v[28:31], a[64:67]
    s_waitcnt vmcnt(3)
    buffer_load_dwordx4 v241, s[48:51], s62 offen offset:1056 nt lds
    v_exp_f32 v74, v74
    v_mfma_f32_16x16x32_bf16 a[68:71], a[232:235], v[40:43], a[68:71]
    s_add_u32 s62, s62, 1024
    v_exp_f32 v75, v75
    v_mfma_f32_16x16x32_bf16 a[72:75], a[232:235], v[52:55], a[72:75]
    s_and_b32 s62, s62, 0x1ffff
    v_add_f32 v254, v254, v72
    v_add_f32 v254, v254, v73
    v_mfma_f32_16x16x32_bf16 a[76:79], a[232:235], v[64:67], a[76:79]
    v_add_f32 v254, v254, v74
    v_add_f32 v254, v254, v75
    v_mfma_f32_16x16x32_bf16 a[80:83], a[232:235], v[76:79], a[80:83]
    s_waitcnt lgkmcnt(4)
    v_cvt_pk_bf16_f32 v72, v72, v73
    v_cvt_pk_bf16_f32 v73, v74, v75
    v_mfma_f32_16x16x32_bf16 a[84:87], a[236:239], v[4:7], a[84:87]
    ds_read_b64_tr_b16 a[248:249], v246 offset:33984
    v_exp_f32 v8, v8
    v_mfma_f32_16x16x32_bf16 a[88:91], a[236:239], v[16:19], a[88:91]
    ds_read_b64_tr_b16 a[250:251], v246 offset:34496
    v_exp_f32 v9, v9
    v_mfma_f32_16x16x32_bf16 a[92:95], a[236:239], v[28:31], a[92:95]
    v_exp_f32 v10, v10
    v_mfma_f32_16x16x32_bf16 a[96:99], a[236:239], v[40:43], a[96:99]
    v_exp_f32 v11, v11
    v_mfma_f32_16x16x32_bf16 a[100:103], a[236:239], v[52:55], a[100:103]
    v_add_f32 v248, v248, v8
    v_add_f32 v248, v248, v9
    v_mfma_f32_16x16x32_bf16 a[104:107], a[236:239], v[64:67], a[104:107]
    s_waitcnt vmcnt(3)
    buffer_load_dwordx4 v242, s[48:51], s62 offen offset:2112 nt lds
    v_add_f32 v248, v248, v10
    v_add_f32 v248, v248, v11
    v_mfma_f32_16x16x32_bf16 a[108:111], a[236:239], v[76:79], a[108:111]
    s_waitcnt lgkmcnt(4)
    v_cvt_pk_bf16_f32 v2, v8, v9
    v_cvt_pk_bf16_f32 v3, v10, v11
    v_mfma_f32_16x16x32_bf16 a[112:115], a[240:243], v[4:7], a[112:115]
    ds_read_b64_tr_b16 a[252:253], v246 offset:34016
    v_exp_f32 v20, v20
    v_mfma_f32_16x16x32_bf16 a[116:119], a[240:243], v[16:19], a[116:119]
    ds_read_b64_tr_b16 a[254:255], v246 offset:34528
    v_exp_f32 v21, v21
    v_mfma_f32_16x16x32_bf16 a[120:123], a[240:243], v[28:31], a[120:123]
    s_add_u32 s62, s62, 1024
    v_exp_f32 v22, v22
    v_mfma_f32_16x16x32_bf16 a[124:127], a[240:243], v[40:43], a[124:127]
    s_and_b32 s62, s62, 0x1ffff
    v_exp_f32 v23, v23
    v_mfma_f32_16x16x32_bf16 a[128:131], a[240:243], v[52:55], a[128:131]
    v_add_f32 v249, v249, v20
    v_add_f32 v249, v249, v21
    v_mfma_f32_16x16x32_bf16 a[132:135], a[240:243], v[64:67], a[132:135]
    v_add_f32 v249, v249, v22
    v_add_f32 v249, v249, v23
    v_mfma_f32_16x16x32_bf16 a[136:139], a[240:243], v[76:79], a[136:139]
    s_waitcnt vmcnt(15) lgkmcnt(0)
    s_barrier
    v_cvt_pk_bf16_f32 v14, v20, v21
    v_cvt_pk_bf16_f32 v15, v22, v23
    v_mfma_f32_16x16x32_bf16 a[140:143], a[244:247], v[4:7], a[140:143]
    ds_read_b128 a[224:227], v245 offset:33792
    v_exp_f32 v32, v32
    v_mfma_f32_16x16x32_bf16 a[144:147], a[244:247], v[16:19], a[144:147]
    v_exp_f32 v33, v33
    v_mfma_f32_16x16x32_bf16 a[148:151], a[244:247], v[28:31], a[148:151]
    v_exp_f32 v34, v34
    v_mfma_f32_16x16x32_bf16 a[152:155], a[244:247], v[40:43], a[152:155]
    v_exp_f32 v35, v35
    v_mfma_f32_16x16x32_bf16 a[156:159], a[244:247], v[52:55], a[156:159]
    v_add_f32 v250, v250, v32
    v_add_f32 v250, v250, v33
    v_mfma_f32_16x16x32_bf16 a[160:163], a[244:247], v[64:67], a[160:163]
    s_waitcnt vmcnt(3)
    buffer_load_dwordx4 v243, s[48:51], s62 offen offset:3168 nt lds
    v_add_f32 v250, v250, v34
    v_add_f32 v250, v250, v35
    v_mfma_f32_16x16x32_bf16 a[164:167], a[244:247], v[76:79], a[164:167]
    v_cvt_pk_bf16_f32 v26, v32, v33
    v_cvt_pk_bf16_f32 v27, v34, v35
    v_mfma_f32_16x16x32_bf16 a[168:171], a[248:251], v[4:7], a[168:171]
    ds_read_b128 a[228:231], v245 offset:33824
    v_exp_f32 v44, v44
    v_mfma_f32_16x16x32_bf16 a[172:175], a[248:251], v[16:19], a[172:175]
    s_add_u32 s62, s62, 1024
    v_exp_f32 v45, v45
    v_mfma_f32_16x16x32_bf16 a[176:179], a[248:251], v[28:31], a[176:179]
    s_and_b32 s62, s62, 0x1ffff
    v_exp_f32 v46, v46
    v_mfma_f32_16x16x32_bf16 a[180:183], a[248:251], v[40:43], a[180:183]
    s_add_u32 s66, s66, 1
    v_exp_f32 v47, v47
    v_mfma_f32_16x16x32_bf16 a[184:187], a[248:251], v[52:55], a[184:187]
    s_add_u32 s67, s67, 33792
    v_add_f32 v251, v251, v44
    v_add_f32 v251, v251, v45
    v_mfma_f32_16x16x32_bf16 a[188:191], a[248:251], v[64:67], a[188:191]
    s_cmp_eq_u32 s67, s68
    s_cselect_b32 s3, 135168, 0
    v_add_f32 v251, v251, v46
    v_add_f32 v251, v251, v47
    v_mfma_f32_16x16x32_bf16 a[192:195], a[248:251], v[76:79], a[192:195]
    v_cvt_pk_bf16_f32 v38, v44, v45
    v_cvt_pk_bf16_f32 v39, v46, v47
    v_mfma_f32_16x16x32_bf16 a[196:199], a[252:255], v[4:7], a[196:199]
    ds_read_b128 a[232:235], v245 offset:33856
    v_exp_f32 v56, v56
    v_mfma_f32_16x16x32_bf16 a[200:203], a[252:255], v[16:19], a[200:203]
    s_sub_u32 s67, s67, s3
    v_exp_f32 v57, v57
    v_mfma_f32_16x16x32_bf16 a[204:207], a[252:255], v[28:31], a[204:207]
    v_exp_f32 v58, v58
    v_mfma_f32_16x16x32_bf16 a[208:211], a[252:255], v[40:43], a[208:211]
    v_exp_f32 v59, v59
    v_mfma_f32_16x16x32_bf16 a[212:215], a[252:255], v[52:55], a[212:215]
    v_add_f32 v252, v252, v56
    v_add_f32 v252, v252, v57
    v_mfma_f32_16x16x32_bf16 a[216:219], a[252:255], v[64:67], a[216:219]
    v_add_f32 v252, v252, v58
    v_add_f32 v252, v252, v59
    v_mfma_f32_16x16x32_bf16 a[220:223], a[252:255], v[76:79], a[220:223]
    s_waitcnt lgkmcnt(2)
    v_cvt_pk_bf16_f32 v50, v56, v57
    v_cvt_pk_bf16_f32 v51, v58, v59
    v_mfma_f32_16x16x32_bf16 v[4:7], a[224:227], v[96:99], 0
    ds_read_b128 a[236:239], v245 offset:33888
    v_exp_f32 v68, v68
    v_mfma_f32_16x16x32_bf16 v[16:19], a[224:227], v[112:115], 0
    v_exp_f32 v69, v69
    v_mfma_f32_16x16x32_bf16 v[28:31], a[224:227], v[128:131], 0
    s_mov_b32 m0, s67
    v_exp_f32 v70, v70
    v_mfma_f32_16x16x32_bf16 v[40:43], a[224:227], v[144:147], 0
    s_cmp_lt_u32 s66, 16
    s_cselect_b32 s50, 135168, 0
    v_exp_f32 v71, v71
    v_mfma_f32_16x16x32_bf16 v[52:55], a[224:227], v[160:163], 0
    s_waitcnt vmcnt(3)
    buffer_load_dwordx4 v240, s[48:51], s62 offen offset:0 nt lds
    v_add_f32 v253, v253, v68
    v_add_f32 v253, v253, v69
    v_mfma_f32_16x16x32_bf16 v[64:67], a[224:227], v[176:179], 0
    s_add_u32 s62, s62, 1024
    v_add_f32 v253, v253, v70
    v_add_f32 v253, v253, v71
    v_mfma_f32_16x16x32_bf16 v[76:79], a[224:227], v[192:195], 0
    s_waitcnt lgkmcnt(2)
    v_cvt_pk_bf16_f32 v62, v68, v69
    v_cvt_pk_bf16_f32 v63, v70, v71
    v_mfma_f32_16x16x32_bf16 v[4:7], a[228:231], v[100:103], v[4:7]
    ds_read_b128 a[240:243], v245 offset:34304
    v_exp_f32 v80, v80
    v_mfma_f32_16x16x32_bf16 v[16:19], a[228:231], v[116:119], v[16:19]
    s_and_b32 s62, s62, 0x1ffff
    v_exp_f32 v81, v81
    v_mfma_f32_16x16x32_bf16 v[28:31], a[228:231], v[132:135], v[28:31]
    v_exp_f32 v82, v82
    v_mfma_f32_16x16x32_bf16 v[40:43], a[228:231], v[148:151], v[40:43]
    v_exp_f32 v83, v83
    v_mfma_f32_16x16x32_bf16 v[52:55], a[228:231], v[164:167], v[52:55]
    v_add_f32 v254, v254, v80
    v_add_f32 v254, v254, v81
    v_mfma_f32_16x16x32_bf16 v[64:67], a[228:231], v[180:183], v[64:67]
    v_add_f32 v254, v254, v82
    v_add_f32 v254, v254, v83
    v_mfma_f32_16x16x32_bf16 v[76:79], a[228:231], v[196:199], v[76:79]
    s_waitcnt lgkmcnt(2)
    v_cvt_pk_bf16_f32 v74, v80, v81
    v_cvt_pk_bf16_f32 v75, v82, v83
    v_mfma_f32_16x16x32_bf16 v[4:7], a[232:235], v[104:107], v[4:7]
    ds_read_b128 a[244:247], v245 offset:34336
    v_add_u32 v246, s98, v246
    v_mfma_f32_16x16x32_bf16 v[16:19], a[232:235], v[120:123], v[16:19]
    v_mfma_f32_16x16x32_bf16 v[28:31], a[232:235], v[136:139], v[28:31]
    s_sub_u32 s98, 0, s98
    v_mfma_f32_16x16x32_bf16 v[40:43], a[232:235], v[152:155], v[40:43]
    s_waitcnt vmcnt(3)
    buffer_load_dwordx4 v241, s[48:51], s62 offen offset:1056 nt lds
    v_mfma_f32_16x16x32_bf16 v[52:55], a[232:235], v[168:171], v[52:55]
    s_add_u32 s62, s62, 1024
    v_mfma_f32_16x16x32_bf16 v[64:67], a[232:235], v[184:187], v[64:67]
    s_and_b32 s62, s62, 0x1ffff
    v_mfma_f32_16x16x32_bf16 v[76:79], a[232:235], v[200:203], v[76:79]
    s_waitcnt lgkmcnt(2)
    v_mfma_f32_16x16x32_bf16 v[4:7], a[236:239], v[108:111], v[4:7]
    ds_read_b128 a[248:251], v245 offset:34368
    v_mfma_f32_16x16x32_bf16 v[16:19], a[236:239], v[124:127], v[16:19]
    v_mfma_f32_16x16x32_bf16 v[28:31], a[236:239], v[140:143], v[28:31]
    v_mfma_f32_16x16x32_bf16 v[40:43], a[236:239], v[156:159], v[40:43]
    v_mfma_f32_16x16x32_bf16 v[52:55], a[236:239], v[172:175], v[52:55]
    v_mfma_f32_16x16x32_bf16 v[64:67], a[236:239], v[188:191], v[64:67]
    v_mfma_f32_16x16x32_bf16 v[76:79], a[236:239], v[204:207], v[76:79]
    s_waitcnt lgkmcnt(2)
    v_mfma_f32_16x16x32_bf16 v[8:11], a[240:243], v[96:99], 0
    ds_read_b128 a[252:255], v245 offset:34400
    v_exp_f32 v4, v4
    v_mfma_f32_16x16x32_bf16 v[20:23], a[240:243], v[112:115], 0
    v_exp_f32 v5, v5
    v_mfma_f32_16x16x32_bf16 v[32:35], a[240:243], v[128:131], 0
    s_waitcnt vmcnt(3)
    buffer_load_dwordx4 v242, s[48:51], s62 offen offset:2112 nt lds
    v_exp_f32 v6, v6
    v_mfma_f32_16x16x32_bf16 v[44:47], a[240:243], v[144:147], 0
    s_add_u32 s62, s62, 1024
    v_exp_f32 v7, v7
    v_mfma_f32_16x16x32_bf16 v[56:59], a[240:243], v[160:163], 0
    s_and_b32 s62, s62, 0x1ffff
    v_add_f32 v248, v248, v4
    v_add_f32 v248, v248, v5
    v_mfma_f32_16x16x32_bf16 v[68:71], a[240:243], v[176:179], 0
    v_add_f32 v248, v248, v6
    v_add_f32 v248, v248, v7
    v_mfma_f32_16x16x32_bf16 v[80:83], a[240:243], v[192:195], 0
    s_waitcnt lgkmcnt(2)
    v_cvt_pk_bf16_f32 v4, v4, v5
    v_cvt_pk_bf16_f32 v5, v6, v7
    v_mfma_f32_16x16x32_bf16 v[8:11], a[244:247], v[100:103], v[8:11]
    ds_read_b64_tr_b16 a[224:225], v246 offset:0
    v_exp_f32 v16, v16
    v_mfma_f32_16x16x32_bf16 v[20:23], a[244:247], v[116:119], v[20:23]
    ds_read_b64_tr_b16 a[226:227], v246 offset:512
    v_exp_f32 v17, v17
    v_mfma_f32_16x16x32_bf16 v[32:35], a[244:247], v[132:135], v[32:35]
    v_exp_f32 v18, v18
    v_mfma_f32_16x16x32_bf16 v[44:47], a[244:247], v[148:151], v[44:47]
    v_exp_f32 v19, v19
    v_mfma_f32_16x16x32_bf16 v[56:59], a[244:247], v[164:167], v[56:59]
    v_add_f32 v249, v249, v16
    v_add_f32 v249, v249, v17
    v_mfma_f32_16x16x32_bf16 v[68:71], a[244:247], v[180:183], v[68:71]
    v_add_f32 v249, v249, v18
    v_add_f32 v249, v249, v19
    v_mfma_f32_16x16x32_bf16 v[80:83], a[244:247], v[196:199], v[80:83]
    s_waitcnt lgkmcnt(3)
    v_cvt_pk_bf16_f32 v16, v16, v17
    v_cvt_pk_bf16_f32 v17, v18, v19
    v_mfma_f32_16x16x32_bf16 v[8:11], a[248:251], v[104:107], v[8:11]
    ds_read_b64_tr_b16 a[228:229], v246 offset:32
    v_exp_f32 v28, v28
    v_mfma_f32_16x16x32_bf16 v[20:23], a[248:251], v[120:123], v[20:23]
    ds_read_b64_tr_b16 a[230:231], v246 offset:544
    v_exp_f32 v29, v29
    v_mfma_f32_16x16x32_bf16 v[32:35], a[248:251], v[136:139], v[32:35]
    s_waitcnt vmcnt(3)
    buffer_load_dwordx4 v243, s[48:51], s62 offen offset:3168 nt lds
    v_exp_f32 v30, v30
    v_mfma_f32_16x16x32_bf16 v[44:47], a[248:251], v[152:155], v[44:47]
    s_add_u32 s62, s62, 1024
    v_exp_f32 v31, v31
    v_mfma_f32_16x16x32_bf16 v[56:59], a[248:251], v[168:171], v[56:59]
    s_and_b32 s62, s62, 0x1ffff
    v_add_f32 v250, v250, v28
    v_add_f32 v250, v250, v29
    v_mfma_f32_16x16x32_bf16 v[68:71], a[248:251], v[184:187], v[68:71]
    s_add_u32 m0, s67, 4224
    v_add_f32 v250, v250, v30
    v_add_f32 v250, v250, v31
    v_mfma_f32_16x16x32_bf16 v[80:83], a[248:251], v[200:203], v[80:83]
    s_waitcnt lgkmcnt(4)
    v_cvt_pk_bf16_f32 v28, v28, v29
    v_cvt_pk_bf16_f32 v29, v30, v31
    v_mfma_f32_16x16x32_bf16 v[8:11], a[252:255], v[108:111], v[8:11]
    ds_read_b64_tr_b16 a[232:233], v246 offset:64
    v_exp_f32 v40, v40
    v_mfma_f32_16x16x32_bf16 v[20:23], a[252:255], v[124:127], v[20:23]
    ds_read_b64_tr_b16 a[234:235], v246 offset:576
    v_exp_f32 v41, v41
    v_mfma_f32_16x16x32_bf16 v[32:35], a[252:255], v[140:143], v[32:35]
    v_exp_f32 v42, v42
    v_mfma_f32_16x16x32_bf16 v[44:47], a[252:255], v[156:159], v[44:47]
    v_exp_f32 v43, v43
    v_mfma_f32_16x16x32_bf16 v[56:59], a[252:255], v[172:175], v[56:59]
    v_add_f32 v251, v251, v40
    v_add_f32 v251, v251, v41
    v_mfma_f32_16x16x32_bf16 v[68:71], a[252:255], v[188:191], v[68:71]
    v_add_f32 v251, v251, v42
    v_add_f32 v251, v251, v43
    v_mfma_f32_16x16x32_bf16 v[80:83], a[252:255], v[204:207], v[80:83]
    s_waitcnt lgkmcnt(4)
    v_cvt_pk_bf16_f32 v40, v40, v41
    v_cvt_pk_bf16_f32 v41, v42, v43
    v_mfma_f32_16x16x32_bf16 a[0:3], a[224:227], v[0:3], a[0:3]
    ds_read_b64_tr_b16 a[236:237], v246 offset:96
    v_exp_f32 v52, v52
    v_mfma_f32_16x16x32_bf16 a[4:7], a[224:227], v[12:15], a[4:7]
    ds_read_b64_tr_b16 a[238:239], v246 offset:608
    v_exp_f32 v53, v53
    v_mfma_f32_16x16x32_bf16 a[8:11], a[224:227], v[24:27], a[8:11]
    s_waitcnt vmcnt(3)
    buffer_load_dwordx4 v240, s[48:51], s62 offen offset:0 nt lds
    v_exp_f32 v54, v54
    v_mfma_f32_16x16x32_bf16 a[12:15], a[224:227], v[36:39], a[12:15]
    s_add_u32 s62, s62, 1024
    v_exp_f32 v55, v55
    v_mfma_f32_16x16x32_bf16 a[16:19], a[224:227], v[48:51], a[16:19]
    s_and_b32 s62, s62, 0x1ffff
    v_add_f32 v252, v252, v52
    v_add_f32 v252, v252, v53
    v_mfma_f32_16x16x32_bf16 a[20:23], a[224:227], v[60:63], a[20:23]
    v_add_f32 v252, v252, v54
    v_add_f32 v252, v252, v55
    v_mfma_f32_16x16x32_bf16 a[24:27], a[224:227], v[72:75], a[24:27]
    s_waitcnt lgkmcnt(4)
    v_cvt_pk_bf16_f32 v52, v52, v53
    v_cvt_pk_bf16_f32 v53, v54, v55
    v_mfma_f32_16x16x32_bf16 a[28:31], a[228:231], v[0:3], a[28:31]
    ds_read_b64_tr_b16 a[240:241], v246 offset:128
    v_exp_f32 v64, v64
    v_mfma_f32_16x16x32_bf16 a[32:35], a[228:231], v[12:15], a[32:35]
    ds_read_b64_tr_b16 a[242:243], v246 offset:640
    v_exp_f32 v65, v65
    v_mfma_f32_16x16x32_bf16 a[36:39], a[228:231], v[24:27], a[36:39]
    v_exp_f32 v66, v66
    v_mfma_f32_16x16x32_bf16 a[40:43], a[228:231], v[36:39], a[40:43]
    v_exp_f32 v67, v67
    v_mfma_f32_16x16x32_bf16 a[44:47], a[228:231], v[48:51], a[44:47]
    v_add_f32 v253, v253, v64
    v_add_f32 v253, v253, v65
    v_mfma_f32_16x16x32_bf16 a[48:51], a[228:231], v[60:63], a[48:51]
    v_add_f32 v253, v253, v66
    v_add_f32 v253, v253, v67
    v_mfma_f32_16x16x32_bf16 a[52:55], a[228:231], v[72:75], a[52:55]
    s_waitcnt lgkmcnt(4)
    v_cvt_pk_bf16_f32 v64, v64, v65
    v_cvt_pk_bf16_f32 v65, v66, v67
    v_mfma_f32_16x16x32_bf16 a[56:59], a[232:235], v[0:3], a[56:59]
    ds_read_b64_tr_b16 a[244:245], v246 offset:160
    v_exp_f32 v76, v76
    v_mfma_f32_16x16x32_bf16 a[60:63], a[232:235], v[12:15], a[60:63]
    ds_read_b64_tr_b16 a[246:247], v246 offset:672
    v_exp_f32 v77, v77
    v_mfma_f32_16x16x32_bf16 a[64:67], a[232:235], v[24:27], a[64:67]
    s_waitcnt vmcnt(3)
    buffer_load_dwordx4 v241, s[48:51], s62 offen offset:1056 nt lds
    v_exp_f32 v78, v78
    v_mfma_f32_16x16x32_bf16 a[68:71], a[232:235], v[36:39], a[68:71]
    s_add_u32 s62, s62, 1024
    v_exp_f32 v79, v79
    v_mfma_f32_16x16x32_bf16 a[72:75], a[232:235], v[48:51], a[72:75]
    s_and_b32 s62, s62, 0x1ffff
    v_add_f32 v254, v254, v76
    v_add_f32 v254, v254, v77
    v_mfma_f32_16x16x32_bf16 a[76:79], a[232:235], v[60:63], a[76:79]
    v_add_f32 v254, v254, v78
    v_add_f32 v254, v254, v79
    v_mfma_f32_16x16x32_bf16 a[80:83], a[232:235], v[72:75], a[80:83]
    s_waitcnt lgkmcnt(4)
    v_cvt_pk_bf16_f32 v76, v76, v77
    v_cvt_pk_bf16_f32 v77, v78, v79
    v_mfma_f32_16x16x32_bf16 a[84:87], a[236:239], v[0:3], a[84:87]
    ds_read_b64_tr_b16 a[248:249], v246 offset:192
    v_exp_f32 v8, v8
    v_mfma_f32_16x16x32_bf16 a[88:91], a[236:239], v[12:15], a[88:91]
    ds_read_b64_tr_b16 a[250:251], v246 offset:704
    v_exp_f32 v9, v9
    v_mfma_f32_16x16x32_bf16 a[92:95], a[236:239], v[24:27], a[92:95]
    v_exp_f32 v10, v10
    v_mfma_f32_16x16x32_bf16 a[96:99], a[236:239], v[36:39], a[96:99]
    v_exp_f32 v11, v11
    v_mfma_f32_16x16x32_bf16 a[100:103], a[236:239], v[48:51], a[100:103]
    v_add_f32 v248, v248, v8
    v_add_f32 v248, v248, v9
    v_mfma_f32_16x16x32_bf16 a[104:107], a[236:239], v[60:63], a[104:107]
    s_waitcnt vmcnt(3)
    buffer_load_dwordx4 v242, s[48:51], s62 offen offset:2112 nt lds
    v_add_f32 v248, v248, v10
    v_add_f32 v248, v248, v11
    v_mfma_f32_16x16x32_bf16 a[108:111], a[236:239], v[72:75], a[108:111]
    s_waitcnt lgkmcnt(4)
    v_cvt_pk_bf16_f32 v6, v8, v9
    v_cvt_pk_bf16_f32 v7, v10, v11
    v_mfma_f32_16x16x32_bf16 a[112:115], a[240:243], v[0:3], a[112:115]
    ds_read_b64_tr_b16 a[252:253], v246 offset:224
    v_exp_f32 v20, v20
    v_mfma_f32_16x16x32_bf16 a[116:119], a[240:243], v[12:15], a[116:119]
    ds_read_b64_tr_b16 a[254:255], v246 offset:736
    v_exp_f32 v21, v21
    v_mfma_f32_16x16x32_bf16 a[120:123], a[240:243], v[24:27], a[120:123]
    s_add_u32 s62, s62, 1024
    v_exp_f32 v22, v22
    v_mfma_f32_16x16x32_bf16 a[124:127], a[240:243], v[36:39], a[124:127]
    s_and_b32 s62, s62, 0x1ffff
    v_exp_f32 v23, v23
    v_mfma_f32_16x16x32_bf16 a[128:131], a[240:243], v[48:51], a[128:131]
    v_add_f32 v249, v249, v20
    v_add_f32 v249, v249, v21
    v_mfma_f32_16x16x32_bf16 a[132:135], a[240:243], v[60:63], a[132:135]
    v_add_f32 v249, v249, v22
    v_add_f32 v249, v249, v23
    v_mfma_f32_16x16x32_bf16 a[136:139], a[240:243], v[72:75], a[136:139]
    s_waitcnt vmcnt(15) lgkmcnt(0)
    s_barrier
    v_add_u32 v245, s98, v245
    v_cvt_pk_bf16_f32 v18, v20, v21
    v_cvt_pk_bf16_f32 v19, v22, v23
    v_mfma_f32_16x16x32_bf16 a[140:143], a[244:247], v[0:3], a[140:143]
    ds_read_b128 a[224:227], v245 offset:0
    v_exp_f32 v32, v32
    v_mfma_f32_16x16x32_bf16 a[144:147], a[244:247], v[12:15], a[144:147]
    v_exp_f32 v33, v33
    v_mfma_f32_16x16x32_bf16 a[148:151], a[244:247], v[24:27], a[148:151]
    v_exp_f32 v34, v34
    v_mfma_f32_16x16x32_bf16 a[152:155], a[244:247], v[36:39], a[152:155]
    v_exp_f32 v35, v35
    v_mfma_f32_16x16x32_bf16 a[156:159], a[244:247], v[48:51], a[156:159]
    v_add_f32 v250, v250, v32
    v_add_f32 v250, v250, v33
    v_mfma_f32_16x16x32_bf16 a[160:163], a[244:247], v[60:63], a[160:163]
    s_waitcnt vmcnt(3)
    buffer_load_dwordx4 v243, s[48:51], s62 offen offset:3168 nt lds
    v_add_f32 v250, v250, v34
    v_add_f32 v250, v250, v35
    v_mfma_f32_16x16x32_bf16 a[164:167], a[244:247], v[72:75], a[164:167]
    v_cvt_pk_bf16_f32 v30, v32, v33
    v_cvt_pk_bf16_f32 v31, v34, v35
    v_mfma_f32_16x16x32_bf16 a[168:171], a[248:251], v[0:3], a[168:171]
    ds_read_b128 a[228:231], v245 offset:32
    v_exp_f32 v44, v44
    v_mfma_f32_16x16x32_bf16 a[172:175], a[248:251], v[12:15], a[172:175]
    s_add_u32 s62, s62, 1024
    v_exp_f32 v45, v45
    v_mfma_f32_16x16x32_bf16 a[176:179], a[248:251], v[24:27], a[176:179]
    s_and_b32 s62, s62, 0x1ffff
    v_exp_f32 v46, v46
    v_mfma_f32_16x16x32_bf16 a[180:183], a[248:251], v[36:39], a[180:183]
    s_add_u32 s66, s66, 1
    v_exp_f32 v47, v47
    v_mfma_f32_16x16x32_bf16 a[184:187], a[248:251], v[48:51], a[184:187]
    s_add_u32 s67, s67, 33792
    v_add_f32 v251, v251, v44
    v_add_f32 v251, v251, v45
    v_mfma_f32_16x16x32_bf16 a[188:191], a[248:251], v[60:63], a[188:191]
    s_cmp_eq_u32 s67, s68
    s_cselect_b32 s3, 135168, 0
    v_add_f32 v251, v251, v46
    v_add_f32 v251, v251, v47
    v_mfma_f32_16x16x32_bf16 a[192:195], a[248:251], v[72:75], a[192:195]
    v_cvt_pk_bf16_f32 v42, v44, v45
    v_cvt_pk_bf16_f32 v43, v46, v47
    v_mfma_f32_16x16x32_bf16 a[196:199], a[252:255], v[0:3], a[196:199]
    ds_read_b128 a[232:235], v245 offset:64
    v_exp_f32 v56, v56
    v_mfma_f32_16x16x32_bf16 a[200:203], a[252:255], v[12:15], a[200:203]
    s_sub_u32 s67, s67, s3
    v_exp_f32 v57, v57
    v_mfma_f32_16x16x32_bf16 a[204:207], a[252:255], v[24:27], a[204:207]
    v_exp_f32 v58, v58
    v_mfma_f32_16x16x32_bf16 a[208:211], a[252:255], v[36:39], a[208:211]
    v_exp_f32 v59, v59
    v_mfma_f32_16x16x32_bf16 a[212:215], a[252:255], v[48:51], a[212:215]
    v_add_f32 v252, v252, v56
    v_add_f32 v252, v252, v57
    v_mfma_f32_16x16x32_bf16 a[216:219], a[252:255], v[60:63], a[216:219]
    v_add_f32 v252, v252, v58
    v_add_f32 v252, v252, v59
    v_mfma_f32_16x16x32_bf16 a[220:223], a[252:255], v[72:75], a[220:223]
    s_waitcnt lgkmcnt(2)
    v_cvt_pk_bf16_f32 v54, v56, v57
    v_cvt_pk_bf16_f32 v55, v58, v59
    s_add_u32 s99, s99, 1
    s_cmp_lt_u32 s99, 6
    s_cbranch_scc1 L_loop
    v_mfma_f32_16x16x32_bf16 v[0:3], a[224:227], v[96:99], 0
    ds_read_b128 a[236:239], v245 offset:96
    v_exp_f32 v68, v68
    v_mfma_f32_16x16x32_bf16 v[12:15], a[224:227], v[112:115], 0
    v_exp_f32 v69, v69
    v_mfma_f32_16x16x32_bf16 v[24:27], a[224:227], v[128:131], 0
    v_exp_f32 v70, v70
    v_mfma_f32_16x16x32_bf16 v[36:39], a[224:227], v[144:147], 0
    buffer_load_dword v231, v228, s[16:19], s22 offen
    v_exp_f32 v71, v71
    v_mfma_f32_16x16x32_bf16 v[48:51], a[224:227], v[160:163], 0
    v_add_f32 v253, v253, v68
    v_add_f32 v253, v253, v69
    v_mfma_f32_16x16x32_bf16 v[60:63], a[224:227], v[176:179], 0
    v_add_f32 v253, v253, v70
    v_add_f32 v253, v253, v71
    v_mfma_f32_16x16x32_bf16 v[72:75], a[224:227], v[192:195], 0
    s_waitcnt lgkmcnt(2)
    v_cvt_pk_bf16_f32 v66, v68, v69
    v_cvt_pk_bf16_f32 v67, v70, v71
    v_mfma_f32_16x16x32_bf16 v[0:3], a[228:231], v[100:103], v[0:3]
    ds_read_b128 a[240:243], v245 offset:512
    v_exp_f32 v80, v80
    v_mfma_f32_16x16x32_bf16 v[12:15], a[228:231], v[116:119], v[12:15]
    v_exp_f32 v81, v81
    v_mfma_f32_16x16x32_bf16 v[24:27], a[228:231], v[132:135], v[24:27]
    v_exp_f32 v82, v82
    v_mfma_f32_16x16x32_bf16 v[36:39], a[228:231], v[148:151], v[36:39]
    buffer_load_dword v231, v244, s[44:47], 0 offen
    v_exp_f32 v83, v83
    v_mfma_f32_16x16x32_bf16 v[48:51], a[228:231], v[164:167], v[48:51]
    v_add_f32 v254, v254, v80
    v_add_f32 v254, v254, v81
    v_mfma_f32_16x16x32_bf16 v[60:63], a[228:231], v[180:183], v[60:63]
    v_add_f32 v254, v254, v82
    v_add_f32 v254, v254, v83
    v_mfma_f32_16x16x32_bf16 v[72:75], a[228:231], v[196:199], v[72:75]
    s_waitcnt lgkmcnt(2)
    v_cvt_pk_bf16_f32 v78, v80, v81
    v_cvt_pk_bf16_f32 v79, v82, v83
    v_mfma_f32_16x16x32_bf16 v[0:3], a[232:235], v[104:107], v[0:3]
    ds_read_b128 a[244:247], v245 offset:544
    v_mfma_f32_16x16x32_bf16 v[12:15], a[232:235], v[120:123], v[12:15]
    v_mfma_f32_16x16x32_bf16 v[24:27], a[232:235], v[136:139], v[24:27]
    v_mfma_f32_16x16x32_bf16 v[36:39], a[232:235], v[152:155], v[36:39]
    v_mfma_f32_16x16x32_bf16 v[48:51], a[232:235], v[168:171], v[48:51]
    v_mfma_f32_16x16x32_bf16 v[60:63], a[232:235], v[184:187], v[60:63]
    v_mfma_f32_16x16x32_bf16 v[72:75], a[232:235], v[200:203], v[72:75]
    s_waitcnt lgkmcnt(2)
    v_mfma_f32_16x16x32_bf16 v[0:3], a[236:239], v[108:111], v[0:3]
    ds_read_b128 a[248:251], v245 offset:576
    v_mfma_f32_16x16x32_bf16 v[12:15], a[236:239], v[124:127], v[12:15]
    v_mfma_f32_16x16x32_bf16 v[24:27], a[236:239], v[140:143], v[24:27]
    v_mfma_f32_16x16x32_bf16 v[36:39], a[236:239], v[156:159], v[36:39]
    buffer_load_dword v231, v244, s[44:47], s100 offen
    v_mfma_f32_16x16x32_bf16 v[48:51], a[236:239], v[172:175], v[48:51]
    v_mfma_f32_16x16x32_bf16 v[60:63], a[236:239], v[188:191], v[60:63]
    v_mfma_f32_16x16x32_bf16 v[72:75], a[236:239], v[204:207], v[72:75]
    s_waitcnt lgkmcnt(2)
    v_mfma_f32_16x16x32_bf16 v[8:11], a[240:243], v[96:99], 0
    ds_read_b128 a[252:255], v245 offset:608
    v_exp_f32 v0, v0
    v_mfma_f32_16x16x32_bf16 v[20:23], a[240:243], v[112:115], 0
    v_exp_f32 v1, v1
    v_mfma_f32_16x16x32_bf16 v[32:35], a[240:243], v[128:131], 0
    v_exp_f32 v2, v2
    v_mfma_f32_16x16x32_bf16 v[44:47], a[240:243], v[144:147], 0
    v_exp_f32 v3, v3
    v_mfma_f32_16x16x32_bf16 v[56:59], a[240:243], v[160:163], 0
    v_add_f32 v248, v248, v0
    v_add_f32 v248, v248, v1
    v_mfma_f32_16x16x32_bf16 v[68:71], a[240:243], v[176:179], 0
    v_add_f32 v248, v248, v2
    v_add_f32 v248, v248, v3
    v_mfma_f32_16x16x32_bf16 v[80:83], a[240:243], v[192:195], 0
    s_waitcnt lgkmcnt(2)
    v_cvt_pk_bf16_f32 v0, v0, v1
    v_cvt_pk_bf16_f32 v1, v2, v3
    v_mfma_f32_16x16x32_bf16 v[8:11], a[244:247], v[100:103], v[8:11]
    ds_read_b64_tr_b16 a[224:225], v246 offset:33792
    v_exp_f32 v12, v12
    v_mfma_f32_16x16x32_bf16 v[20:23], a[244:247], v[116:119], v[20:23]
    ds_read_b64_tr_b16 a[226:227], v246 offset:34304
    v_exp_f32 v13, v13
    v_mfma_f32_16x16x32_bf16 v[32:35], a[244:247], v[132:135], v[32:35]
    v_exp_f32 v14, v14
    v_mfma_f32_16x16x32_bf16 v[44:47], a[244:247], v[148:151], v[44:47]
    v_exp_f32 v15, v15
    v_mfma_f32_16x16x32_bf16 v[56:59], a[244:247], v[164:167], v[56:59]
    v_add_f32 v249, v249, v12
    v_add_f32 v249, v249, v13
    v_mfma_f32_16x16x32_bf16 v[68:71], a[244:247], v[180:183], v[68:71]
    buffer_atomic_add v234, v235, s[76:79], s75 offen sc1
    v_add_f32 v249, v249, v14
    v_add_f32 v249, v249, v15
    v_mfma_f32_16x16x32_bf16 v[80:83], a[244:247], v[196:199], v[80:83]
    s_waitcnt lgkmcnt(3)
    v_cvt_pk_bf16_f32 v12, v12, v13
    v_cvt_pk_bf16_f32 v13, v14, v15
    v_mfma_f32_16x16x32_bf16 v[8:11], a[248:251], v[104:107], v[8:11]
    ds_read_b64_tr_b16 a[228:229], v246 offset:33824
    v_exp_f32 v24, v24
    v_mfma_f32_16x16x32_bf16 v[20:23], a[248:251], v[120:123], v[20:23]
    ds_read_b64_tr_b16 a[230:231], v246 offset:34336
    v_exp_f32 v25, v25
    v_mfma_f32_16x16x32_bf16 v[32:35], a[248:251], v[136:139], v[32:35]
    v_exp_f32 v26, v26
    v_mfma_f32_16x16x32_bf16 v[44:47], a[248:251], v[152:155], v[44:47]
    v_exp_f32 v27, v27
    v_mfma_f32_16x16x32_bf16 v[56:59], a[248:251], v[168:171], v[56:59]
    v_add_f32 v250, v250, v24
    v_add_f32 v250, v250, v25
    v_mfma_f32_16x16x32_bf16 v[68:71], a[248:251], v[184:187], v[68:71]
    v_add_f32 v250, v250, v26
    v_add_f32 v250, v250, v27
    v_mfma_f32_16x16x32_bf16 v[80:83], a[248:251], v[200:203], v[80:83]
    s_waitcnt lgkmcnt(4)
    v_cvt_pk_bf16_f32 v24, v24, v25
    v_cvt_pk_bf16_f32 v25, v26, v27
    v_mfma_f32_16x16x32_bf16 v[8:11], a[252:255], v[108:111], v[8:11]
    ds_read_b64_tr_b16 a[232:233], v246 offset:33856
    v_exp_f32 v36, v36
    v_mfma_f32_16x16x32_bf16 v[20:23], a[252:255], v[124:127], v[20:23]
    ds_read_b64_tr_b16 a[234:235], v246 offset:34368
    v_exp_f32 v37, v37
    v_mfma_f32_16x16x32_bf16 v[32:35], a[252:255], v[140:143], v[32:35]
    v_exp_f32 v38, v38
    v_mfma_f32_16x16x32_bf16 v[44:47], a[252:255], v[156:159], v[44:47]
    v_exp_f32 v39, v39
    v_mfma_f32_16x16x32_bf16 v[56:59], a[252:255], v[172:175], v[56:59]
    v_add_f32 v251, v251, v36
    v_add_f32 v251, v251, v37
    v_mfma_f32_16x16x32_bf16 v[68:71], a[252:255], v[188:191], v[68:71]
    v_add_f32 v251, v251, v38
    v_add_f32 v251, v251, v39
    v_mfma_f32_16x16x32_bf16 v[80:83], a[252:255], v[204:207], v[80:83]
    s_waitcnt lgkmcnt(4)
    v_cvt_pk_bf16_f32 v36, v36, v37
    v_cvt_pk_bf16_f32 v37, v38, v39
    v_mfma_f32_16x16x32_bf16 a[0:3], a[224:227], v[4:7], a[0:3]
    ds_read_b64_tr_b16 a[236:237], v246 offset:33888
    v_exp_f32 v48, v48
    v_mfma_f32_16x16x32_bf16 a[4:7], a[224:227], v[16:19], a[4:7]
    ds_read_b64_tr_b16 a[238:239], v246 offset:34400
    v_exp_f32 v49, v49
    v_mfma_f32_16x16x32_bf16 a[8:11], a[224:227], v[28:31], a[8:11]
    v_exp_f32 v50, v50
    v_mfma_f32_16x16x32_bf16 a[12:15], a[224:227], v[40:43], a[12:15]
    v_exp_f32 v51, v51
    v_mfma_f32_16x16x32_bf16 a[16:19], a[224:227], v[52:55], a[16:19]
    v_add_f32 v252, v252, v48
    v_add_f32 v252, v252, v49
    v_mfma_f32_16x16x32_bf16 a[20:23], a[224:227], v[64:67], a[20:23]
    v_add_f32 v252, v252, v50
    v_add_f32 v252, v252, v51
    v_mfma_f32_16x16x32_bf16 a[24:27], a[224:227], v[76:79], a[24:27]
    s_waitcnt lgkmcnt(4)
    v_cvt_pk_bf16_f32 v48, v48, v49
    v_cvt_pk_bf16_f32 v49, v50, v51
    v_mfma_f32_16x16x32_bf16 a[28:31], a[228:231], v[4:7], a[28:31]
    ds_read_b64_tr_b16 a[240:241], v246 offset:33920
    v_exp_f32 v60, v60
    v_mfma_f32_16x16x32_bf16 a[32:35], a[228:231], v[16:19], a[32:35]
    ds_read_b64_tr_b16 a[242:243], v246 offset:34432
    v_exp_f32 v61, v61
    v_mfma_f32_16x16x32_bf16 a[36:39], a[228:231], v[28:31], a[36:39]
    v_exp_f32 v62, v62
    v_mfma_f32_16x16x32_bf16 a[40:43], a[228:231], v[40:43], a[40:43]
    v_exp_f32 v63, v63
    v_mfma_f32_16x16x32_bf16 a[44:47], a[228:231], v[52:55], a[44:47]
    v_add_f32 v253, v253, v60
    v_add_f32 v253, v253, v61
    v_mfma_f32_16x16x32_bf16 a[48:51], a[228:231], v[64:67], a[48:51]
    v_add_f32 v253, v253, v62
    v_add_f32 v253, v253, v63
    v_mfma_f32_16x16x32_bf16 a[52:55], a[228:231], v[76:79], a[52:55]
    s_waitcnt lgkmcnt(4)
    v_cvt_pk_bf16_f32 v60, v60, v61
    v_cvt_pk_bf16_f32 v61, v62, v63
    v_mfma_f32_16x16x32_bf16 a[56:59], a[232:235], v[4:7], a[56:59]
    ds_read_b64_tr_b16 a[244:245], v246 offset:33952
    v_exp_f32 v72, v72
    v_mfma_f32_16x16x32_bf16 a[60:63], a[232:235], v[16:19], a[60:63]
    ds_read_b64_tr_b16 a[246:247], v246 offset:34464
    v_exp_f32 v73, v73
    v_mfma_f32_16x16x32_bf16 a[64:67], a[232:235], v[28:31], a[64:67]
    v_exp_f32 v74, v74
    v_mfma_f32_16x16x32_bf16 a[68:71], a[232:235], v[40:43], a[68:71]
    v_exp_f32 v75, v75
    v_mfma_f32_16x16x32_bf16 a[72:75], a[232:235], v[52:55], a[72:75]
    v_add_f32 v254, v254, v72
    v_add_f32 v254, v254, v73
    v_mfma_f32_16x16x32_bf16 a[76:79], a[232:235], v[64:67], a[76:79]
    v_add_f32 v254, v254, v74
    v_add_f32 v254, v254, v75
    v_mfma_f32_16x16x32_bf16 a[80:83], a[232:235], v[76:79], a[80:83]
    s_waitcnt lgkmcnt(4)
    v_cvt_pk_bf16_f32 v72, v72, v73
    v_cvt_pk_bf16_f32 v73, v74, v75
    v_mfma_f32_16x16x32_bf16 a[84:87], a[236:239], v[4:7], a[84:87]
    ds_read_b64_tr_b16 a[248:249], v246 offset:33984
    v_exp_f32 v8, v8
    v_mfma_f32_16x16x32_bf16 a[88:91], a[236:239], v[16:19], a[88:91]
    ds_read_b64_tr_b16 a[250:251], v246 offset:34496
    v_exp_f32 v9, v9
    v_mfma_f32_16x16x32_bf16 a[92:95], a[236:239], v[28:31], a[92:95]
    v_exp_f32 v10, v10
    v_mfma_f32_16x16x32_bf16 a[96:99], a[236:239], v[40:43], a[96:99]
    v_exp_f32 v11, v11
    v_mfma_f32_16x16x32_bf16 a[100:103], a[236:239], v[52:55], a[100:103]
    v_add_f32 v248, v248, v8
    v_add_f32 v248, v248, v9
    v_mfma_f32_16x16x32_bf16 a[104:107], a[236:239], v[64:67], a[104:107]
    v_add_f32 v248, v248, v10
    v_add_f32 v248, v248, v11
    v_mfma_f32_16x16x32_bf16 a[108:111], a[236:239], v[76:79], a[108:111]
    s_waitcnt lgkmcnt(4)
    v_cvt_pk_bf16_f32 v2, v8, v9
    v_cvt_pk_bf16_f32 v3, v10, v11
    v_mfma_f32_16x16x32_bf16 a[112:115], a[240:243], v[4:7], a[112:115]
    ds_read_b64_tr_b16 a[252:253], v246 offset:34016
    v_exp_f32 v20, v20
    v_mfma_f32_16x16x32_bf16 a[116:119], a[240:243], v[16:19], a[116:119]
    ds_read_b64_tr_b16 a[254:255], v246 offset:34528
    v_exp_f32 v21, v21
    v_mfma_f32_16x16x32_bf16 a[120:123], a[240:243], v[28:31], a[120:123]
    v_exp_f32 v22, v22
    v_mfma_f32_16x16x32_bf16 a[124:127], a[240:243], v[40:43], a[124:127]
    v_exp_f32 v23, v23
    v_mfma_f32_16x16x32_bf16 a[128:131], a[240:243], v[52:55], a[128:131]
    v_add_f32 v249, v249, v20
    v_add_f32 v249, v249, v21
    v_mfma_f32_16x16x32_bf16 a[132:135], a[240:243], v[64:67], a[132:135]
    v_add_f32 v249, v249, v22
    v_add_f32 v249, v249, v23
    v_mfma_f32_16x16x32_bf16 a[136:139], a[240:243], v[76:79], a[136:139]
    s_waitcnt vmcnt(12) lgkmcnt(0)
    s_barrier
    v_cvt_pk_bf16_f32 v14, v20, v21
    v_cvt_pk_bf16_f32 v15, v22, v23
    v_mfma_f32_16x16x32_bf16 a[140:143], a[244:247], v[4:7], a[140:143]
    ds_read_b128 a[224:227], v245 offset:33792
    v_exp_f32 v32, v32
    v_mfma_f32_16x16x32_bf16 a[144:147], a[244:247], v[16:19], a[144:147]
    v_exp_f32 v33, v33
    v_mfma_f32_16x16x32_bf16 a[148:151], a[244:247], v[28:31], a[148:151]
    v_exp_f32 v34, v34
    v_mfma_f32_16x16x32_bf16 a[152:155], a[244:247], v[40:43], a[152:155]
    v_exp_f32 v35, v35
    v_mfma_f32_16x16x32_bf16 a[156:159], a[244:247], v[52:55], a[156:159]
    v_add_f32 v250, v250, v32
    v_add_f32 v250, v250, v33
    v_mfma_f32_16x16x32_bf16 a[160:163], a[244:247], v[64:67], a[160:163]
    v_add_f32 v250, v250, v34
    v_add_f32 v250, v250, v35
    v_mfma_f32_16x16x32_bf16 a[164:167], a[244:247], v[76:79], a[164:167]
    v_cvt_pk_bf16_f32 v26, v32, v33
    v_cvt_pk_bf16_f32 v27, v34, v35
    v_mfma_f32_16x16x32_bf16 a[168:171], a[248:251], v[4:7], a[168:171]
    ds_read_b128 a[228:231], v245 offset:33824
    v_exp_f32 v44, v44
    v_mfma_f32_16x16x32_bf16 a[172:175], a[248:251], v[16:19], a[172:175]
    v_exp_f32 v45, v45
    v_mfma_f32_16x16x32_bf16 a[176:179], a[248:251], v[28:31], a[176:179]
    v_exp_f32 v46, v46
    v_mfma_f32_16x16x32_bf16 a[180:183], a[248:251], v[40:43], a[180:183]
    v_exp_f32 v47, v47
    v_mfma_f32_16x16x32_bf16 a[184:187], a[248:251], v[52:55], a[184:187]
    v_add_f32 v251, v251, v44
    v_add_f32 v251, v251, v45
    v_mfma_f32_16x16x32_bf16 a[188:191], a[248:251], v[64:67], a[188:191]
    v_add_f32 v251, v251, v46
    v_add_f32 v251, v251, v47
    v_mfma_f32_16x16x32_bf16 a[192:195], a[248:251], v[76:79], a[192:195]
    v_cvt_pk_bf16_f32 v38, v44, v45
    v_cvt_pk_bf16_f32 v39, v46, v47
    v_mfma_f32_16x16x32_bf16 a[196:199], a[252:255], v[4:7], a[196:199]
    ds_read_b128 a[232:235], v245 offset:33856
    v_exp_f32 v56, v56
    v_mfma_f32_16x16x32_bf16 a[200:203], a[252:255], v[16:19], a[200:203]
    v_exp_f32 v57, v57
    v_mfma_f32_16x16x32_bf16 a[204:207], a[252:255], v[28:31], a[204:207]
    v_exp_f32 v58, v58
    v_mfma_f32_16x16x32_bf16 a[208:211], a[252:255], v[40:43], a[208:211]
    v_exp_f32 v59, v59
    v_mfma_f32_16x16x32_bf16 a[212:215], a[252:255], v[52:55], a[212:215]
    v_add_f32 v252, v252, v56
    v_add_f32 v252, v252, v57
    v_mfma_f32_16x16x32_bf16 a[216:219], a[252:255], v[64:67], a[216:219]
    v_add_f32 v252, v252, v58
    v_add_f32 v252, v252, v59
    v_mfma_f32_16x16x32_bf16 a[220:223], a[252:255], v[76:79], a[220:223]
    s_waitcnt lgkmcnt(2)
    v_cvt_pk_bf16_f32 v50, v56, v57
    v_cvt_pk_bf16_f32 v51, v58, v59
    v_mfma_f32_16x16x32_bf16 v[4:7], a[224:227], v[96:99], 0
    ds_read_b128 a[236:239], v245 offset:33888
    v_exp_f32 v68, v68
    v_mfma_f32_16x16x32_bf16 v[16:19], a[224:227], v[112:115], 0
    v_exp_f32 v69, v69
    v_mfma_f32_16x16x32_bf16 v[28:31], a[224:227], v[128:131], 0
    v_exp_f32 v70, v70
    v_mfma_f32_16x16x32_bf16 v[40:43], a[224:227], v[144:147], 0
    v_exp_f32 v71, v71
    v_mfma_f32_16x16x32_bf16 v[52:55], a[224:227], v[160:163], 0
    v_add_f32 v253, v253, v68
    v_add_f32 v253, v253, v69
    v_mfma_f32_16x16x32_bf16 v[64:67], a[224:227], v[176:179], 0
    v_add_f32 v253, v253, v70
    v_add_f32 v253, v253, v71
    v_mfma_f32_16x16x32_bf16 v[76:79], a[224:227], v[192:195], 0
    s_waitcnt lgkmcnt(2)
    v_cvt_pk_bf16_f32 v62, v68, v69
    v_cvt_pk_bf16_f32 v63, v70, v71
    v_mfma_f32_16x16x32_bf16 v[4:7], a[228:231], v[100:103], v[4:7]
    ds_read_b128 a[240:243], v245 offset:34304
    v_exp_f32 v80, v80
    v_mfma_f32_16x16x32_bf16 v[16:19], a[228:231], v[116:119], v[16:19]
    v_exp_f32 v81, v81
    v_mfma_f32_16x16x32_bf16 v[28:31], a[228:231], v[132:135], v[28:31]
    v_exp_f32 v82, v82
    v_mfma_f32_16x16x32_bf16 v[40:43], a[228:231], v[148:151], v[40:43]
    v_exp_f32 v83, v83
    v_mfma_f32_16x16x32_bf16 v[52:55], a[228:231], v[164:167], v[52:55]
    v_add_f32 v254, v254, v80
    v_add_f32 v254, v254, v81
    v_mfma_f32_16x16x32_bf16 v[64:67], a[228:231], v[180:183], v[64:67]
    v_add_f32 v254, v254, v82
    v_add_f32 v254, v254, v83
    v_mfma_f32_16x16x32_bf16 v[76:79], a[228:231], v[196:199], v[76:79]
    s_waitcnt lgkmcnt(2)
    v_cvt_pk_bf16_f32 v74, v80, v81
    v_cvt_pk_bf16_f32 v75, v82, v83
    v_mfma_f32_16x16x32_bf16 v[4:7], a[232:235], v[104:107], v[4:7]
    ds_read_b128 a[244:247], v245 offset:34336
    v_add_u32 v246, s98, v246
    v_mfma_f32_16x16x32_bf16 v[16:19], a[232:235], v[120:123], v[16:19]
    v_mfma_f32_16x16x32_bf16 v[28:31], a[232:235], v[136:139], v[28:31]
    s_sub_u32 s98, 0, s98
    v_mfma_f32_16x16x32_bf16 v[40:43], a[232:235], v[152:155], v[40:43]
    v_mfma_f32_16x16x32_bf16 v[52:55], a[232:235], v[168:171], v[52:55]
    v_mfma_f32_16x16x32_bf16 v[64:67], a[232:235], v[184:187], v[64:67]
    v_mfma_f32_16x16x32_bf16 v[76:79], a[232:235], v[200:203], v[76:79]
    s_waitcnt lgkmcnt(2)
    v_mfma_f32_16x16x32_bf16 v[4:7], a[236:239], v[108:111], v[4:7]
    ds_read_b128 a[248:251], v245 offset:34368
    v_mfma_f32_16x16x32_bf16 v[16:19], a[236:239], v[124:127], v[16:19]
    v_mfma_f32_16x16x32_bf16 v[28:31], a[236:239], v[140:143], v[28:31]
    v_mfma_f32_16x16x32_bf16 v[40:43], a[236:239], v[156:159], v[40:43]
    v_mfma_f32_16x16x32_bf16 v[52:55], a[236:239], v[172:175], v[52:55]
    v_mfma_f32_16x16x32_bf16 v[64:67], a[236:239], v[188:191], v[64:67]
    v_mfma_f32_16x16x32_bf16 v[76:79], a[236:239], v[204:207], v[76:79]
    s_waitcnt lgkmcnt(2)
    v_mfma_f32_16x16x32_bf16 v[8:11], a[240:243], v[96:99], 0
    ds_read_b128 a[252:255], v245 offset:34400
    v_exp_f32 v4, v4
    v_mfma_f32_16x16x32_bf16 v[20:23], a[240:243], v[112:115], 0
    v_exp_f32 v5, v5
    v_mfma_f32_16x16x32_bf16 v[32:35], a[240:243], v[128:131], 0
    v_exp_f32 v6, v6
    v_mfma_f32_16x16x32_bf16 v[44:47], a[240:243], v[144:147], 0
    v_exp_f32 v7, v7
    v_mfma_f32_16x16x32_bf16 v[56:59], a[240:243], v[160:163], 0
    v_add_f32 v248, v248, v4
    v_add_f32 v248, v248, v5
    v_mfma_f32_16x16x32_bf16 v[68:71], a[240:243], v[176:179], 0
    v_add_f32 v248, v248, v6
    v_add_f32 v248, v248, v7
    v_mfma_f32_16x16x32_bf16 v[80:83], a[240:243], v[192:195], 0
    s_waitcnt lgkmcnt(2)
    v_cvt_pk_bf16_f32 v4, v4, v5
    v_cvt_pk_bf16_f32 v5, v6, v7
    v_mfma_f32_16x16x32_bf16 v[8:11], a[244:247], v[100:103], v[8:11]
    ds_read_b64_tr_b16 a[224:225], v246 offset:0
    v_exp_f32 v16, v16
    v_mfma_f32_16x16x32_bf16 v[20:23], a[244:247], v[116:119], v[20:23]
    ds_read_b64_tr_b16 a[226:227], v246 offset:512
    v_exp_f32 v17, v17
    v_mfma_f32_16x16x32_bf16 v[32:35], a[244:247], v[132:135], v[32:35]
    v_exp_f32 v18, v18
    v_mfma_f32_16x16x32_bf16 v[44:47], a[244:247], v[148:151], v[44:47]
    v_exp_f32 v19, v19
    v_mfma_f32_16x16x32_bf16 v[56:59], a[244:247], v[164:167], v[56:59]
    v_add_f32 v249, v249, v16
    v_add_f32 v249, v249, v17
    v_mfma_f32_16x16x32_bf16 v[68:71], a[244:247], v[180:183], v[68:71]
    v_add_f32 v249, v249, v18
    v_add_f32 v249, v249, v19
    v_mfma_f32_16x16x32_bf16 v[80:83], a[244:247], v[196:199], v[80:83]
    s_waitcnt lgkmcnt(3)
    v_cvt_pk_bf16_f32 v16, v16, v17
    v_cvt_pk_bf16_f32 v17, v18, v19
    v_mfma_f32_16x16x32_bf16 v[8:11], a[248:251], v[104:107], v[8:11]
    ds_read_b64_tr_b16 a[228:229], v246 offset:32
    v_exp_f32 v28, v28
    v_mfma_f32_16x16x32_bf16 v[20:23], a[248:251], v[120:123], v[20:23]
    ds_read_b64_tr_b16 a[230:231], v246 offset:544
    v_exp_f32 v29, v29
    v_mfma_f32_16x16x32_bf16 v[32:35], a[248:251], v[136:139], v[32:35]
    v_exp_f32 v30, v30
    v_mfma_f32_16x16x32_bf16 v[44:47], a[248:251], v[152:155], v[44:47]
    v_exp_f32 v31, v31
    v_mfma_f32_16x16x32_bf16 v[56:59], a[248:251], v[168:171], v[56:59]
    v_add_f32 v250, v250, v28
    v_add_f32 v250, v250, v29
    v_mfma_f32_16x16x32_bf16 v[68:71], a[248:251], v[184:187], v[68:71]
    v_add_f32 v250, v250, v30
    v_add_f32 v250, v250, v31
    v_mfma_f32_16x16x32_bf16 v[80:83], a[248:251], v[200:203], v[80:83]
    s_waitcnt lgkmcnt(4)
    v_cvt_pk_bf16_f32 v28, v28, v29
    v_cvt_pk_bf16_f32 v29, v30, v31
    v_mfma_f32_16x16x32_bf16 v[8:11], a[252:255], v[108:111], v[8:11]
    ds_read_b64_tr_b16 a[232:233], v246 offset:64
    v_exp_f32 v40, v40
    v_mfma_f32_16x16x32_bf16 v[20:23], a[252:255], v[124:127], v[20:23]
    ds_read_b64_tr_b16 a[234:235], v246 offset:576
    v_exp_f32 v41, v41
    v_mfma_f32_16x16x32_bf16 v[32:35], a[252:255], v[140:143], v[32:35]
    v_exp_f32 v42, v42
    v_mfma_f32_16x16x32_bf16 v[44:47], a[252:255], v[156:159], v[44:47]
    v_exp_f32 v43, v43
    v_mfma_f32_16x16x32_bf16 v[56:59], a[252:255], v[172:175], v[56:59]
    v_add_f32 v251, v251, v40
    v_add_f32 v251, v251, v41
    v_mfma_f32_16x16x32_bf16 v[68:71], a[252:255], v[188:191], v[68:71]
    v_add_f32 v251, v251, v42
    v_add_f32 v251, v251, v43
    v_mfma_f32_16x16x32_bf16 v[80:83], a[252:255], v[204:207], v[80:83]
    s_waitcnt lgkmcnt(4)
    v_cvt_pk_bf16_f32 v40, v40, v41
    v_cvt_pk_bf16_f32 v41, v42, v43
    v_mfma_f32_16x16x32_bf16 a[0:3], a[224:227], v[0:3], a[0:3]
    ds_read_b64_tr_b16 a[236:237], v246 offset:96
    v_exp_f32 v52, v52
    v_mfma_f32_16x16x32_bf16 a[4:7], a[224:227], v[12:15], a[4:7]
    ds_read_b64_tr_b16 a[238:239], v246 offset:608
    v_exp_f32 v53, v53
    v_mfma_f32_16x16x32_bf16 a[8:11], a[224:227], v[24:27], a[8:11]
    v_exp_f32 v54, v54
    v_mfma_f32_16x16x32_bf16 a[12:15], a[224:227], v[36:39], a[12:15]
    v_exp_f32 v55, v55
    v_mfma_f32_16x16x32_bf16 a[16:19], a[224:227], v[48:51], a[16:19]
    v_add_f32 v252, v252, v52
    v_add_f32 v252, v252, v53
    v_mfma_f32_16x16x32_bf16 a[20:23], a[224:227], v[60:63], a[20:23]
    v_add_f32 v252, v252, v54
    v_add_f32 v252, v252, v55
    v_mfma_f32_16x16x32_bf16 a[24:27], a[224:227], v[72:75], a[24:27]
    s_waitcnt lgkmcnt(4)
    v_cvt_pk_bf16_f32 v52, v52, v53
    v_cvt_pk_bf16_f32 v53, v54, v55
    v_mfma_f32_16x16x32_bf16 a[28:31], a[228:231], v[0:3], a[28:31]
    ds_read_b64_tr_b16 a[240:241], v246 offset:128
    v_exp_f32 v64, v64
    v_mfma_f32_16x16x32_bf16 a[32:35], a[228:231], v[12:15], a[32:35]
    ds_read_b64_tr_b16 a[242:243], v246 offset:640
    v_exp_f32 v65, v65
    v_mfma_f32_16x16x32_bf16 a[36:39], a[228:231], v[24:27], a[36:39]
    v_exp_f32 v66, v66
    v_mfma_f32_16x16x32_bf16 a[40:43], a[228:231], v[36:39], a[40:43]
    v_exp_f32 v67, v67
    v_mfma_f32_16x16x32_bf16 a[44:47], a[228:231], v[48:51], a[44:47]
    v_add_f32 v253, v253, v64
    v_add_f32 v253, v253, v65
    v_mfma_f32_16x16x32_bf16 a[48:51], a[228:231], v[60:63], a[48:51]
    v_add_f32 v253, v253, v66
    v_add_f32 v253, v253, v67
    v_mfma_f32_16x16x32_bf16 a[52:55], a[228:231], v[72:75], a[52:55]
    s_waitcnt lgkmcnt(4)
    v_cvt_pk_bf16_f32 v64, v64, v65
    v_cvt_pk_bf16_f32 v65, v66, v67
    v_mfma_f32_16x16x32_bf16 a[56:59], a[232:235], v[0:3], a[56:59]
    ds_read_b64_tr_b16 a[244:245], v246 offset:160
    v_exp_f32 v76, v76
    v_mfma_f32_16x16x32_bf16 a[60:63], a[232:235], v[12:15], a[60:63]
    ds_read_b64_tr_b16 a[246:247], v246 offset:672
    v_exp_f32 v77, v77
    v_mfma_f32_16x16x32_bf16 a[64:67], a[232:235], v[24:27], a[64:67]
    v_exp_f32 v78, v78
    v_mfma_f32_16x16x32_bf16 a[68:71], a[232:235], v[36:39], a[68:71]
    v_exp_f32 v79, v79
    v_mfma_f32_16x16x32_bf16 a[72:75], a[232:235], v[48:51], a[72:75]
    v_add_f32 v254, v254, v76
    v_add_f32 v254, v254, v77
    v_mfma_f32_16x16x32_bf16 a[76:79], a[232:235], v[60:63], a[76:79]
    v_add_f32 v254, v254, v78
    v_add_f32 v254, v254, v79
    v_mfma_f32_16x16x32_bf16 a[80:83], a[232:235], v[72:75], a[80:83]
    s_waitcnt lgkmcnt(4)
    v_cvt_pk_bf16_f32 v76, v76, v77
    v_cvt_pk_bf16_f32 v77, v78, v79
    v_mfma_f32_16x16x32_bf16 a[84:87], a[236:239], v[0:3], a[84:87]
    ds_read_b64_tr_b16 a[248:249], v246 offset:192
    v_exp_f32 v8, v8
    v_mfma_f32_16x16x32_bf16 a[88:91], a[236:239], v[12:15], a[88:91]
    ds_read_b64_tr_b16 a[250:251], v246 offset:704
    v_exp_f32 v9, v9
    v_mfma_f32_16x16x32_bf16 a[92:95], a[236:239], v[24:27], a[92:95]
    v_exp_f32 v10, v10
    v_mfma_f32_16x16x32_bf16 a[96:99], a[236:239], v[36:39], a[96:99]
    v_exp_f32 v11, v11
    v_mfma_f32_16x16x32_bf16 a[100:103], a[236:239], v[48:51], a[100:103]
    v_add_f32 v248, v248, v8
    v_add_f32 v248, v248, v9
    v_mfma_f32_16x16x32_bf16 a[104:107], a[236:239], v[60:63], a[104:107]
    v_add_f32 v248, v248, v10
    v_add_f32 v248, v248, v11
    v_mfma_f32_16x16x32_bf16 a[108:111], a[236:239], v[72:75], a[108:111]
    s_waitcnt lgkmcnt(4)
    v_cvt_pk_bf16_f32 v6, v8, v9
    v_cvt_pk_bf16_f32 v7, v10, v11
    v_mfma_f32_16x16x32_bf16 a[112:115], a[240:243], v[0:3], a[112:115]
    ds_read_b64_tr_b16 a[252:253], v246 offset:224
    v_exp_f32 v20, v20
    v_mfma_f32_16x16x32_bf16 a[116:119], a[240:243], v[12:15], a[116:119]
    ds_read_b64_tr_b16 a[254:255], v246 offset:736
    v_exp_f32 v21, v21
    v_mfma_f32_16x16x32_bf16 a[120:123], a[240:243], v[24:27], a[120:123]
    v_exp_f32 v22, v22
    v_mfma_f32_16x16x32_bf16 a[124:127], a[240:243], v[36:39], a[124:127]
    v_exp_f32 v23, v23
    v_mfma_f32_16x16x32_bf16 a[128:131], a[240:243], v[48:51], a[128:131]
    v_add_f32 v249, v249, v20
    v_add_f32 v249, v249, v21
    v_mfma_f32_16x16x32_bf16 a[132:135], a[240:243], v[60:63], a[132:135]
    v_add_f32 v249, v249, v22
    v_add_f32 v249, v249, v23
    v_mfma_f32_16x16x32_bf16 a[136:139], a[240:243], v[72:75], a[136:139]
    s_waitcnt vmcnt(4) lgkmcnt(0)
    s_barrier
    v_add_u32 v245, s98, v245
    v_cvt_pk_bf16_f32 v18, v20, v21
    v_cvt_pk_bf16_f32 v19, v22, v23
    v_mfma_f32_16x16x32_bf16 a[140:143], a[244:247], v[0:3], a[140:143]
    ds_read_b64_tr_b16 a[224:225], v246 offset:33792
    v_exp_f32 v32, v32
    v_mfma_f32_16x16x32_bf16 a[144:147], a[244:247], v[12:15], a[144:147]
    ds_read_b64_tr_b16 a[226:227], v246 offset:34304
    v_exp_f32 v33, v33
    v_mfma_f32_16x16x32_bf16 a[148:151], a[244:247], v[24:27], a[148:151]
    v_exp_f32 v34, v34
    v_mfma_f32_16x16x32_bf16 a[152:155], a[244:247], v[36:39], a[152:155]
    v_exp_f32 v35, v35
    v_mfma_f32_16x16x32_bf16 a[156:159], a[244:247], v[48:51], a[156:159]
    v_add_f32 v250, v250, v32
    v_add_f32 v250, v250, v33
    v_mfma_f32_16x16x32_bf16 a[160:163], a[244:247], v[60:63], a[160:163]
    v_add_f32 v250, v250, v34
    v_add_f32 v250, v250, v35
    v_mfma_f32_16x16x32_bf16 a[164:167], a[244:247], v[72:75], a[164:167]
    v_cvt_pk_bf16_f32 v30, v32, v33
    v_cvt_pk_bf16_f32 v31, v34, v35
    v_mfma_f32_16x16x32_bf16 a[168:171], a[248:251], v[0:3], a[168:171]
    ds_read_b64_tr_b16 a[228:229], v246 offset:33824
    v_exp_f32 v44, v44
    v_mfma_f32_16x16x32_bf16 a[172:175], a[248:251], v[12:15], a[172:175]
    ds_read_b64_tr_b16 a[230:231], v246 offset:34336
    v_exp_f32 v45, v45
    v_mfma_f32_16x16x32_bf16 a[176:179], a[248:251], v[24:27], a[176:179]
    v_exp_f32 v46, v46
    v_mfma_f32_16x16x32_bf16 a[180:183], a[248:251], v[36:39], a[180:183]
    v_exp_f32 v47, v47
    v_mfma_f32_16x16x32_bf16 a[184:187], a[248:251], v[48:51], a[184:187]
    v_add_f32 v251, v251, v44
    v_add_f32 v251, v251, v45
    v_mfma_f32_16x16x32_bf16 a[188:191], a[248:251], v[60:63], a[188:191]
    v_add_f32 v251, v251, v46
    v_add_f32 v251, v251, v47
    v_mfma_f32_16x16x32_bf16 a[192:195], a[248:251], v[72:75], a[192:195]
    v_cvt_pk_bf16_f32 v42, v44, v45
    v_cvt_pk_bf16_f32 v43, v46, v47
    v_mfma_f32_16x16x32_bf16 a[196:199], a[252:255], v[0:3], a[196:199]
    ds_read_b64_tr_b16 a[232:233], v246 offset:33856
    v_exp_f32 v56, v56
    v_mfma_f32_16x16x32_bf16 a[200:203], a[252:255], v[12:15], a[200:203]
    ds_read_b64_tr_b16 a[234:235], v246 offset:34368
    v_exp_f32 v57, v57
    v_mfma_f32_16x16x32_bf16 a[204:207], a[252:255], v[24:27], a[204:207]
    v_exp_f32 v58, v58
    v_mfma_f32_16x16x32_bf16 a[208:211], a[252:255], v[36:39], a[208:211]
    v_exp_f32 v59, v59
    v_mfma_f32_16x16x32_bf16 a[212:215], a[252:255], v[48:51], a[212:215]
    v_add_f32 v252, v252, v56
    v_add_f32 v252, v252, v57
    v_mfma_f32_16x16x32_bf16 a[216:219], a[252:255], v[60:63], a[216:219]
    v_add_f32 v252, v252, v58
    v_add_f32 v252, v252, v59
    v_mfma_f32_16x16x32_bf16 a[220:223], a[252:255], v[72:75], a[220:223]
    s_waitcnt lgkmcnt(4)
    v_cvt_pk_bf16_f32 v54, v56, v57
    v_cvt_pk_bf16_f32 v55, v58, v59
    v_exp_f32 v68, v68
    v_exp_f32 v69, v69
    v_exp_f32 v70, v70
    v_exp_f32 v71, v71
    v_add_f32 v253, v253, v68
    v_add_f32 v253, v253, v69
    v_add_f32 v253, v253, v70
    v_add_f32 v253, v253, v71
    v_cvt_pk_bf16_f32 v66, v68, v69
    v_cvt_pk_bf16_f32 v67, v70, v71
    v_exp_f32 v80, v80
    v_exp_f32 v81, v81
    v_exp_f32 v82, v82
    v_exp_f32 v83, v83
    v_add_f32 v254, v254, v80
    v_add_f32 v254, v254, v81
    v_add_f32 v254, v254, v82
    v_add_f32 v254, v254, v83
    v_cvt_pk_bf16_f32 v78, v80, v81
    v_cvt_pk_bf16_f32 v79, v82, v83
    v_mfma_f32_16x16x32_bf16 a[0:3], a[224:227], v[4:7], a[0:3]
    ds_read_b64_tr_b16 a[236:237], v246 offset:33888
    v_mov_b32 v84, v248
    v_mov_b32 v85, v249
    v_mfma_f32_16x16x32_bf16 a[4:7], a[224:227], v[16:19], a[4:7]
    ds_read_b64_tr_b16 a[238:239], v246 offset:34400
    v_mov_b32 v86, v250
    v_mov_b32 v87, v251
    v_mfma_f32_16x16x32_bf16 a[8:11], a[224:227], v[28:31], a[8:11]
    s_mov_b32 s16, 0x4e800000
    v_mov_b32 v88, v252
    v_mov_b32 v89, v253
    v_mfma_f32_16x16x32_bf16 a[12:15], a[224:227], v[40:43], a[12:15]
    s_mov_b32 s17, 0x30800000
    v_mov_b32 v90, v254
    v_permlane32_swap_b32 v248, v84
    v_mfma_f32_16x16x32_bf16 a[16:19], a[224:227], v[52:55], a[16:19]
    v_permlane32_swap_b32 v249, v85
    v_permlane32_swap_b32 v250, v86
    v_mfma_f32_16x16x32_bf16 a[20:23], a[224:227], v[64:67], a[20:23]
    v_permlane32_swap_b32 v251, v87
    v_permlane32_swap_b32 v252, v88
    v_mfma_f32_16x16x32_bf16 a[24:27], a[224:227], v[76:79], a[24:27]
    s_waitcnt lgkmcnt(4)
    v_permlane32_swap_b32 v253, v89
    v_permlane32_swap_b32 v254, v90
    v_mfma_f32_16x16x32_bf16 a[28:31], a[228:231], v[4:7], a[28:31]
    ds_read_b64_tr_b16 a[240:241], v246 offset:33920
    v_add_f32 v248, v248, v84
    v_add_f32 v249, v249, v85
    v_mfma_f32_16x16x32_bf16 a[32:35], a[228:231], v[16:19], a[32:35]
    ds_read_b64_tr_b16 a[242:243], v246 offset:34432
    v_add_f32 v250, v250, v86
    v_add_f32 v251, v251, v87
    v_mfma_f32_16x16x32_bf16 a[36:39], a[228:231], v[28:31], a[36:39]
    v_add_f32 v252, v252, v88
    v_add_f32 v253, v253, v89
    v_mfma_f32_16x16x32_bf16 a[40:43], a[228:231], v[40:43], a[40:43]
    v_add_f32 v254, v254, v90
    v_mov_b32 v84, v248
    v_mfma_f32_16x16x32_bf16 a[44:47], a[228:231], v[52:55], a[44:47]
    v_mov_b32 v85, v249
    v_mov_b32 v86, v250
    v_mfma_f32_16x16x32_bf16 a[48:51], a[228:231], v[64:67], a[48:51]
    v_mov_b32 v87, v251
    v_mov_b32 v88, v252
    v_mfma_f32_16x16x32_bf16 a[52:55], a[228:231], v[76:79], a[52:55]
    s_waitcnt lgkmcnt(4)
    v_mov_b32 v89, v253
    v_mov_b32 v90, v254
    v_mfma_f32_16x16x32_bf16 a[56:59], a[232:235], v[4:7], a[56:59]
    ds_read_b64_tr_b16 a[244:245], v246 offset:33952
    v_permlane16_swap_b32 v248, v84
    v_permlane16_swap_b32 v249, v85
    v_mfma_f32_16x16x32_bf16 a[60:63], a[232:235], v[16:19], a[60:63]
    ds_read_b64_tr_b16 a[246:247], v246 offset:34464
    v_permlane16_swap_b32 v250, v86
    v_permlane16_swap_b32 v251, v87
    v_mfma_f32_16x16x32_bf16 a[64:67], a[232:235], v[28:31], a[64:67]
    v_permlane16_swap_b32 v252, v88
    v_permlane16_swap_b32 v253, v89
    v_mfma_f32_16x16x32_bf16 a[68:71], a[232:235], v[40:43], a[68:71]
    v_permlane16_swap_b32 v254, v90
    v_add_f32 v248, v248, v84
    v_mfma_f32_16x16x32_bf16 a[72:75], a[232:235], v[52:55], a[72:75]
    v_add_f32 v249, v249, v85
    v_add_f32 v250, v250, v86
    v_mfma_f32_16x16x32_bf16 a[76:79], a[232:235], v[64:67], a[76:79]
    v_add_f32 v251, v251, v87
    v_add_f32 v252, v252, v88
    v_mfma_f32_16x16x32_bf16 a[80:83], a[232:235], v[76:79], a[80:83]
    s_waitcnt lgkmcnt(4)
    v_add_f32 v253, v253, v89
    v_add_f32 v254, v254, v90
    v_mfma_f32_16x16x32_bf16 a[84:87], a[236:239], v[4:7], a[84:87]
    ds_read_b64_tr_b16 a[248:249], v246 offset:33984
    v_max3_f32 v227, v248, v249, v250
    v_min3_f32 v228, v248, v249, v250
    v_mfma_f32_16x16x32_bf16 a[88:91], a[236:239], v[16:19], a[88:91]
    ds_read_b64_tr_b16 a[250:251], v246 offset:34496
    v_max3_f32 v227, v227, v251, v252
    v_min3_f32 v228, v228, v251, v252
    v_mfma_f32_16x16x32_bf16 a[92:95], a[236:239], v[28:31], a[92:95]
    v_max3_f32 v227, v227, v253, v254
    v_min3_f32 v228, v228, v253, v254
    v_mfma_f32_16x16x32_bf16 a[96:99], a[236:239], v[40:43], a[96:99]
    v_cmp_ngt_f32 s[18:19], s16, v227
    v_cmp_nle_f32 s[20:21], s17, v228
    v_mfma_f32_16x16x32_bf16 a[100:103], a[236:239], v[52:55], a[100:103]
    v_rcp_f32 v248, v248
    v_mfma_f32_16x16x32_bf16 a[104:107], a[236:239], v[64:67], a[104:107]
    v_rcp_f32 v249, v249
    v_mfma_f32_16x16x32_bf16 a[108:111], a[236:239], v[76:79], a[108:111]
    s_waitcnt lgkmcnt(4)
    v_rcp_f32 v250, v250
    v_mfma_f32_16x16x32_bf16 a[112:115], a[240:243], v[4:7], a[112:115]
    ds_read_b64_tr_b16 a[252:253], v246 offset:34016
    v_rcp_f32 v251, v251
    v_mfma_f32_16x16x32_bf16 a[116:119], a[240:243], v[16:19], a[116:119]
    ds_read_b64_tr_b16 a[254:255], v246 offset:34528
    v_rcp_f32 v252, v252
    v_mfma_f32_16x16x32_bf16 a[120:123], a[240:243], v[28:31], a[120:123]
    v_rcp_f32 v253, v253
    v_mfma_f32_16x16x32_bf16 a[124:127], a[240:243], v[40:43], a[124:127]
    v_rcp_f32 v254, v254
    v_mfma_f32_16x16x32_bf16 a[128:131], a[240:243], v[52:55], a[128:131]
    v_mfma_f32_16x16x32_bf16 a[132:135], a[240:243], v[64:67], a[132:135]
    v_mfma_f32_16x16x32_bf16 a[136:139], a[240:243], v[76:79], a[136:139]
    s_waitcnt lgkmcnt(4)
    v_mfma_f32_16x16x32_bf16 a[140:143], a[244:247], v[4:7], a[140:143]
    s_or_b64 s[18:19], s[18:19], s[20:21]
    v_mfma_f32_16x16x32_bf16 a[144:147], a[244:247], v[16:19], a[144:147]
    v_mfma_f32_16x16x32_bf16 a[148:151], a[244:247], v[28:31], a[148:151]
    v_mfma_f32_16x16x32_bf16 a[152:155], a[244:247], v[40:43], a[152:155]
    v_mfma_f32_16x16x32_bf16 a[156:159], a[244:247], v[52:55], a[156:159]
    v_mfma_f32_16x16x32_bf16 a[160:163], a[244:247], v[64:67], a[160:163]
    v_mfma_f32_16x16x32_bf16 a[164:167], a[244:247], v[76:79], a[164:167]
    s_waitcnt lgkmcnt(2)
    v_mfma_f32_16x16x32_bf16 a[168:171], a[248:251], v[4:7], a[168:171]
    v_mfma_f32_16x16x32_bf16 a[172:175], a[248:251], v[16:19], a[172:175]
    v_mfma_f32_16x16x32_bf16 a[176:179], a[248:251], v[28:31], a[176:179]
    v_mfma_f32_16x16x32_bf16 a[180:183], a[248:251], v[40:43], a[180:183]
    v_mfma_f32_16x16x32_bf16 a[184:187], a[248:251], v[52:55], a[184:187]
    v_mfma_f32_16x16x32_bf16 a[188:191], a[248:251], v[64:67], a[188:191]
    v_mfma_f32_16x16x32_bf16 a[192:195], a[248:251], v[76:79], a[192:195]
    s_waitcnt lgkmcnt(0)
    v_mfma_f32_16x16x32_bf16 a[196:199], a[252:255], v[4:7], a[196:199]
    v_mfma_f32_16x16x32_bf16 a[200:203], a[252:255], v[16:19], a[200:203]
    v_mfma_f32_16x16x32_bf16 a[204:207], a[252:255], v[28:31], a[204:207]
    v_mfma_f32_16x16x32_bf16 a[208:211], a[252:255], v[40:43], a[208:211]
    v_mfma_f32_16x16x32_bf16 a[212:215], a[252:255], v[52:55], a[212:215]
    v_mfma_f32_16x16x32_bf16 a[216:219], a[252:255], v[64:67], a[216:219]
    v_mfma_f32_16x16x32_bf16 a[220:223], a[252:255], v[76:79], a[220:223]
    s_waitcnt vmcnt(0)
    s_barrier
    s_cmp_lg_u64 s[18:19], 0
    s_cbranch_scc1 L_slow
    s_nop 3
L_norm:
    s_mul_i32 s3, s31, 589824
    s_add_u32 s36, s6, s3
    s_addc_u32 s37, s7, 0
    s_mov_b32 s38, 589824
    v_mul_u32_u24 v229, 4608, v226
    s_lshl_b32 s3, s26, 8
    v_lshl_add_u32 v229, v225, 4, v229
    v_add_u32 v229, s3, v229
    s_mul_i32 s56, s26, 2048
    s_add_u32 s56, s56, 114688
    v_lshrrev_b32 v227, 1, v224
    v_and_b32 v228, 1, v224
    v_mul_u32_u24 v230, 1152, v227
    v_lshl_add_u32 v230, v228, 4, v230
    s_lshl_b32 s3, s26, 5
    s_add_u32 s3, s3, 1024
    v_add_u32 v230, s3, v230
    s_mov_b32 s16, 0
    s_mov_b32 s20, 0
    s_mov_b32 s17, 147456
    s_mov_b32 s21, 28672
    s_mov_b32 s18, 294912
    s_mov_b32 s22, 57344
    s_mov_b32 s19, 442368
    s_mov_b32 s23, 86016
    s_add_u32 s58, s16, 0
    buffer_load_dwordx4 v[96:99], v229, s[36:39], s58 offen offset:0
    buffer_load_dwordx4 v[100:103], v229, s[36:39], s58 offen offset:1152
    buffer_load_dwordx4 v[104:107], v229, s[36:39], s58 offen offset:2304
    buffer_load_dwordx4 v[108:111], v229, s[36:39], s58 offen offset:3456
    s_add_u32 s58, s16, 18432
    buffer_load_dwordx4 v[112:115], v229, s[36:39], s58 offen offset:0
    buffer_load_dwordx4 v[116:119], v229, s[36:39], s58 offen offset:1152
    buffer_load_dwordx4 v[120:123], v229, s[36:39], s58 offen offset:2304
    buffer_load_dwordx4 v[124:127], v229, s[36:39], s58 offen offset:3456
    s_add_u32 s59, s16, 0
    buffer_load_dwordx4 v[216:219], v230, s[36:39], s59 offen
    v_lshlrev_b32 v237, 4, v224
    s_mul_i32 s4, s26, 28672
    v_add_u32 v238, s4, v237
    v_add_u32 v235, s56, v237
    v_add_u32 v240, s20, v237
    v_add_u32 v241, s21, v237
    v_add_u32 v242, s22, v237
    v_add_u32 v243, s23, v237
    v_lshrrev_b32 v227, 2, v225
    v_lshl_add_u32 v227, v226, 2, v227
    v_and_b32 v228, 3, v225
    v_lshlrev_b32 v228, 3, v228
    v_lshl_add_u32 v236, v227, 5, v228
    v_add_u32 v236, s56, v236
    v_accvgpr_read_b32 v160, a0
    v_accvgpr_read_b32 v161, a1
    v_accvgpr_read_b32 v162, a2
    v_accvgpr_read_b32 v163, a3
    v_accvgpr_read_b32 v164, a28
    v_accvgpr_read_b32 v165, a29
    v_accvgpr_read_b32 v166, a30
    v_accvgpr_read_b32 v167, a31
    v_pk_mul_f32 v[160:161], v[160:161], v[248:249] op_sel_hi:[1,0]
    v_pk_mul_f32 v[162:163], v[162:163], v[248:249] op_sel_hi:[1,0]
    v_pk_mul_f32 v[164:165], v[164:165], v[248:249] op_sel_hi:[1,0]
    v_pk_mul_f32 v[166:167], v[166:167], v[248:249] op_sel_hi:[1,0]
    v_cvt_pk_bf16_f32 v168, v160, v161
    v_cvt_pk_bf16_f32 v169, v162, v163
    v_cvt_pk_bf16_f32 v170, v164, v165
    v_cvt_pk_bf16_f32 v171, v166, v167
    ds_write_b128 v238, v[168:171] offset:0
    s_add_u32 s58, s16, 36864
    buffer_load_dwordx4 v[128:131], v229, s[36:39], s58 offen offset:0
    v_accvgpr_read_b32 v172, a4
    v_accvgpr_read_b32 v173, a5
    v_accvgpr_read_b32 v174, a6
    v_accvgpr_read_b32 v175, a7
    v_accvgpr_read_b32 v176, a32
    v_accvgpr_read_b32 v177, a33
    v_accvgpr_read_b32 v178, a34
    v_accvgpr_read_b32 v179, a35
    v_pk_mul_f32 v[172:173], v[172:173], v[248:249] op_sel:[0,1] op_sel_hi:[1,1]
    v_pk_mul_f32 v[174:175], v[174:175], v[248:249] op_sel:[0,1] op_sel_hi:[1,1]
    v_pk_mul_f32 v[176:177], v[176:177], v[248:249] op_sel:[0,1] op_sel_hi:[1,1]
    v_pk_mul_f32 v[178:179], v[178:179], v[248:249] op_sel:[0,1] op_sel_hi:[1,1]
    v_cvt_pk_bf16_f32 v180, v172, v173
    v_cvt_pk_bf16_f32 v181, v174, v175
    v_cvt_pk_bf16_f32 v182, v176, v177
    v_cvt_pk_bf16_f32 v183, v178, v179
    ds_write_b128 v238, v[180:183] offset:1024
    buffer_load_dwordx4 v[132:135], v229, s[36:39], s58 offen offset:1152
    v_accvgpr_read_b32 v184, a8
    v_accvgpr_read_b32 v185, a9
    v_accvgpr_read_b32 v186, a10
    v_accvgpr_read_b32 v187, a11
    v_accvgpr_read_b32 v188, a36
    v_accvgpr_read_b32 v189, a37
    v_accvgpr_read_b32 v190, a38
    v_accvgpr_read_b32 v191, a39
    v_pk_mul_f32 v[184:185], v[184:185], v[250:251] op_sel_hi:[1,0]
    v_pk_mul_f32 v[186:187], v[186:187], v[250:251] op_sel_hi:[1,0]
    v_pk_mul_f32 v[188:189], v[188:189], v[250:251] op_sel_hi:[1,0]
    v_pk_mul_f32 v[190:191], v[190:191], v[250:251] op_sel_hi:[1,0]
    v_cvt_pk_bf16_f32 v192, v184, v185
    v_cvt_pk_bf16_f32 v193, v186, v187
    v_cvt_pk_bf16_f32 v194, v188, v189
    v_cvt_pk_bf16_f32 v195, v190, v191
    ds_write_b128 v238, v[192:195] offset:2048
    buffer_load_dwordx4 v[136:139], v229, s[36:39], s58 offen offset:2304
    v_accvgpr_read_b32 v196, a12
    v_accvgpr_read_b32 v197, a13
    v_accvgpr_read_b32 v198, a14
    v_accvgpr_read_b32 v199, a15
    v_accvgpr_read_b32 v200, a40
    v_accvgpr_read_b32 v201, a41
    v_accvgpr_read_b32 v202, a42
    v_accvgpr_read_b32 v203, a43
    v_pk_mul_f32 v[196:197], v[196:197], v[250:251] op_sel:[0,1] op_sel_hi:[1,1]
    v_pk_mul_f32 v[198:199], v[198:199], v[250:251] op_sel:[0,1] op_sel_hi:[1,1]
    v_pk_mul_f32 v[200:201], v[200:201], v[250:251] op_sel:[0,1] op_sel_hi:[1,1]
    v_pk_mul_f32 v[202:203], v[202:203], v[250:251] op_sel:[0,1] op_sel_hi:[1,1]
    v_cvt_pk_bf16_f32 v204, v196, v197
    v_cvt_pk_bf16_f32 v205, v198, v199
    v_cvt_pk_bf16_f32 v206, v200, v201
    v_cvt_pk_bf16_f32 v207, v202, v203
    ds_write_b128 v238, v[204:207] offset:3072
    buffer_load_dwordx4 v[140:143], v229, s[36:39], s58 offen offset:3456
    v_accvgpr_read_b32 v160, a16
    v_accvgpr_read_b32 v161, a17
    v_accvgpr_read_b32 v162, a18
    v_accvgpr_read_b32 v163, a19
    v_accvgpr_read_b32 v164, a44
    v_accvgpr_read_b32 v165, a45
    v_accvgpr_read_b32 v166, a46
    v_accvgpr_read_b32 v167, a47
    v_pk_mul_f32 v[160:161], v[160:161], v[252:253] op_sel_hi:[1,0]
    v_pk_mul_f32 v[162:163], v[162:163], v[252:253] op_sel_hi:[1,0]
    v_pk_mul_f32 v[164:165], v[164:165], v[252:253] op_sel_hi:[1,0]
    v_pk_mul_f32 v[166:167], v[166:167], v[252:253] op_sel_hi:[1,0]
    v_cvt_pk_bf16_f32 v168, v160, v161
    v_cvt_pk_bf16_f32 v169, v162, v163
    v_cvt_pk_bf16_f32 v170, v164, v165
    v_cvt_pk_bf16_f32 v171, v166, v167
    ds_write_b128 v238, v[168:171] offset:4096
    s_add_u32 s58, s16, 55296
    buffer_load_dwordx4 v[144:147], v229, s[36:39], s58 offen offset:0
    v_accvgpr_read_b32 v172, a20
    v_accvgpr_read_b32 v173, a21
    v_accvgpr_read_b32 v174, a22
    v_accvgpr_read_b32 v175, a23
    v_accvgpr_read_b32 v176, a48
    v_accvgpr_read_b32 v177, a49
    v_accvgpr_read_b32 v178, a50
    v_accvgpr_read_b32 v179, a51
    v_pk_mul_f32 v[172:173], v[172:173], v[252:253] op_sel:[0,1] op_sel_hi:[1,1]
    v_pk_mul_f32 v[174:175], v[174:175], v[252:253] op_sel:[0,1] op_sel_hi:[1,1]
    v_pk_mul_f32 v[176:177], v[176:177], v[252:253] op_sel:[0,1] op_sel_hi:[1,1]
    v_pk_mul_f32 v[178:179], v[178:179], v[252:253] op_sel:[0,1] op_sel_hi:[1,1]
    v_cvt_pk_bf16_f32 v180, v172, v173
    v_cvt_pk_bf16_f32 v181, v174, v175
    v_cvt_pk_bf16_f32 v182, v176, v177
    v_cvt_pk_bf16_f32 v183, v178, v179
    ds_write_b128 v238, v[180:183] offset:5120
    buffer_load_dwordx4 v[148:151], v229, s[36:39], s58 offen offset:1152
    v_accvgpr_read_b32 v184, a24
    v_accvgpr_read_b32 v185, a25
    v_accvgpr_read_b32 v186, a26
    v_accvgpr_read_b32 v187, a27
    v_accvgpr_read_b32 v188, a52
    v_accvgpr_read_b32 v189, a53
    v_accvgpr_read_b32 v190, a54
    v_accvgpr_read_b32 v191, a55
    v_pk_mul_f32 v[184:185], v[184:185], v[254:255] op_sel_hi:[1,0]
    v_pk_mul_f32 v[186:187], v[186:187], v[254:255] op_sel_hi:[1,0]
    v_pk_mul_f32 v[188:189], v[188:189], v[254:255] op_sel_hi:[1,0]
    v_pk_mul_f32 v[190:191], v[190:191], v[254:255] op_sel_hi:[1,0]
    v_cvt_pk_bf16_f32 v192, v184, v185
    v_cvt_pk_bf16_f32 v193, v186, v187
    v_cvt_pk_bf16_f32 v194, v188, v189
    v_cvt_pk_bf16_f32 v195, v190, v191
    ds_write_b128 v238, v[192:195] offset:6144
    buffer_load_dwordx4 v[152:155], v229, s[36:39], s58 offen offset:2304
    v_accvgpr_read_b32 v196, a56
    v_accvgpr_read_b32 v197, a57
    v_accvgpr_read_b32 v198, a58
    v_accvgpr_read_b32 v199, a59
    v_accvgpr_read_b32 v200, a84
    v_accvgpr_read_b32 v201, a85
    v_accvgpr_read_b32 v202, a86
    v_accvgpr_read_b32 v203, a87
    v_pk_mul_f32 v[196:197], v[196:197], v[248:249] op_sel_hi:[1,0]
    v_pk_mul_f32 v[198:199], v[198:199], v[248:249] op_sel_hi:[1,0]
    v_pk_mul_f32 v[200:201], v[200:201], v[248:249] op_sel_hi:[1,0]
    v_pk_mul_f32 v[202:203], v[202:203], v[248:249] op_sel_hi:[1,0]
    v_cvt_pk_bf16_f32 v204, v196, v197
    v_cvt_pk_bf16_f32 v205, v198, v199
    v_cvt_pk_bf16_f32 v206, v200, v201
    v_cvt_pk_bf16_f32 v207, v202, v203
    ds_write_b128 v238, v[204:207] offset:7168
    buffer_load_dwordx4 v[156:159], v229, s[36:39], s58 offen offset:3456
    v_accvgpr_read_b32 v160, a60
    v_accvgpr_read_b32 v161, a61
    v_accvgpr_read_b32 v162, a62
    v_accvgpr_read_b32 v163, a63
    v_accvgpr_read_b32 v164, a88
    v_accvgpr_read_b32 v165, a89
    v_accvgpr_read_b32 v166, a90
    v_accvgpr_read_b32 v167, a91
    v_pk_mul_f32 v[160:161], v[160:161], v[248:249] op_sel:[0,1] op_sel_hi:[1,1]
    v_pk_mul_f32 v[162:163], v[162:163], v[248:249] op_sel:[0,1] op_sel_hi:[1,1]
    v_pk_mul_f32 v[164:165], v[164:165], v[248:249] op_sel:[0,1] op_sel_hi:[1,1]
    v_pk_mul_f32 v[166:167], v[166:167], v[248:249] op_sel:[0,1] op_sel_hi:[1,1]
    v_cvt_pk_bf16_f32 v168, v160, v161
    v_cvt_pk_bf16_f32 v169, v162, v163
    v_cvt_pk_bf16_f32 v170, v164, v165
    v_cvt_pk_bf16_f32 v171, v166, v167
    ds_write_b128 v238, v[168:171] offset:8192
    s_add_u32 s59, s16, 36864
    buffer_load_dwordx4 a[252:255], v230, s[36:39], s59 offen
    v_accvgpr_read_b32 v172, a64
    v_accvgpr_read_b32 v173, a65
    v_accvgpr_read_b32 v174, a66
    v_accvgpr_read_b32 v175, a67
    v_accvgpr_read_b32 v176, a92
    v_accvgpr_read_b32 v177, a93
    v_accvgpr_read_b32 v178, a94
    v_accvgpr_read_b32 v179, a95
    v_pk_mul_f32 v[172:173], v[172:173], v[250:251] op_sel_hi:[1,0]
    v_pk_mul_f32 v[174:175], v[174:175], v[250:251] op_sel_hi:[1,0]
    v_pk_mul_f32 v[176:177], v[176:177], v[250:251] op_sel_hi:[1,0]
    v_pk_mul_f32 v[178:179], v[178:179], v[250:251] op_sel_hi:[1,0]
    v_cvt_pk_bf16_f32 v180, v172, v173
    v_cvt_pk_bf16_f32 v181, v174, v175
    v_cvt_pk_bf16_f32 v182, v176, v177
    v_cvt_pk_bf16_f32 v183, v178, v179
    ds_write_b128 v238, v[180:183] offset:9216
    s_add_u32 s58, s16, 73728
    buffer_load_dwordx4 v[32:35], v229, s[36:39], s58 offen offset:0
    v_accvgpr_read_b32 v184, a68
    v_accvgpr_read_b32 v185, a69
    v_accvgpr_read_b32 v186, a70
    v_accvgpr_read_b32 v187, a71
    v_accvgpr_read_b32 v188, a96
    v_accvgpr_read_b32 v189, a97
    v_accvgpr_read_b32 v190, a98
    v_accvgpr_read_b32 v191, a99
    v_pk_mul_f32 v[184:185], v[184:185], v[250:251] op_sel:[0,1] op_sel_hi:[1,1]
    v_pk_mul_f32 v[186:187], v[186:187], v[250:251] op_sel:[0,1] op_sel_hi:[1,1]
    v_pk_mul_f32 v[188:189], v[188:189], v[250:251] op_sel:[0,1] op_sel_hi:[1,1]
    v_pk_mul_f32 v[190:191], v[190:191], v[250:251] op_sel:[0,1] op_sel_hi:[1,1]
    v_cvt_pk_bf16_f32 v192, v184, v185
    v_cvt_pk_bf16_f32 v193, v186, v187
    v_cvt_pk_bf16_f32 v194, v188, v189
    v_cvt_pk_bf16_f32 v195, v190, v191
    ds_write_b128 v238, v[192:195] offset:10240
    buffer_load_dwordx4 v[36:39], v229, s[36:39], s58 offen offset:1152
    v_accvgpr_read_b32 v196, a72
    v_accvgpr_read_b32 v197, a73
    v_accvgpr_read_b32 v198, a74
    v_accvgpr_read_b32 v199, a75
    v_accvgpr_read_b32 v200, a100
    v_accvgpr_read_b32 v201, a101
    v_accvgpr_read_b32 v202, a102
    v_accvgpr_read_b32 v203, a103
    v_pk_mul_f32 v[196:197], v[196:197], v[252:253] op_sel_hi:[1,0]
    v_pk_mul_f32 v[198:199], v[198:199], v[252:253] op_sel_hi:[1,0]
    v_pk_mul_f32 v[200:201], v[200:201], v[252:253] op_sel_hi:[1,0]
    v_pk_mul_f32 v[202:203], v[202:203], v[252:253] op_sel_hi:[1,0]
    v_cvt_pk_bf16_f32 v204, v196, v197
    v_cvt_pk_bf16_f32 v205, v198, v199
    v_cvt_pk_bf16_f32 v206, v200, v201
    v_cvt_pk_bf16_f32 v207, v202, v203
    ds_write_b128 v238, v[204:207] offset:11264
    buffer_load_dwordx4 v[40:43], v229, s[36:39], s58 offen offset:2304
    v_accvgpr_read_b32 v160, a76
    v_accvgpr_read_b32 v161, a77
    v_accvgpr_read_b32 v162, a78
    v_accvgpr_read_b32 v163, a79
    v_accvgpr_read_b32 v164, a104
    v_accvgpr_read_b32 v165, a105
    v_accvgpr_read_b32 v166, a106
    v_accvgpr_read_b32 v167, a107
    v_pk_mul_f32 v[160:161], v[160:161], v[252:253] op_sel:[0,1] op_sel_hi:[1,1]
    v_pk_mul_f32 v[162:163], v[162:163], v[252:253] op_sel:[0,1] op_sel_hi:[1,1]
    v_pk_mul_f32 v[164:165], v[164:165], v[252:253] op_sel:[0,1] op_sel_hi:[1,1]
    v_pk_mul_f32 v[166:167], v[166:167], v[252:253] op_sel:[0,1] op_sel_hi:[1,1]
    v_cvt_pk_bf16_f32 v168, v160, v161
    v_cvt_pk_bf16_f32 v169, v162, v163
    v_cvt_pk_bf16_f32 v170, v164, v165
    v_cvt_pk_bf16_f32 v171, v166, v167
    ds_write_b128 v238, v[168:171] offset:12288
    buffer_load_dwordx4 v[44:47], v229, s[36:39], s58 offen offset:3456
    v_accvgpr_read_b32 v172, a80
    v_accvgpr_read_b32 v173, a81
    v_accvgpr_read_b32 v174, a82
    v_accvgpr_read_b32 v175, a83
    v_accvgpr_read_b32 v176, a108
    v_accvgpr_read_b32 v177, a109
    v_accvgpr_read_b32 v178, a110
    v_accvgpr_read_b32 v179, a111
    v_pk_mul_f32 v[172:173], v[172:173], v[254:255] op_sel_hi:[1,0]
    v_pk_mul_f32 v[174:175], v[174:175], v[254:255] op_sel_hi:[1,0]
    v_pk_mul_f32 v[176:177], v[176:177], v[254:255] op_sel_hi:[1,0]
    v_pk_mul_f32 v[178:179], v[178:179], v[254:255] op_sel_hi:[1,0]
    v_cvt_pk_bf16_f32 v180, v172, v173
    v_cvt_pk_bf16_f32 v181, v174, v175
    v_cvt_pk_bf16_f32 v182, v176, v177
    v_cvt_pk_bf16_f32 v183, v178, v179
    ds_write_b128 v238, v[180:183] offset:13312
    s_add_u32 s58, s16, 92160
    buffer_load_dwordx4 v[48:51], v229, s[36:39], s58 offen offset:0
    v_accvgpr_read_b32 v184, a112
    v_accvgpr_read_b32 v185, a113
    v_accvgpr_read_b32 v186, a114
    v_accvgpr_read_b32 v187, a115
    v_accvgpr_read_b32 v188, a140
    v_accvgpr_read_b32 v189, a141
    v_accvgpr_read_b32 v190, a142
    v_accvgpr_read_b32 v191, a143
    v_pk_mul_f32 v[184:185], v[184:185], v[248:249] op_sel_hi:[1,0]
    v_pk_mul_f32 v[186:187], v[186:187], v[248:249] op_sel_hi:[1,0]
    v_pk_mul_f32 v[188:189], v[188:189], v[248:249] op_sel_hi:[1,0]
    v_pk_mul_f32 v[190:191], v[190:191], v[248:249] op_sel_hi:[1,0]
    v_cvt_pk_bf16_f32 v192, v184, v185
    v_cvt_pk_bf16_f32 v193, v186, v187
    v_cvt_pk_bf16_f32 v194, v188, v189
    v_cvt_pk_bf16_f32 v195, v190, v191
    ds_write_b128 v238, v[192:195] offset:14336
    buffer_load_dwordx4 v[52:55], v229, s[36:39], s58 offen offset:1152
    v_accvgpr_read_b32 v196, a116
    v_accvgpr_read_b32 v197, a117
    v_accvgpr_read_b32 v198, a118
    v_accvgpr_read_b32 v199, a119
    v_accvgpr_read_b32 v200, a144
    v_accvgpr_read_b32 v201, a145
    v_accvgpr_read_b32 v202, a146
    v_accvgpr_read_b32 v203, a147
    v_pk_mul_f32 v[196:197], v[196:197], v[248:249] op_sel:[0,1] op_sel_hi:[1,1]
    v_pk_mul_f32 v[198:199], v[198:199], v[248:249] op_sel:[0,1] op_sel_hi:[1,1]
    v_pk_mul_f32 v[200:201], v[200:201], v[248:249] op_sel:[0,1] op_sel_hi:[1,1]
    v_pk_mul_f32 v[202:203], v[202:203], v[248:249] op_sel:[0,1] op_sel_hi:[1,1]
    v_cvt_pk_bf16_f32 v204, v196, v197
    v_cvt_pk_bf16_f32 v205, v198, v199
    v_cvt_pk_bf16_f32 v206, v200, v201
    v_cvt_pk_bf16_f32 v207, v202, v203
    s_waitcnt lgkmcnt(10)
    ds_write_b128 v238, v[204:207] offset:15360
    buffer_load_dwordx4 v[56:59], v229, s[36:39], s58 offen offset:2304
    v_accvgpr_read_b32 v160, a120
    v_accvgpr_read_b32 v161, a121
    v_accvgpr_read_b32 v162, a122
    v_accvgpr_read_b32 v163, a123
    v_accvgpr_read_b32 v164, a148
    v_accvgpr_read_b32 v165, a149
    v_accvgpr_read_b32 v166, a150
    v_accvgpr_read_b32 v167, a151
    v_pk_mul_f32 v[160:161], v[160:161], v[250:251] op_sel_hi:[1,0]
    v_pk_mul_f32 v[162:163], v[162:163], v[250:251] op_sel_hi:[1,0]
    v_pk_mul_f32 v[164:165], v[164:165], v[250:251] op_sel_hi:[1,0]
    v_pk_mul_f32 v[166:167], v[166:167], v[250:251] op_sel_hi:[1,0]
    v_cvt_pk_bf16_f32 v168, v160, v161
    v_cvt_pk_bf16_f32 v169, v162, v163
    v_cvt_pk_bf16_f32 v170, v164, v165
    v_cvt_pk_bf16_f32 v171, v166, v167
    ds_write_b128 v238, v[168:171] offset:16384
    buffer_load_dwordx4 v[60:63], v229, s[36:39], s58 offen offset:3456
    v_accvgpr_read_b32 v172, a124
    v_accvgpr_read_b32 v173, a125
    v_accvgpr_read_b32 v174, a126
    v_accvgpr_read_b32 v175, a127
    v_accvgpr_read_b32 v176, a152
    v_accvgpr_read_b32 v177, a153
    v_accvgpr_read_b32 v178, a154
    v_accvgpr_read_b32 v179, a155
    v_pk_mul_f32 v[172:173], v[172:173], v[250:251] op_sel:[0,1] op_sel_hi:[1,1]
    v_pk_mul_f32 v[174:175], v[174:175], v[250:251] op_sel:[0,1] op_sel_hi:[1,1]
    v_pk_mul_f32 v[176:177], v[176:177], v[250:251] op_sel:[0,1] op_sel_hi:[1,1]
    v_pk_mul_f32 v[178:179], v[178:179], v[250:251] op_sel:[0,1] op_sel_hi:[1,1]
    v_cvt_pk_bf16_f32 v180, v172, v173
    v_cvt_pk_bf16_f32 v181, v174, v175
    v_cvt_pk_bf16_f32 v182, v176, v177
    v_cvt_pk_bf16_f32 v183, v178, v179
    ds_write_b128 v238, v[180:183] offset:17408
    s_add_u32 s58, s16, 110592
    buffer_load_dwordx4 v[64:67], v229, s[36:39], s58 offen offset:0
    v_accvgpr_read_b32 v184, a128
    v_accvgpr_read_b32 v185, a129
    v_accvgpr_read_b32 v186, a130
    v_accvgpr_read_b32 v187, a131
    v_accvgpr_read_b32 v188, a156
    v_accvgpr_read_b32 v189, a157
    v_accvgpr_read_b32 v190, a158
    v_accvgpr_read_b32 v191, a159
    v_pk_mul_f32 v[184:185], v[184:185], v[252:253] op_sel_hi:[1,0]
    v_pk_mul_f32 v[186:187], v[186:187], v[252:253] op_sel_hi:[1,0]
    v_pk_mul_f32 v[188:189], v[188:189], v[252:253] op_sel_hi:[1,0]
    v_pk_mul_f32 v[190:191], v[190:191], v[252:253] op_sel_hi:[1,0]
    v_cvt_pk_bf16_f32 v192, v184, v185
    v_cvt_pk_bf16_f32 v193, v186, v187
    v_cvt_pk_bf16_f32 v194, v188, v189
    v_cvt_pk_bf16_f32 v195, v190, v191
    ds_write_b128 v238, v[192:195] offset:18432
    buffer_load_dwordx4 v[68:71], v229, s[36:39], s58 offen offset:1152
    v_accvgpr_read_b32 v196, a132
    v_accvgpr_read_b32 v197, a133
    v_accvgpr_read_b32 v198, a134
    v_accvgpr_read_b32 v199, a135
    v_accvgpr_read_b32 v200, a160
    v_accvgpr_read_b32 v201, a161
    v_accvgpr_read_b32 v202, a162
    v_accvgpr_read_b32 v203, a163
    v_pk_mul_f32 v[196:197], v[196:197], v[252:253] op_sel:[0,1] op_sel_hi:[1,1]
    v_pk_mul_f32 v[198:199], v[198:199], v[252:253] op_sel:[0,1] op_sel_hi:[1,1]
    v_pk_mul_f32 v[200:201], v[200:201], v[252:253] op_sel:[0,1] op_sel_hi:[1,1]
    v_pk_mul_f32 v[202:203], v[202:203], v[252:253] op_sel:[0,1] op_sel_hi:[1,1]
    v_cvt_pk_bf16_f32 v204, v196, v197
    v_cvt_pk_bf16_f32 v205, v198, v199
    v_cvt_pk_bf16_f32 v206, v200, v201
    v_cvt_pk_bf16_f32 v207, v202, v203
    ds_write_b128 v238, v[204:207] offset:19456
    buffer_load_dwordx4 v[72:75], v229, s[36:39], s58 offen offset:2304
    v_accvgpr_read_b32 v160, a136
    v_accvgpr_read_b32 v161, a137
    v_accvgpr_read_b32 v162, a138
    v_accvgpr_read_b32 v163, a139
    v_accvgpr_read_b32 v164, a164
    v_accvgpr_read_b32 v165, a165
    v_accvgpr_read_b32 v166, a166
    v_accvgpr_read_b32 v167, a167
    v_pk_mul_f32 v[160:161], v[160:161], v[254:255] op_sel_hi:[1,0]
    v_pk_mul_f32 v[162:163], v[162:163], v[254:255] op_sel_hi:[1,0]
    v_pk_mul_f32 v[164:165], v[164:165], v[254:255] op_sel_hi:[1,0]
    v_pk_mul_f32 v[166:167], v[166:167], v[254:255] op_sel_hi:[1,0]
    v_cvt_pk_bf16_f32 v168, v160, v161
    v_cvt_pk_bf16_f32 v169, v162, v163
    v_cvt_pk_bf16_f32 v170, v164, v165
    v_cvt_pk_bf16_f32 v171, v166, v167
    s_waitcnt lgkmcnt(10)
    ds_write_b128 v238, v[168:171] offset:20480
    buffer_load_dwordx4 v[76:79], v229, s[36:39], s58 offen offset:3456
    v_accvgpr_read_b32 v172, a168
    v_accvgpr_read_b32 v173, a169
    v_accvgpr_read_b32 v174, a170
    v_accvgpr_read_b32 v175, a171
    v_accvgpr_read_b32 v176, a196
    v_accvgpr_read_b32 v177, a197
    v_accvgpr_read_b32 v178, a198
    v_accvgpr_read_b32 v179, a199
    v_pk_mul_f32 v[172:173], v[172:173], v[248:249] op_sel_hi:[1,0]
    v_pk_mul_f32 v[174:175], v[174:175], v[248:249] op_sel_hi:[1,0]
    v_pk_mul_f32 v[176:177], v[176:177], v[248:249] op_sel_hi:[1,0]
    v_pk_mul_f32 v[178:179], v[178:179], v[248:249] op_sel_hi:[1,0]
    v_cvt_pk_bf16_f32 v180, v172, v173
    v_cvt_pk_bf16_f32 v181, v174, v175
    v_cvt_pk_bf16_f32 v182, v176, v177
    v_cvt_pk_bf16_f32 v183, v178, v179
    ds_write_b128 v238, v[180:183] offset:21504
    s_add_u32 s58, s16, 129024
    buffer_load_dwordx4 v[80:83], v229, s[36:39], s58 offen offset:0
    v_accvgpr_read_b32 v184, a172
    v_accvgpr_read_b32 v185, a173
    v_accvgpr_read_b32 v186, a174
    v_accvgpr_read_b32 v187, a175
    v_accvgpr_read_b32 v188, a200
    v_accvgpr_read_b32 v189, a201
    v_accvgpr_read_b32 v190, a202
    v_accvgpr_read_b32 v191, a203
    v_pk_mul_f32 v[184:185], v[184:185], v[248:249] op_sel:[0,1] op_sel_hi:[1,1]
    v_pk_mul_f32 v[186:187], v[186:187], v[248:249] op_sel:[0,1] op_sel_hi:[1,1]
    v_pk_mul_f32 v[188:189], v[188:189], v[248:249] op_sel:[0,1] op_sel_hi:[1,1]
    v_pk_mul_f32 v[190:191], v[190:191], v[248:249] op_sel:[0,1] op_sel_hi:[1,1]
    v_cvt_pk_bf16_f32 v192, v184, v185
    v_cvt_pk_bf16_f32 v193, v186, v187
    v_cvt_pk_bf16_f32 v194, v188, v189
    v_cvt_pk_bf16_f32 v195, v190, v191
    ds_write_b128 v238, v[192:195] offset:22528
    buffer_load_dwordx4 v[84:87], v229, s[36:39], s58 offen offset:1152
    v_accvgpr_read_b32 v196, a176
    v_accvgpr_read_b32 v197, a177
    v_accvgpr_read_b32 v198, a178
    v_accvgpr_read_b32 v199, a179
    v_accvgpr_read_b32 v200, a204
    v_accvgpr_read_b32 v201, a205
    v_accvgpr_read_b32 v202, a206
    v_accvgpr_read_b32 v203, a207
    v_pk_mul_f32 v[196:197], v[196:197], v[250:251] op_sel_hi:[1,0]
    v_pk_mul_f32 v[198:199], v[198:199], v[250:251] op_sel_hi:[1,0]
    v_pk_mul_f32 v[200:201], v[200:201], v[250:251] op_sel_hi:[1,0]
    v_pk_mul_f32 v[202:203], v[202:203], v[250:251] op_sel_hi:[1,0]
    v_cvt_pk_bf16_f32 v204, v196, v197
    v_cvt_pk_bf16_f32 v205, v198, v199
    v_cvt_pk_bf16_f32 v206, v200, v201
    v_cvt_pk_bf16_f32 v207, v202, v203
    ds_write_b128 v238, v[204:207] offset:23552
    buffer_load_dwordx4 v[88:91], v229, s[36:39], s58 offen offset:2304
    v_accvgpr_read_b32 v160, a180
    v_accvgpr_read_b32 v161, a181
    v_accvgpr_read_b32 v162, a182
    v_accvgpr_read_b32 v163, a183
    v_accvgpr_read_b32 v164, a208
    v_accvgpr_read_b32 v165, a209
    v_accvgpr_read_b32 v166, a210
    v_accvgpr_read_b32 v167, a211
    v_pk_mul_f32 v[160:161], v[160:161], v[250:251] op_sel:[0,1] op_sel_hi:[1,1]
    v_pk_mul_f32 v[162:163], v[162:163], v[250:251] op_sel:[0,1] op_sel_hi:[1,1]
    v_pk_mul_f32 v[164:165], v[164:165], v[250:251] op_sel:[0,1] op_sel_hi:[1,1]
    v_pk_mul_f32 v[166:167], v[166:167], v[250:251] op_sel:[0,1] op_sel_hi:[1,1]
    v_cvt_pk_bf16_f32 v168, v160, v161
    v_cvt_pk_bf16_f32 v169, v162, v163
    v_cvt_pk_bf16_f32 v170, v164, v165
    v_cvt_pk_bf16_f32 v171, v166, v167
    ds_write_b128 v238, v[168:171] offset:24576
    buffer_load_dwordx4 v[92:95], v229, s[36:39], s58 offen offset:3456
    v_accvgpr_read_b32 v172, a184
    v_accvgpr_read_b32 v173, a185
    v_accvgpr_read_b32 v174, a186
    v_accvgpr_read_b32 v175, a187
    v_accvgpr_read_b32 v176, a212
    v_accvgpr_read_b32 v177, a213
    v_accvgpr_read_b32 v178, a214
    v_accvgpr_read_b32 v179, a215
    v_pk_mul_f32 v[172:173], v[172:173], v[252:253] op_sel_hi:[1,0]
    v_pk_mul_f32 v[174:175], v[174:175], v[252:253] op_sel_hi:[1,0]
    v_pk_mul_f32 v[176:177], v[176:177], v[252:253] op_sel_hi:[1,0]
    v_pk_mul_f32 v[178:179], v[178:179], v[252:253] op_sel_hi:[1,0]
    v_cvt_pk_bf16_f32 v180, v172, v173
    v_cvt_pk_bf16_f32 v181, v174, v175
    v_cvt_pk_bf16_f32 v182, v176, v177
    v_cvt_pk_bf16_f32 v183, v178, v179
    s_waitcnt lgkmcnt(10)
    ds_write_b128 v238, v[180:183] offset:25600
    v_accvgpr_read_b32 v184, a188
    v_accvgpr_read_b32 v185, a189
    v_accvgpr_read_b32 v186, a190
    v_accvgpr_read_b32 v187, a191
    v_accvgpr_read_b32 v188, a216
    v_accvgpr_read_b32 v189, a217
    v_accvgpr_read_b32 v190, a218
    v_accvgpr_read_b32 v191, a219
    v_pk_mul_f32 v[184:185], v[184:185], v[252:253] op_sel:[0,1] op_sel_hi:[1,1]
    v_pk_mul_f32 v[186:187], v[186:187], v[252:253] op_sel:[0,1] op_sel_hi:[1,1]
    v_pk_mul_f32 v[188:189], v[188:189], v[252:253] op_sel:[0,1] op_sel_hi:[1,1]
    v_pk_mul_f32 v[190:191], v[190:191], v[252:253] op_sel:[0,1] op_sel_hi:[1,1]
    v_cvt_pk_bf16_f32 v192, v184, v185
    v_cvt_pk_bf16_f32 v193, v186, v187
    v_cvt_pk_bf16_f32 v194, v188, v189
    v_cvt_pk_bf16_f32 v195, v190, v191
    ds_write_b128 v238, v[192:195] offset:26624
    v_accvgpr_read_b32 v196, a192
    v_accvgpr_read_b32 v197, a193
    v_accvgpr_read_b32 v198, a194
    v_accvgpr_read_b32 v199, a195
    v_accvgpr_read_b32 v200, a220
    v_accvgpr_read_b32 v201, a221
    v_accvgpr_read_b32 v202, a222
    v_accvgpr_read_b32 v203, a223
    v_pk_mul_f32 v[196:197], v[196:197], v[254:255] op_sel_hi:[1,0]
    v_pk_mul_f32 v[198:199], v[198:199], v[254:255] op_sel_hi:[1,0]
    v_pk_mul_f32 v[200:201], v[200:201], v[254:255] op_sel_hi:[1,0]
    v_pk_mul_f32 v[202:203], v[202:203], v[254:255] op_sel_hi:[1,0]
    v_cvt_pk_bf16_f32 v204, v196, v197
    v_cvt_pk_bf16_f32 v205, v198, v199
    v_cvt_pk_bf16_f32 v206, v200, v201
    v_cvt_pk_bf16_f32 v207, v202, v203
    ds_write_b128 v238, v[204:207] offset:27648
    s_waitcnt vmcnt(25)
    ds_write_b128 v235, v[216:219] offset:0
    v_perm_b32 v0, v100, v96, s92
    v_perm_b32 v1, v108, v104, s92
    v_perm_b32 v2, v116, v112, s92
    v_perm_b32 v3, v124, v120, s92
    v_perm_b32 v4, v100, v96, s93
    v_perm_b32 v5, v108, v104, s93
    v_perm_b32 v6, v116, v112, s93
    v_perm_b32 v7, v124, v120, s93
    v_perm_b32 v8, v101, v97, s92
    v_perm_b32 v9, v109, v105, s92
    v_perm_b32 v10, v117, v113, s92
    v_perm_b32 v11, v125, v121, s92
    v_perm_b32 v12, v101, v97, s93
    v_perm_b32 v13, v109, v105, s93
    v_perm_b32 v14, v117, v113, s93
    v_perm_b32 v15, v125, v121, s93
    v_perm_b32 v16, v102, v98, s92
    v_perm_b32 v17, v110, v106, s92
    v_perm_b32 v18, v118, v114, s92
    v_perm_b32 v19, v126, v122, s92
    v_perm_b32 v20, v102, v98, s93
    v_perm_b32 v21, v110, v106, s93
    v_perm_b32 v22, v118, v114, s93
    v_perm_b32 v23, v126, v122, s93
    v_perm_b32 v24, v103, v99, s92
    v_perm_b32 v25, v111, v107, s92
    v_perm_b32 v26, v119, v115, s92
    v_perm_b32 v27, v127, v123, s92
    v_perm_b32 v28, v103, v99, s93
    v_perm_b32 v29, v111, v107, s93
    v_perm_b32 v30, v119, v115, s93
    v_perm_b32 v31, v127, v123, s93
    s_mul_i32 s3, s24, 1048576
    s_add_u32 s40, s86, s3
    s_addc_u32 s41, s87, 0
    s_mov_b32 s42, 1048576
    s_lshl_b32 s3, s31, 17
    s_lshl_b32 s4, s26, 12
    s_add_u32 s70, s3, s4
    s_add_u32 s71, s70, 114688
    v_lshlrev_b32 v231, 2, v224
    v_mov_b32 v244, s75
    s_waitcnt lgkmcnt(0)
    s_barrier
    ds_read_b128 v[160:163], v240 offset:0
    ds_read_b128 v[164:167], v240 offset:1024
    ds_read_b128 v[168:171], v240 offset:2048
    ds_read_b128 v[172:175], v240 offset:3072
    ds_read_b128 v[176:179], v240 offset:4096
    ds_read_b128 v[180:183], v240 offset:5120
    ds_read_b128 v[184:187], v240 offset:6144
    s_waitcnt lgkmcnt(0)
    v_mfma_f32_16x16x32_bf16 a[0:3], v[0:3], v[160:163], 0
    v_mfma_f32_16x16x32_bf16 a[4:7], v[0:3], v[164:167], 0
    v_mfma_f32_16x16x32_bf16 a[8:11], v[0:3], v[168:171], 0
    s_add_u32 s58, s17, 0
    buffer_load_dwordx4 v[96:99], v229, s[36:39], s58 offen offset:0
    v_mfma_f32_16x16x32_bf16 a[12:15], v[0:3], v[172:175], 0
    v_mfma_f32_16x16x32_bf16 a[16:19], v[0:3], v[176:179], 0
    s_add_u32 s59, s16, 73728
    buffer_load_dwordx4 v[216:219], v230, s[36:39], s59 offen
    v_mfma_f32_16x16x32_bf16 a[20:23], v[0:3], v[180:183], 0
    v_mfma_f32_16x16x32_bf16 a[24:27], v[0:3], v[184:187], 0
    s_waitcnt vmcnt(19)
    v_mfma_f32_16x16x32_bf16 a[28:31], v[4:7], v[160:163], 0
    v_perm_b32 v0, v132, v128, s92
    v_perm_b32 v1, v140, v136, s92
    v_mfma_f32_16x16x32_bf16 a[32:35], v[4:7], v[164:167], 0
    v_perm_b32 v2, v148, v144, s92
    v_perm_b32 v3, v156, v152, s92
    v_mfma_f32_16x16x32_bf16 a[36:39], v[4:7], v[168:171], 0
    v_mfma_f32_16x16x32_bf16 a[40:43], v[4:7], v[172:175], 0
    buffer_load_dwordx4 v[100:103], v229, s[36:39], s58 offen offset:1152
    v_mfma_f32_16x16x32_bf16 a[44:47], v[4:7], v[176:179], 0
    v_mfma_f32_16x16x32_bf16 a[48:51], v[4:7], v[180:183], 0
    v_mfma_f32_16x16x32_bf16 a[52:55], v[4:7], v[184:187], 0
    v_mfma_f32_16x16x32_bf16 a[56:59], v[8:11], v[160:163], 0
    v_perm_b32 v4, v132, v128, s93
    v_perm_b32 v5, v140, v136, s93
    v_mfma_f32_16x16x32_bf16 a[60:63], v[8:11], v[164:167], 0
    v_perm_b32 v6, v148, v144, s93
    v_perm_b32 v7, v156, v152, s93
    v_mfma_f32_16x16x32_bf16 a[64:67], v[8:11], v[168:171], 0
    v_mfma_f32_16x16x32_bf16 a[68:71], v[8:11], v[172:175], 0
    buffer_load_dwordx4 v[104:107], v229, s[36:39], s58 offen offset:2304
    v_mfma_f32_16x16x32_bf16 a[72:75], v[8:11], v[176:179], 0
    v_mfma_f32_16x16x32_bf16 a[76:79], v[8:11], v[180:183], 0
    v_mfma_f32_16x16x32_bf16 a[80:83], v[8:11], v[184:187], 0
    v_mfma_f32_16x16x32_bf16 a[84:87], v[12:15], v[160:163], 0
    v_perm_b32 v8, v133, v129, s92
    v_perm_b32 v9, v141, v137, s92
    v_mfma_f32_16x16x32_bf16 a[88:91], v[12:15], v[164:167], 0
    v_perm_b32 v10, v149, v145, s92
    v_perm_b32 v11, v157, v153, s92
    v_mfma_f32_16x16x32_bf16 a[92:95], v[12:15], v[168:171], 0
    v_mfma_f32_16x16x32_bf16 a[96:99], v[12:15], v[172:175], 0
    buffer_load_dwordx4 v[108:111], v229, s[36:39], s58 offen offset:3456
    v_mfma_f32_16x16x32_bf16 a[100:103], v[12:15], v[176:179], 0
    v_mfma_f32_16x16x32_bf16 a[104:107], v[12:15], v[180:183], 0
    v_mfma_f32_16x16x32_bf16 a[108:111], v[12:15], v[184:187], 0
    v_mfma_f32_16x16x32_bf16 a[112:115], v[16:19], v[160:163], 0
    v_perm_b32 v12, v133, v129, s93
    v_perm_b32 v13, v141, v137, s93
    v_mfma_f32_16x16x32_bf16 a[116:119], v[16:19], v[164:167], 0
    v_perm_b32 v14, v149, v145, s93
    v_perm_b32 v15, v157, v153, s93
    v_mfma_f32_16x16x32_bf16 a[120:123], v[16:19], v[168:171], 0
    v_mfma_f32_16x16x32_bf16 a[124:127], v[16:19], v[172:175], 0
    s_add_u32 s58, s17, 18432
    buffer_load_dwordx4 v[112:115], v229, s[36:39], s58 offen offset:0
    v_mfma_f32_16x16x32_bf16 a[128:131], v[16:19], v[176:179], 0
    v_mfma_f32_16x16x32_bf16 a[132:135], v[16:19], v[180:183], 0
    ds_read_b64_tr_b16 v[220:221], v236 offset:0
    v_mfma_f32_16x16x32_bf16 a[136:139], v[16:19], v[184:187], 0
    ds_read_b64_tr_b16 v[222:223], v236 offset:512
    v_mfma_f32_16x16x32_bf16 a[140:143], v[20:23], v[160:163], 0
    v_perm_b32 v16, v134, v130, s92
    v_perm_b32 v17, v142, v138, s92
    v_mfma_f32_16x16x32_bf16 a[144:147], v[20:23], v[164:167], 0
    v_perm_b32 v18, v150, v146, s92
    v_perm_b32 v19, v158, v154, s92
    v_mfma_f32_16x16x32_bf16 a[148:151], v[20:23], v[168:171], 0
    v_mfma_f32_16x16x32_bf16 a[152:155], v[20:23], v[172:175], 0
    buffer_load_dwordx4 v[116:119], v229, s[36:39], s58 offen offset:1152
    v_mfma_f32_16x16x32_bf16 a[156:159], v[20:23], v[176:179], 0
    ds_read_b128 v[188:191], v240 offset:7168
    v_mfma_f32_16x16x32_bf16 a[160:163], v[20:23], v[180:183], 0
    v_mfma_f32_16x16x32_bf16 a[164:167], v[20:23], v[184:187], 0
    ds_read_b128 v[192:195], v240 offset:8192
    v_mfma_f32_16x16x32_bf16 a[168:171], v[24:27], v[160:163], 0
    v_perm_b32 v20, v134, v130, s93
    v_perm_b32 v21, v142, v138, s93
    v_mfma_f32_16x16x32_bf16 a[172:175], v[24:27], v[164:167], 0
    v_perm_b32 v22, v150, v146, s93
    v_perm_b32 v23, v158, v154, s93
    v_mfma_f32_16x16x32_bf16 a[176:179], v[24:27], v[168:171], 0
    ds_read_b128 v[196:199], v240 offset:9216
    v_mfma_f32_16x16x32_bf16 a[180:183], v[24:27], v[172:175], 0
    buffer_load_dwordx4 v[120:123], v229, s[36:39], s58 offen offset:2304
    v_mfma_f32_16x16x32_bf16 a[184:187], v[24:27], v[176:179], 0
    ds_read_b128 v[200:203], v240 offset:10240
    v_mfma_f32_16x16x32_bf16 a[188:191], v[24:27], v[180:183], 0
    v_mfma_f32_16x16x32_bf16 a[192:195], v[24:27], v[184:187], 0
    ds_read_b128 v[204:207], v240 offset:11264
    v_mfma_f32_16x16x32_bf16 a[196:199], v[28:31], v[160:163], 0
    v_perm_b32 v24, v135, v131, s92
    v_perm_b32 v25, v143, v139, s92
    v_mfma_f32_16x16x32_bf16 a[200:203], v[28:31], v[164:167], 0
    v_perm_b32 v26, v151, v147, s92
    v_perm_b32 v27, v159, v155, s92
    v_mfma_f32_16x16x32_bf16 a[204:207], v[28:31], v[168:171], 0
    ds_read_b128 v[208:211], v240 offset:12288
    v_mfma_f32_16x16x32_bf16 a[208:211], v[28:31], v[172:175], 0
    buffer_load_dwordx4 v[124:127], v229, s[36:39], s58 offen offset:3456
    v_mfma_f32_16x16x32_bf16 a[212:215], v[28:31], v[176:179], 0
    ds_read_b128 v[212:215], v240 offset:13312
    v_mfma_f32_16x16x32_bf16 a[216:219], v[28:31], v[180:183], 0
    v_mfma_f32_16x16x32_bf16 a[220:223], v[28:31], v[184:187], 0
    s_waitcnt lgkmcnt(7)
    v_mfma_f32_16x16x32_bf16 a[224:227], v[220:223], v[160:163], 0
    v_perm_b32 v28, v135, v131, s93
    v_perm_b32 v29, v143, v139, s93
    v_mfma_f32_16x16x32_bf16 a[228:231], v[220:223], v[164:167], 0
    v_perm_b32 v30, v151, v147, s93
    v_perm_b32 v31, v159, v155, s93
    v_mfma_f32_16x16x32_bf16 a[232:235], v[220:223], v[168:171], 0
    v_mfma_f32_16x16x32_bf16 a[236:239], v[220:223], v[172:175], 0
    s_waitcnt vmcnt(25)
    ds_write_b128 v235, a[252:255] offset:1024
    v_mfma_f32_16x16x32_bf16 a[240:243], v[220:223], v[176:179], 0
    v_mfma_f32_16x16x32_bf16 a[244:247], v[220:223], v[180:183], 0
    v_mfma_f32_16x16x32_bf16 a[248:251], v[220:223], v[184:187], 0
    s_waitcnt lgkmcnt(1)
    v_mfma_f32_16x16x32_bf16 a[0:3], v[0:3], v[188:191], a[0:3]
    v_mfma_f32_16x16x32_bf16 a[4:7], v[0:3], v[192:195], a[4:7]
    v_mfma_f32_16x16x32_bf16 a[8:11], v[0:3], v[196:199], a[8:11]
    s_add_u32 s58, s17, 36864
    buffer_load_dwordx4 v[128:131], v229, s[36:39], s58 offen offset:0
    v_mfma_f32_16x16x32_bf16 a[12:15], v[0:3], v[200:203], a[12:15]
    v_mfma_f32_16x16x32_bf16 a[16:19], v[0:3], v[204:207], a[16:19]
    s_add_u32 s59, s16, 110592
    buffer_load_dwordx4 a[252:255], v230, s[36:39], s59 offen
    v_mfma_f32_16x16x32_bf16 a[20:23], v[0:3], v[208:211], a[20:23]
    v_mfma_f32_16x16x32_bf16 a[24:27], v[0:3], v[212:215], a[24:27]
    s_waitcnt vmcnt(19)
    v_mfma_f32_16x16x32_bf16 a[28:31], v[4:7], v[188:191], a[28:31]
    v_perm_b32 v0, v36, v32, s92
    v_perm_b32 v1, v44, v40, s92
    v_mfma_f32_16x16x32_bf16 a[32:35], v[4:7], v[192:195], a[32:35]
    v_perm_b32 v2, v52, v48, s92
    v_perm_b32 v3, v60, v56, s92
    v_mfma_f32_16x16x32_bf16 a[36:39], v[4:7], v[196:199], a[36:39]
    v_mfma_f32_16x16x32_bf16 a[40:43], v[4:7], v[200:203], a[40:43]
    buffer_load_dwordx4 v[132:135], v229, s[36:39], s58 offen offset:1152
    v_mfma_f32_16x16x32_bf16 a[44:47], v[4:7], v[204:207], a[44:47]
    v_mfma_f32_16x16x32_bf16 a[48:51], v[4:7], v[208:211], a[48:51]
    v_mfma_f32_16x16x32_bf16 a[52:55], v[4:7], v[212:215], a[52:55]
    v_mfma_f32_16x16x32_bf16 a[56:59], v[8:11], v[188:191], a[56:59]
    v_perm_b32 v4, v36, v32, s93
    v_perm_b32 v5, v44, v40, s93
    v_mfma_f32_16x16x32_bf16 a[60:63], v[8:11], v[192:195], a[60:63]
    v_perm_b32 v6, v52, v48, s93
    v_perm_b32 v7, v60, v56, s93
    v_mfma_f32_16x16x32_bf16 a[64:67], v[8:11], v[196:199], a[64:67]
    v_mfma_f32_16x16x32_bf16 a[68:71], v[8:11], v[200:203], a[68:71]
    buffer_load_dwordx4 v[136:139], v229, s[36:39], s58 offen offset:2304
    v_mfma_f32_16x16x32_bf16 a[72:75], v[8:11], v[204:207], a[72:75]
    v_mfma_f32_16x16x32_bf16 a[76:79], v[8:11], v[208:211], a[76:79]
    v_mfma_f32_16x16x32_bf16 a[80:83], v[8:11], v[212:215], a[80:83]
    v_mfma_f32_16x16x32_bf16 a[84:87], v[12:15], v[188:191], a[84:87]
    v_perm_b32 v8, v37, v33, s92
    v_perm_b32 v9, v45, v41, s92
    v_mfma_f32_16x16x32_bf16 a[88:91], v[12:15], v[192:195], a[88:91]
    v_perm_b32 v10, v53, v49, s92
    v_perm_b32 v11, v61, v57, s92
    v_mfma_f32_16x16x32_bf16 a[92:95], v[12:15], v[196:199], a[92:95]
    v_mfma_f32_16x16x32_bf16 a[96:99], v[12:15], v[200:203], a[96:99]
    buffer_load_dwordx4 v[140:143], v229, s[36:39], s58 offen offset:3456
    v_mfma_f32_16x16x32_bf16 a[100:103], v[12:15], v[204:207], a[100:103]
    v_mfma_f32_16x16x32_bf16 a[104:107], v[12:15], v[208:211], a[104:107]
    v_mfma_f32_16x16x32_bf16 a[108:111], v[12:15], v[212:215], a[108:111]
    v_mfma_f32_16x16x32_bf16 a[112:115], v[16:19], v[188:191], a[112:115]
    v_perm_b32 v12, v37, v33, s93
    v_perm_b32 v13, v45, v41, s93
    v_mfma_f32_16x16x32_bf16 a[116:119], v[16:19], v[192:195], a[116:119]
    v_perm_b32 v14, v53, v49, s93
    v_perm_b32 v15, v61, v57, s93
    v_mfma_f32_16x16x32_bf16 a[120:123], v[16:19], v[196:199], a[120:123]
    v_mfma_f32_16x16x32_bf16 a[124:127], v[16:19], v[200:203], a[124:127]
    s_add_u32 s58, s17, 55296
    buffer_load_dwordx4 v[144:147], v229, s[36:39], s58 offen offset:0
    v_mfma_f32_16x16x32_bf16 a[128:131], v[16:19], v[204:207], a[128:131]
    v_mfma_f32_16x16x32_bf16 a[132:135], v[16:19], v[208:211], a[132:135]
    ds_read_b64_tr_b16 v[220:221], v236 offset:1024
    v_mfma_f32_16x16x32_bf16 a[136:139], v[16:19], v[212:215], a[136:139]
    ds_read_b64_tr_b16 v[222:223], v236 offset:1536
    v_mfma_f32_16x16x32_bf16 a[140:143], v[20:23], v[188:191], a[140:143]
    v_perm_b32 v16, v38, v34, s92
    v_perm_b32 v17, v46, v42, s92
    v_mfma_f32_16x16x32_bf16 a[144:147], v[20:23], v[192:195], a[144:147]
    v_perm_b32 v18, v54, v50, s92
    v_perm_b32 v19, v62, v58, s92
    v_mfma_f32_16x16x32_bf16 a[148:151], v[20:23], v[196:199], a[148:151]
    v_mfma_f32_16x16x32_bf16 a[152:155], v[20:23], v[200:203], a[152:155]
    buffer_load_dwordx4 v[148:151], v229, s[36:39], s58 offen offset:1152
    v_mfma_f32_16x16x32_bf16 a[156:159], v[20:23], v[204:207], a[156:159]
    ds_read_b128 v[160:163], v240 offset:14336
    v_mfma_f32_16x16x32_bf16 a[160:163], v[20:23], v[208:211], a[160:163]
    v_mfma_f32_16x16x32_bf16 a[164:167], v[20:23], v[212:215], a[164:167]
    ds_read_b128 v[164:167], v240 offset:15360
    v_mfma_f32_16x16x32_bf16 a[168:171], v[24:27], v[188:191], a[168:171]
    v_perm_b32 v20, v38, v34, s93
    v_perm_b32 v21, v46, v42, s93
    v_mfma_f32_16x16x32_bf16 a[172:175], v[24:27], v[192:195], a[172:175]
    v_perm_b32 v22, v54, v50, s93
    v_perm_b32 v23, v62, v58, s93
    v_mfma_f32_16x16x32_bf16 a[176:179], v[24:27], v[196:199], a[176:179]
    ds_read_b128 v[168:171], v240 offset:16384
    v_mfma_f32_16x16x32_bf16 a[180:183], v[24:27], v[200:203], a[180:183]
    buffer_load_dwordx4 v[152:155], v229, s[36:39], s58 offen offset:2304
    v_mfma_f32_16x16x32_bf16 a[184:187], v[24:27], v[204:207], a[184:187]
    ds_read_b128 v[172:175], v240 offset:17408
    v_mfma_f32_16x16x32_bf16 a[188:191], v[24:27], v[208:211], a[188:191]
    v_mfma_f32_16x16x32_bf16 a[192:195], v[24:27], v[212:215], a[192:195]
    ds_read_b128 v[176:179], v240 offset:18432
    v_mfma_f32_16x16x32_bf16 a[196:199], v[28:31], v[188:191], a[196:199]
    v_perm_b32 v24, v39, v35, s92
    v_perm_b32 v25, v47, v43, s92
    v_mfma_f32_16x16x32_bf16 a[200:203], v[28:31], v[192:195], a[200:203]
    v_perm_b32 v26, v55, v51, s92
    v_perm_b32 v27, v63, v59, s92
    v_mfma_f32_16x16x32_bf16 a[204:207], v[28:31], v[196:199], a[204:207]
    ds_read_b128 v[180:183], v240 offset:19456
    v_mfma_f32_16x16x32_bf16 a[208:211], v[28:31], v[200:203], a[208:211]
    buffer_load_dwordx4 v[156:159], v229, s[36:39], s58 offen offset:3456
    v_mfma_f32_16x16x32_bf16 a[212:215], v[28:31], v[204:207], a[212:215]
    ds_read_b128 v[184:187], v240 offset:20480
    v_mfma_f32_16x16x32_bf16 a[216:219], v[28:31], v[208:211], a[216:219]
    v_mfma_f32_16x16x32_bf16 a[220:223], v[28:31], v[212:215], a[220:223]
    s_waitcnt lgkmcnt(7)
    v_mfma_f32_16x16x32_bf16 a[224:227], v[220:223], v[188:191], a[224:227]
    v_perm_b32 v28, v39, v35, s93
    v_perm_b32 v29, v47, v43, s93
    v_mfma_f32_16x16x32_bf16 a[228:231], v[220:223], v[192:195], a[228:231]
    v_perm_b32 v30, v55, v51, s93
    v_perm_b32 v31, v63, v59, s93
    v_mfma_f32_16x16x32_bf16 a[232:235], v[220:223], v[196:199], a[232:235]
    v_mfma_f32_16x16x32_bf16 a[236:239], v[220:223], v[200:203], a[236:239]
    s_waitcnt vmcnt(16)
    ds_write_b128 v235, v[216:219] offset:0
    v_mfma_f32_16x16x32_bf16 a[240:243], v[220:223], v[204:207], a[240:243]
    v_mfma_f32_16x16x32_bf16 a[244:247], v[220:223], v[208:211], a[244:247]
    v_mfma_f32_16x16x32_bf16 a[248:251], v[220:223], v[212:215], a[248:251]
    s_waitcnt lgkmcnt(1)
    v_mfma_f32_16x16x32_bf16 a[0:3], v[0:3], v[160:163], a[0:3]
    v_mfma_f32_16x16x32_bf16 a[4:7], v[0:3], v[164:167], a[4:7]
    v_mfma_f32_16x16x32_bf16 a[8:11], v[0:3], v[168:171], a[8:11]
    s_add_u32 s58, s17, 73728
    buffer_load_dwordx4 v[32:35], v229, s[36:39], s58 offen offset:0
    v_mfma_f32_16x16x32_bf16 a[12:15], v[0:3], v[172:175], a[12:15]
    v_mfma_f32_16x16x32_bf16 a[16:19], v[0:3], v[176:179], a[16:19]
    s_add_u32 s59, s17, 0
    buffer_load_dwordx4 v[216:219], v230, s[36:39], s59 offen
    v_mfma_f32_16x16x32_bf16 a[20:23], v[0:3], v[180:183], a[20:23]
    v_mfma_f32_16x16x32_bf16 a[24:27], v[0:3], v[184:187], a[24:27]
    v_mfma_f32_16x16x32_bf16 a[28:31], v[4:7], v[160:163], a[28:31]
    v_perm_b32 v0, v68, v64, s92
    v_perm_b32 v1, v76, v72, s92
    v_mfma_f32_16x16x32_bf16 a[32:35], v[4:7], v[164:167], a[32:35]
    v_perm_b32 v2, v84, v80, s92
    v_perm_b32 v3, v92, v88, s92
    v_mfma_f32_16x16x32_bf16 a[36:39], v[4:7], v[168:171], a[36:39]
    v_mfma_f32_16x16x32_bf16 a[40:43], v[4:7], v[172:175], a[40:43]
    buffer_load_dwordx4 v[36:39], v229, s[36:39], s58 offen offset:1152
    v_mfma_f32_16x16x32_bf16 a[44:47], v[4:7], v[176:179], a[44:47]
    v_mfma_f32_16x16x32_bf16 a[48:51], v[4:7], v[180:183], a[48:51]
    v_mfma_f32_16x16x32_bf16 a[52:55], v[4:7], v[184:187], a[52:55]
    v_mfma_f32_16x16x32_bf16 a[56:59], v[8:11], v[160:163], a[56:59]
    v_perm_b32 v4, v68, v64, s93
    v_perm_b32 v5, v76, v72, s93
    v_mfma_f32_16x16x32_bf16 a[60:63], v[8:11], v[164:167], a[60:63]
    v_perm_b32 v6, v84, v80, s93
    v_perm_b32 v7, v92, v88, s93
    v_mfma_f32_16x16x32_bf16 a[64:67], v[8:11], v[168:171], a[64:67]
    v_mfma_f32_16x16x32_bf16 a[68:71], v[8:11], v[172:175], a[68:71]
    buffer_load_dwordx4 v[40:43], v229, s[36:39], s58 offen offset:2304
    v_mfma_f32_16x16x32_bf16 a[72:75], v[8:11], v[176:179], a[72:75]
    v_mfma_f32_16x16x32_bf16 a[76:79], v[8:11], v[180:183], a[76:79]
    v_mfma_f32_16x16x32_bf16 a[80:83], v[8:11], v[184:187], a[80:83]
    v_mfma_f32_16x16x32_bf16 a[84:87], v[12:15], v[160:163], a[84:87]
    v_perm_b32 v8, v69, v65, s92
    v_perm_b32 v9, v77, v73, s92
    v_mfma_f32_16x16x32_bf16 a[88:91], v[12:15], v[164:167], a[88:91]
    v_perm_b32 v10, v85, v81, s92
    v_perm_b32 v11, v93, v89, s92
    v_mfma_f32_16x16x32_bf16 a[92:95], v[12:15], v[168:171], a[92:95]
    v_mfma_f32_16x16x32_bf16 a[96:99], v[12:15], v[172:175], a[96:99]
    buffer_load_dwordx4 v[44:47], v229, s[36:39], s58 offen offset:3456
    v_mfma_f32_16x16x32_bf16 a[100:103], v[12:15], v[176:179], a[100:103]
    v_mfma_f32_16x16x32_bf16 a[104:107], v[12:15], v[180:183], a[104:107]
    v_mfma_f32_16x16x32_bf16 a[108:111], v[12:15], v[184:187], a[108:111]
    v_mfma_f32_16x16x32_bf16 a[112:115], v[16:19], v[160:163], a[112:115]
    v_perm_b32 v12, v69, v65, s93
    v_perm_b32 v13, v77, v73, s93
    v_mfma_f32_16x16x32_bf16 a[116:119], v[16:19], v[164:167], a[116:119]
    v_perm_b32 v14, v85, v81, s93
    v_perm_b32 v15, v93, v89, s93
    v_mfma_f32_16x16x32_bf16 a[120:123], v[16:19], v[168:171], a[120:123]
    v_mfma_f32_16x16x32_bf16 a[124:127], v[16:19], v[172:175], a[124:127]
    s_add_u32 s58, s17, 92160
    buffer_load_dwordx4 v[48:51], v229, s[36:39], s58 offen offset:0
    v_mfma_f32_16x16x32_bf16 a[128:131], v[16:19], v[176:179], a[128:131]
    v_mfma_f32_16x16x32_bf16 a[132:135], v[16:19], v[180:183], a[132:135]
    ds_read_b64_tr_b16 v[220:221], v236 offset:0
    v_mfma_f32_16x16x32_bf16 a[136:139], v[16:19], v[184:187], a[136:139]
    ds_read_b64_tr_b16 v[222:223], v236 offset:512
    v_mfma_f32_16x16x32_bf16 a[140:143], v[20:23], v[160:163], a[140:143]
    v_perm_b32 v16, v70, v66, s92
    v_perm_b32 v17, v78, v74, s92
    v_mfma_f32_16x16x32_bf16 a[144:147], v[20:23], v[164:167], a[144:147]
    v_perm_b32 v18, v86, v82, s92
    v_perm_b32 v19, v94, v90, s92
    v_mfma_f32_16x16x32_bf16 a[148:151], v[20:23], v[168:171], a[148:151]
    v_mfma_f32_16x16x32_bf16 a[152:155], v[20:23], v[172:175], a[152:155]
    buffer_load_dwordx4 v[52:55], v229, s[36:39], s58 offen offset:1152
    v_mfma_f32_16x16x32_bf16 a[156:159], v[20:23], v[176:179], a[156:159]
    ds_read_b128 v[188:191], v240 offset:21504
    v_mfma_f32_16x16x32_bf16 a[160:163], v[20:23], v[180:183], a[160:163]
    v_mfma_f32_16x16x32_bf16 a[164:167], v[20:23], v[184:187], a[164:167]
    ds_read_b128 v[192:195], v240 offset:22528
    v_mfma_f32_16x16x32_bf16 a[168:171], v[24:27], v[160:163], a[168:171]
    v_perm_b32 v20, v70, v66, s93
    v_perm_b32 v21, v78, v74, s93
    v_mfma_f32_16x16x32_bf16 a[172:175], v[24:27], v[164:167], a[172:175]
    v_perm_b32 v22, v86, v82, s93
    v_perm_b32 v23, v94, v90, s93
    v_mfma_f32_16x16x32_bf16 a[176:179], v[24:27], v[168:171], a[176:179]
    ds_read_b128 v[196:199], v240 offset:23552
    v_mfma_f32_16x16x32_bf16 a[180:183], v[24:27], v[172:175], a[180:183]
    buffer_load_dwordx4 v[56:59], v229, s[36:39], s58 offen offset:2304
    v_mfma_f32_16x16x32_bf16 a[184:187], v[24:27], v[176:179], a[184:187]
    ds_read_b128 v[200:203], v240 offset:24576
    v_mfma_f32_16x16x32_bf16 a[188:191], v[24:27], v[180:183], a[188:191]
    v_mfma_f32_16x16x32_bf16 a[192:195], v[24:27], v[184:187], a[192:195]
    ds_read_b128 v[204:207], v240 offset:25600
    v_mfma_f32_16x16x32_bf16 a[196:199], v[28:31], v[160:163], a[196:199]
    v_perm_b32 v24, v71, v67, s92
    v_perm_b32 v25, v79, v75, s92
    v_mfma_f32_16x16x32_bf16 a[200:203], v[28:31], v[164:167], a[200:203]
    v_perm_b32 v26, v87, v83, s92
    v_perm_b32 v27, v95, v91, s92
    v_mfma_f32_16x16x32_bf16 a[204:207], v[28:31], v[168:171], a[204:207]
    ds_read_b128 v[208:211], v240 offset:26624
    v_mfma_f32_16x16x32_bf16 a[208:211], v[28:31], v[172:175], a[208:211]
    buffer_load_dwordx4 v[60:63], v229, s[36:39], s58 offen offset:3456
    v_mfma_f32_16x16x32_bf16 a[212:215], v[28:31], v[176:179], a[212:215]
    ds_read_b128 v[212:215], v240 offset:27648
    v_mfma_f32_16x16x32_bf16 a[216:219], v[28:31], v[180:183], a[216:219]
    v_mfma_f32_16x16x32_bf16 a[220:223], v[28:31], v[184:187], a[220:223]
    s_waitcnt lgkmcnt(7)
    v_mfma_f32_16x16x32_bf16 a[224:227], v[220:223], v[160:163], a[224:227]
    v_perm_b32 v28, v71, v67, s93
    v_perm_b32 v29, v79, v75, s93
    v_mfma_f32_16x16x32_bf16 a[228:231], v[220:223], v[164:167], a[228:231]
    v_perm_b32 v30, v87, v83, s93
    v_perm_b32 v31, v95, v91, s93
    v_mfma_f32_16x16x32_bf16 a[232:235], v[220:223], v[168:171], a[232:235]
    v_mfma_f32_16x16x32_bf16 a[236:239], v[220:223], v[172:175], a[236:239]
    s_waitcnt vmcnt(16)
    ds_write_b128 v235, a[252:255] offset:1024
    v_mfma_f32_16x16x32_bf16 a[240:243], v[220:223], v[176:179], a[240:243]
    v_mfma_f32_16x16x32_bf16 a[244:247], v[220:223], v[180:183], a[244:247]
    v_mfma_f32_16x16x32_bf16 a[248:251], v[220:223], v[184:187], a[248:251]
    s_waitcnt lgkmcnt(1)
    v_mfma_f32_16x16x32_bf16 a[0:3], v[0:3], v[188:191], a[0:3]
    v_mfma_f32_16x16x32_bf16 a[4:7], v[0:3], v[192:195], a[4:7]
    v_mfma_f32_16x16x32_bf16 a[8:11], v[0:3], v[196:199], a[8:11]
    s_add_u32 s58, s17, 110592
    buffer_load_dwordx4 v[64:67], v229, s[36:39], s58 offen offset:0
    v_mfma_f32_16x16x32_bf16 a[12:15], v[0:3], v[200:203], a[12:15]
    v_mfma_f32_16x16x32_bf16 a[16:19], v[0:3], v[204:207], a[16:19]
    s_add_u32 s59, s17, 36864
    buffer_load_dwordx4 a[252:255], v230, s[36:39], s59 offen
    v_mfma_f32_16x16x32_bf16 a[20:23], v[0:3], v[208:211], a[20:23]
    v_mfma_f32_16x16x32_bf16 a[24:27], v[0:3], v[212:215], a[24:27]
    v_mfma_f32_16x16x32_bf16 a[28:31], v[4:7], v[188:191], a[28:31]
    v_perm_b32 v0, v100, v96, s92
    v_perm_b32 v1, v108, v104, s92
    v_mfma_f32_16x16x32_bf16 a[32:35], v[4:7], v[192:195], a[32:35]
    v_perm_b32 v2, v116, v112, s92
    v_perm_b32 v3, v124, v120, s92
    v_mfma_f32_16x16x32_bf16 a[36:39], v[4:7], v[196:199], a[36:39]
    v_mfma_f32_16x16x32_bf16 a[40:43], v[4:7], v[200:203], a[40:43]
    buffer_load_dwordx4 v[68:71], v229, s[36:39], s58 offen offset:1152
    v_mfma_f32_16x16x32_bf16 a[44:47], v[4:7], v[204:207], a[44:47]
    v_mfma_f32_16x16x32_bf16 a[48:51], v[4:7], v[208:211], a[48:51]
    v_mfma_f32_16x16x32_bf16 a[52:55], v[4:7], v[212:215], a[52:55]
    v_mfma_f32_16x16x32_bf16 a[56:59], v[8:11], v[188:191], a[56:59]
    v_perm_b32 v4, v100, v96, s93
    v_perm_b32 v5, v108, v104, s93
    v_mfma_f32_16x16x32_bf16 a[60:63], v[8:11], v[192:195], a[60:63]
    v_perm_b32 v6, v116, v112, s93
    v_perm_b32 v7, v124, v120, s93
    v_mfma_f32_16x16x32_bf16 a[64:67], v[8:11], v[196:199], a[64:67]
    v_mfma_f32_16x16x32_bf16 a[68:71], v[8:11], v[200:203], a[68:71]
    buffer_load_dwordx4 v[72:75], v229, s[36:39], s58 offen offset:2304
    v_mfma_f32_16x16x32_bf16 a[72:75], v[8:11], v[204:207], a[72:75]
    v_mfma_f32_16x16x32_bf16 a[76:79], v[8:11], v[208:211], a[76:79]
    v_mfma_f32_16x16x32_bf16 a[80:83], v[8:11], v[212:215], a[80:83]
    v_mfma_f32_16x16x32_bf16 a[84:87], v[12:15], v[188:191], a[84:87]
    v_perm_b32 v8, v101, v97, s92
    v_perm_b32 v9, v109, v105, s92
    v_mfma_f32_16x16x32_bf16 a[88:91], v[12:15], v[192:195], a[88:91]
    v_perm_b32 v10, v117, v113, s92
    v_perm_b32 v11, v125, v121, s92
    v_mfma_f32_16x16x32_bf16 a[92:95], v[12:15], v[196:199], a[92:95]
    v_mfma_f32_16x16x32_bf16 a[96:99], v[12:15], v[200:203], a[96:99]
    buffer_load_dwordx4 v[76:79], v229, s[36:39], s58 offen offset:3456
    v_mfma_f32_16x16x32_bf16 a[100:103], v[12:15], v[204:207], a[100:103]
    v_mfma_f32_16x16x32_bf16 a[104:107], v[12:15], v[208:211], a[104:107]
    v_mfma_f32_16x16x32_bf16 a[108:111], v[12:15], v[212:215], a[108:111]
    v_mfma_f32_16x16x32_bf16 a[112:115], v[16:19], v[188:191], a[112:115]
    v_perm_b32 v12, v101, v97, s93
    v_perm_b32 v13, v109, v105, s93
    v_mfma_f32_16x16x32_bf16 a[116:119], v[16:19], v[192:195], a[116:119]
    v_perm_b32 v14, v117, v113, s93
    v_perm_b32 v15, v125, v121, s93
    v_mfma_f32_16x16x32_bf16 a[120:123], v[16:19], v[196:199], a[120:123]
    v_mfma_f32_16x16x32_bf16 a[124:127], v[16:19], v[200:203], a[124:127]
    s_add_u32 s58, s17, 129024
    buffer_load_dwordx4 v[80:83], v229, s[36:39], s58 offen offset:0
    v_mfma_f32_16x16x32_bf16 a[128:131], v[16:19], v[204:207], a[128:131]
    v_mfma_f32_16x16x32_bf16 a[132:135], v[16:19], v[208:211], a[132:135]
    ds_read_b64_tr_b16 v[220:221], v236 offset:1024
    v_mfma_f32_16x16x32_bf16 a[136:139], v[16:19], v[212:215], a[136:139]
    ds_read_b64_tr_b16 v[222:223], v236 offset:1536
    v_mfma_f32_16x16x32_bf16 a[140:143], v[20:23], v[188:191], a[140:143]
    v_perm_b32 v16, v102, v98, s92
    v_perm_b32 v17, v110, v106, s92
    v_mfma_f32_16x16x32_bf16 a[144:147], v[20:23], v[192:195], a[144:147]
    v_perm_b32 v18, v118, v114, s92
    v_perm_b32 v19, v126, v122, s92
    v_mfma_f32_16x16x32_bf16 a[148:151], v[20:23], v[196:199], a[148:151]
    v_mfma_f32_16x16x32_bf16 a[152:155], v[20:23], v[200:203], a[152:155]
    buffer_load_dwordx4 v[84:87], v229, s[36:39], s58 offen offset:1152
    v_mfma_f32_16x16x32_bf16 a[156:159], v[20:23], v[204:207], a[156:159]
    ds_read_b128 v[160:163], v241 offset:0
    v_mfma_f32_16x16x32_bf16 a[160:163], v[20:23], v[208:211], a[160:163]
    v_mfma_f32_16x16x32_bf16 a[164:167], v[20:23], v[212:215], a[164:167]
    ds_read_b128 v[164:167], v241 offset:1024
    v_mfma_f32_16x16x32_bf16 a[168:171], v[24:27], v[188:191], a[168:171]
    v_perm_b32 v20, v102, v98, s93
    v_perm_b32 v21, v110, v106, s93
    v_mfma_f32_16x16x32_bf16 a[172:175], v[24:27], v[192:195], a[172:175]
    v_perm_b32 v22, v118, v114, s93
    v_perm_b32 v23, v126, v122, s93
    v_mfma_f32_16x16x32_bf16 a[176:179], v[24:27], v[196:199], a[176:179]
    ds_read_b128 v[168:171], v241 offset:2048
    v_mfma_f32_16x16x32_bf16 a[180:183], v[24:27], v[200:203], a[180:183]
    buffer_load_dwordx4 v[88:91], v229, s[36:39], s58 offen offset:2304
    v_mfma_f32_16x16x32_bf16 a[184:187], v[24:27], v[204:207], a[184:187]
    ds_read_b128 v[172:175], v241 offset:3072
    v_mfma_f32_16x16x32_bf16 a[188:191], v[24:27], v[208:211], a[188:191]
    v_mfma_f32_16x16x32_bf16 a[192:195], v[24:27], v[212:215], a[192:195]
    ds_read_b128 v[176:179], v241 offset:4096
    v_mfma_f32_16x16x32_bf16 a[196:199], v[28:31], v[188:191], a[196:199]
    v_perm_b32 v24, v103, v99, s92
    v_perm_b32 v25, v111, v107, s92
    v_mfma_f32_16x16x32_bf16 a[200:203], v[28:31], v[192:195], a[200:203]
    v_perm_b32 v26, v119, v115, s92
    v_perm_b32 v27, v127, v123, s92
    v_mfma_f32_16x16x32_bf16 a[204:207], v[28:31], v[196:199], a[204:207]
    ds_read_b128 v[180:183], v241 offset:5120
    v_mfma_f32_16x16x32_bf16 a[208:211], v[28:31], v[200:203], a[208:211]
    buffer_load_dwordx4 v[92:95], v229, s[36:39], s58 offen offset:3456
    v_mfma_f32_16x16x32_bf16 a[212:215], v[28:31], v[204:207], a[212:215]
    ds_read_b128 v[184:187], v241 offset:6144
    v_mfma_f32_16x16x32_bf16 a[216:219], v[28:31], v[208:211], a[216:219]
    v_mfma_f32_16x16x32_bf16 a[220:223], v[28:31], v[212:215], a[220:223]
    s_waitcnt lgkmcnt(7)
    v_mfma_f32_16x16x32_bf16 a[224:227], v[220:223], v[188:191], a[224:227]
    v_perm_b32 v28, v103, v99, s93
    v_perm_b32 v29, v111, v107, s93
    v_mfma_f32_16x16x32_bf16 a[228:231], v[220:223], v[192:195], a[228:231]
    v_perm_b32 v30, v119, v115, s93
    v_perm_b32 v31, v127, v123, s93
    v_mfma_f32_16x16x32_bf16 a[232:235], v[220:223], v[196:199], a[232:235]
    v_mfma_f32_16x16x32_bf16 a[236:239], v[220:223], v[200:203], a[236:239]
    s_waitcnt vmcnt(16)
    ds_write_b128 v235, v[216:219] offset:0
    v_mfma_f32_16x16x32_bf16 a[240:243], v[220:223], v[204:207], a[240:243]
    v_mfma_f32_16x16x32_bf16 a[244:247], v[220:223], v[208:211], a[244:247]
    v_mfma_f32_16x16x32_bf16 a[248:251], v[220:223], v[212:215], a[248:251]
    s_waitcnt lgkmcnt(1)
    v_mfma_f32_16x16x32_bf16 a[0:3], v[0:3], v[160:163], a[0:3]
    v_mfma_f32_16x16x32_bf16 a[4:7], v[0:3], v[164:167], a[4:7]
    v_mfma_f32_16x16x32_bf16 a[8:11], v[0:3], v[168:171], a[8:11]
    s_add_u32 s58, s18, 0
    buffer_load_dwordx4 v[96:99], v229, s[36:39], s58 offen offset:0
    v_mfma_f32_16x16x32_bf16 a[12:15], v[0:3], v[172:175], a[12:15]
    v_mfma_f32_16x16x32_bf16 a[16:19], v[0:3], v[176:179], a[16:19]
    s_add_u32 s59, s17, 73728
    buffer_load_dwordx4 v[216:219], v230, s[36:39], s59 offen
    v_mfma_f32_16x16x32_bf16 a[20:23], v[0:3], v[180:183], a[20:23]
    v_mfma_f32_16x16x32_bf16 a[24:27], v[0:3], v[184:187], a[24:27]
    v_mfma_f32_16x16x32_bf16 a[28:31], v[4:7], v[160:163], a[28:31]
    v_perm_b32 v0, v132, v128, s92
    v_perm_b32 v1, v140, v136, s92
    v_mfma_f32_16x16x32_bf16 a[32:35], v[4:7], v[164:167], a[32:35]
    v_perm_b32 v2, v148, v144, s92
    v_perm_b32 v3, v156, v152, s92
    v_mfma_f32_16x16x32_bf16 a[36:39], v[4:7], v[168:171], a[36:39]
    v_mfma_f32_16x16x32_bf16 a[40:43], v[4:7], v[172:175], a[40:43]
    buffer_load_dwordx4 v[100:103], v229, s[36:39], s58 offen offset:1152
    v_mfma_f32_16x16x32_bf16 a[44:47], v[4:7], v[176:179], a[44:47]
    v_mfma_f32_16x16x32_bf16 a[48:51], v[4:7], v[180:183], a[48:51]
    v_mfma_f32_16x16x32_bf16 a[52:55], v[4:7], v[184:187], a[52:55]
    v_mfma_f32_16x16x32_bf16 a[56:59], v[8:11], v[160:163], a[56:59]
    v_perm_b32 v4, v132, v128, s93
    v_perm_b32 v5, v140, v136, s93
    v_mfma_f32_16x16x32_bf16 a[60:63], v[8:11], v[164:167], a[60:63]
    v_perm_b32 v6, v148, v144, s93
    v_perm_b32 v7, v156, v152, s93
    v_mfma_f32_16x16x32_bf16 a[64:67], v[8:11], v[168:171], a[64:67]
    v_mfma_f32_16x16x32_bf16 a[68:71], v[8:11], v[172:175], a[68:71]
    buffer_load_dwordx4 v[104:107], v229, s[36:39], s58 offen offset:2304
    v_mfma_f32_16x16x32_bf16 a[72:75], v[8:11], v[176:179], a[72:75]
    v_mfma_f32_16x16x32_bf16 a[76:79], v[8:11], v[180:183], a[76:79]
    v_mfma_f32_16x16x32_bf16 a[80:83], v[8:11], v[184:187], a[80:83]
    v_mfma_f32_16x16x32_bf16 a[84:87], v[12:15], v[160:163], a[84:87]
    v_perm_b32 v8, v133, v129, s92
    v_perm_b32 v9, v141, v137, s92
    v_mfma_f32_16x16x32_bf16 a[88:91], v[12:15], v[164:167], a[88:91]
    v_perm_b32 v10, v149, v145, s92
    v_perm_b32 v11, v157, v153, s92
    v_mfma_f32_16x16x32_bf16 a[92:95], v[12:15], v[168:171], a[92:95]
    v_mfma_f32_16x16x32_bf16 a[96:99], v[12:15], v[172:175], a[96:99]
    buffer_load_dwordx4 v[108:111], v229, s[36:39], s58 offen offset:3456
    v_mfma_f32_16x16x32_bf16 a[100:103], v[12:15], v[176:179], a[100:103]
    v_mfma_f32_16x16x32_bf16 a[104:107], v[12:15], v[180:183], a[104:107]
    v_mfma_f32_16x16x32_bf16 a[108:111], v[12:15], v[184:187], a[108:111]
    v_mfma_f32_16x16x32_bf16 a[112:115], v[16:19], v[160:163], a[112:115]
    v_perm_b32 v12, v133, v129, s93
    v_perm_b32 v13, v141, v137, s93
    v_mfma_f32_16x16x32_bf16 a[116:119], v[16:19], v[164:167], a[116:119]
    v_perm_b32 v14, v149, v145, s93
    v_perm_b32 v15, v157, v153, s93
    v_mfma_f32_16x16x32_bf16 a[120:123], v[16:19], v[168:171], a[120:123]
    v_mfma_f32_16x16x32_bf16 a[124:127], v[16:19], v[172:175], a[124:127]
    s_add_u32 s58, s18, 18432
    buffer_load_dwordx4 v[112:115], v229, s[36:39], s58 offen offset:0
    v_mfma_f32_16x16x32_bf16 a[128:131], v[16:19], v[176:179], a[128:131]
    v_mfma_f32_16x16x32_bf16 a[132:135], v[16:19], v[180:183], a[132:135]
    ds_read_b64_tr_b16 v[220:221], v236 offset:0
    v_mfma_f32_16x16x32_bf16 a[136:139], v[16:19], v[184:187], a[136:139]
    ds_read_b64_tr_b16 v[222:223], v236 offset:512
    v_mfma_f32_16x16x32_bf16 a[140:143], v[20:23], v[160:163], a[140:143]
    v_perm_b32 v16, v134, v130, s92
    v_perm_b32 v17, v142, v138, s92
    v_mfma_f32_16x16x32_bf16 a[144:147], v[20:23], v[164:167], a[144:147]
    v_perm_b32 v18, v150, v146, s92
    v_perm_b32 v19, v158, v154, s92
    v_mfma_f32_16x16x32_bf16 a[148:151], v[20:23], v[168:171], a[148:151]
    v_mfma_f32_16x16x32_bf16 a[152:155], v[20:23], v[172:175], a[152:155]
    buffer_load_dwordx4 v[116:119], v229, s[36:39], s58 offen offset:1152
    v_mfma_f32_16x16x32_bf16 a[156:159], v[20:23], v[176:179], a[156:159]
    ds_read_b128 v[188:191], v241 offset:7168
    v_mfma_f32_16x16x32_bf16 a[160:163], v[20:23], v[180:183], a[160:163]
    v_mfma_f32_16x16x32_bf16 a[164:167], v[20:23], v[184:187], a[164:167]
    ds_read_b128 v[192:195], v241 offset:8192
    v_mfma_f32_16x16x32_bf16 a[168:171], v[24:27], v[160:163], a[168:171]
    v_perm_b32 v20, v134, v130, s93
    v_perm_b32 v21, v142, v138, s93
    v_mfma_f32_16x16x32_bf16 a[172:175], v[24:27], v[164:167], a[172:175]
    v_perm_b32 v22, v150, v146, s93
    v_perm_b32 v23, v158, v154, s93
    v_mfma_f32_16x16x32_bf16 a[176:179], v[24:27], v[168:171], a[176:179]
    ds_read_b128 v[196:199], v241 offset:9216
    v_mfma_f32_16x16x32_bf16 a[180:183], v[24:27], v[172:175], a[180:183]
    buffer_load_dwordx4 v[120:123], v229, s[36:39], s58 offen offset:2304
    v_mfma_f32_16x16x32_bf16 a[184:187], v[24:27], v[176:179], a[184:187]
    ds_read_b128 v[200:203], v241 offset:10240
    v_mfma_f32_16x16x32_bf16 a[188:191], v[24:27], v[180:183], a[188:191]
    v_mfma_f32_16x16x32_bf16 a[192:195], v[24:27], v[184:187], a[192:195]
    ds_read_b128 v[204:207], v241 offset:11264
    v_mfma_f32_16x16x32_bf16 a[196:199], v[28:31], v[160:163], a[196:199]
    v_perm_b32 v24, v135, v131, s92
    v_perm_b32 v25, v143, v139, s92
    v_mfma_f32_16x16x32_bf16 a[200:203], v[28:31], v[164:167], a[200:203]
    v_perm_b32 v26, v151, v147, s92
    v_perm_b32 v27, v159, v155, s92
    v_mfma_f32_16x16x32_bf16 a[204:207], v[28:31], v[168:171], a[204:207]
    ds_read_b128 v[208:211], v241 offset:12288
    v_mfma_f32_16x16x32_bf16 a[208:211], v[28:31], v[172:175], a[208:211]
    buffer_load_dwordx4 v[124:127], v229, s[36:39], s58 offen offset:3456
    v_mfma_f32_16x16x32_bf16 a[212:215], v[28:31], v[176:179], a[212:215]
    ds_read_b128 v[212:215], v241 offset:13312
    v_mfma_f32_16x16x32_bf16 a[216:219], v[28:31], v[180:183], a[216:219]
    v_mfma_f32_16x16x32_bf16 a[220:223], v[28:31], v[184:187], a[220:223]
    s_waitcnt lgkmcnt(7)
    v_mfma_f32_16x16x32_bf16 a[224:227], v[220:223], v[160:163], a[224:227]
    v_perm_b32 v28, v135, v131, s93
    v_perm_b32 v29, v143, v139, s93
    v_mfma_f32_16x16x32_bf16 a[228:231], v[220:223], v[164:167], a[228:231]
    v_perm_b32 v30, v151, v147, s93
    v_perm_b32 v31, v159, v155, s93
    v_mfma_f32_16x16x32_bf16 a[232:235], v[220:223], v[168:171], a[232:235]
    v_mfma_f32_16x16x32_bf16 a[236:239], v[220:223], v[172:175], a[236:239]
    s_waitcnt vmcnt(16)
    ds_write_b128 v235, a[252:255] offset:1024
    v_mfma_f32_16x16x32_bf16 a[240:243], v[220:223], v[176:179], a[240:243]
    v_mfma_f32_16x16x32_bf16 a[244:247], v[220:223], v[180:183], a[244:247]
    v_mfma_f32_16x16x32_bf16 a[248:251], v[220:223], v[184:187], a[248:251]
    s_waitcnt lgkmcnt(1)
    v_mfma_f32_16x16x32_bf16 a[0:3], v[0:3], v[188:191], a[0:3]
    v_mfma_f32_16x16x32_bf16 a[4:7], v[0:3], v[192:195], a[4:7]
    v_mfma_f32_16x16x32_bf16 a[8:11], v[0:3], v[196:199], a[8:11]
    s_add_u32 s58, s18, 36864
    buffer_load_dwordx4 v[128:131], v229, s[36:39], s58 offen offset:0
    v_mfma_f32_16x16x32_bf16 a[12:15], v[0:3], v[200:203], a[12:15]
    v_mfma_f32_16x16x32_bf16 a[16:19], v[0:3], v[204:207], a[16:19]
    s_add_u32 s59, s17, 110592
    buffer_load_dwordx4 a[252:255], v230, s[36:39], s59 offen
    v_mfma_f32_16x16x32_bf16 a[20:23], v[0:3], v[208:211], a[20:23]
    v_mfma_f32_16x16x32_bf16 a[24:27], v[0:3], v[212:215], a[24:27]
    v_mfma_f32_16x16x32_bf16 a[28:31], v[4:7], v[188:191], a[28:31]
    v_perm_b32 v0, v36, v32, s92
    v_perm_b32 v1, v44, v40, s92
    v_mfma_f32_16x16x32_bf16 a[32:35], v[4:7], v[192:195], a[32:35]
    v_perm_b32 v2, v52, v48, s92
    v_perm_b32 v3, v60, v56, s92
    v_mfma_f32_16x16x32_bf16 a[36:39], v[4:7], v[196:199], a[36:39]
    v_mfma_f32_16x16x32_bf16 a[40:43], v[4:7], v[200:203], a[40:43]
    buffer_load_dwordx4 v[132:135], v229, s[36:39], s58 offen offset:1152
    v_mfma_f32_16x16x32_bf16 a[44:47], v[4:7], v[204:207], a[44:47]
    v_mfma_f32_16x16x32_bf16 a[48:51], v[4:7], v[208:211], a[48:51]
    v_mfma_f32_16x16x32_bf16 a[52:55], v[4:7], v[212:215], a[52:55]
    v_mfma_f32_16x16x32_bf16 a[56:59], v[8:11], v[188:191], a[56:59]
    v_perm_b32 v4, v36, v32, s93
    v_perm_b32 v5, v44, v40, s93
    v_mfma_f32_16x16x32_bf16 a[60:63], v[8:11], v[192:195], a[60:63]
    v_perm_b32 v6, v52, v48, s93
    v_perm_b32 v7, v60, v56, s93
    v_mfma_f32_16x16x32_bf16 a[64:67], v[8:11], v[196:199], a[64:67]
    v_mfma_f32_16x16x32_bf16 a[68:71], v[8:11], v[200:203], a[68:71]
    buffer_load_dwordx4 v[136:139], v229, s[36:39], s58 offen offset:2304
    v_mfma_f32_16x16x32_bf16 a[72:75], v[8:11], v[204:207], a[72:75]
    v_mfma_f32_16x16x32_bf16 a[76:79], v[8:11], v[208:211], a[76:79]
    v_mfma_f32_16x16x32_bf16 a[80:83], v[8:11], v[212:215], a[80:83]
    v_mfma_f32_16x16x32_bf16 a[84:87], v[12:15], v[188:191], a[84:87]
    v_perm_b32 v8, v37, v33, s92
    v_perm_b32 v9, v45, v41, s92
    v_mfma_f32_16x16x32_bf16 a[88:91], v[12:15], v[192:195], a[88:91]
    v_perm_b32 v10, v53, v49, s92
    v_perm_b32 v11, v61, v57, s92
    v_mfma_f32_16x16x32_bf16 a[92:95], v[12:15], v[196:199], a[92:95]
    v_mfma_f32_16x16x32_bf16 a[96:99], v[12:15], v[200:203], a[96:99]
    buffer_load_dwordx4 v[140:143], v229, s[36:39], s58 offen offset:3456
    v_mfma_f32_16x16x32_bf16 a[100:103], v[12:15], v[204:207], a[100:103]
    v_mfma_f32_16x16x32_bf16 a[104:107], v[12:15], v[208:211], a[104:107]
    s_getpc_b64 s[48:49]
L_pc4:
    s_sub_u32 s48, s48, L_pc4-L_pc
    s_subb_u32 s49, s49, 0
    s_mov_b32 s50, L_end-L_pc
    v_lshlrev_b32 v228, 7, v224
    v_mov_b32 v227, 0x40000000
    v_cmp_gt_u32 vcc, 4, v224
    s_nop 1
    v_cndmask_b32 v228, v227, v228, vcc
    buffer_load_dword v227, v228, s[48:51], s101 offen
    v_mfma_f32_16x16x32_bf16 a[108:111], v[12:15], v[212:215], a[108:111]
    v_mfma_f32_16x16x32_bf16 a[112:115], v[16:19], v[188:191], a[112:115]
    v_perm_b32 v12, v37, v33, s93
    v_perm_b32 v13, v45, v41, s93
    v_mfma_f32_16x16x32_bf16 a[116:119], v[16:19], v[192:195], a[116:119]
    v_perm_b32 v14, v53, v49, s93
    v_perm_b32 v15, v61, v57, s93
    v_mfma_f32_16x16x32_bf16 a[120:123], v[16:19], v[196:199], a[120:123]
    v_mfma_f32_16x16x32_bf16 a[124:127], v[16:19], v[200:203], a[124:127]
    s_add_u32 s58, s18, 55296
    buffer_load_dwordx4 v[144:147], v229, s[36:39], s58 offen offset:0
    v_mfma_f32_16x16x32_bf16 a[128:131], v[16:19], v[204:207], a[128:131]
    v_mfma_f32_16x16x32_bf16 a[132:135], v[16:19], v[208:211], a[132:135]
    ds_read_b64_tr_b16 v[220:221], v236 offset:1024
    v_mfma_f32_16x16x32_bf16 a[136:139], v[16:19], v[212:215], a[136:139]
    ds_read_b64_tr_b16 v[222:223], v236 offset:1536
    v_mfma_f32_16x16x32_bf16 a[140:143], v[20:23], v[188:191], a[140:143]
    v_perm_b32 v16, v38, v34, s92
    v_perm_b32 v17, v46, v42, s92
    v_mfma_f32_16x16x32_bf16 a[144:147], v[20:23], v[192:195], a[144:147]
    v_perm_b32 v18, v54, v50, s92
    v_perm_b32 v19, v62, v58, s92
    v_mfma_f32_16x16x32_bf16 a[148:151], v[20:23], v[196:199], a[148:151]
    v_mfma_f32_16x16x32_bf16 a[152:155], v[20:23], v[200:203], a[152:155]
    buffer_load_dwordx4 v[148:151], v229, s[36:39], s58 offen offset:1152
    v_mfma_f32_16x16x32_bf16 a[156:159], v[20:23], v[204:207], a[156:159]
    ds_read_b128 v[160:163], v241 offset:14336
    v_mfma_f32_16x16x32_bf16 a[160:163], v[20:23], v[208:211], a[160:163]
    v_mfma_f32_16x16x32_bf16 a[164:167], v[20:23], v[212:215], a[164:167]
    ds_read_b128 v[164:167], v241 offset:15360
    v_mfma_f32_16x16x32_bf16 a[168:171], v[24:27], v[188:191], a[168:171]
    v_perm_b32 v20, v38, v34, s93
    v_perm_b32 v21, v46, v42, s93
    v_mfma_f32_16x16x32_bf16 a[172:175], v[24:27], v[192:195], a[172:175]
    v_perm_b32 v22, v54, v50, s93
    v_perm_b32 v23, v62, v58, s93
    v_mfma_f32_16x16x32_bf16 a[176:179], v[24:27], v[196:199], a[176:179]
    ds_read_b128 v[168:171], v241 offset:16384
    v_mfma_f32_16x16x32_bf16 a[180:183], v[24:27], v[200:203], a[180:183]
    buffer_load_dwordx4 v[152:155], v229, s[36:39], s58 offen offset:2304
    v_mfma_f32_16x16x32_bf16 a[184:187], v[24:27], v[204:207], a[184:187]
    ds_read_b128 v[172:175], v241 offset:17408
    v_mfma_f32_16x16x32_bf16 a[188:191], v[24:27], v[208:211], a[188:191]
    v_mfma_f32_16x16x32_bf16 a[192:195], v[24:27], v[212:215], a[192:195]
    ds_read_b128 v[176:179], v241 offset:18432
    v_mfma_f32_16x16x32_bf16 a[196:199], v[28:31], v[188:191], a[196:199]
    v_perm_b32 v24, v39, v35, s92
    v_perm_b32 v25, v47, v43, s92
    v_mfma_f32_16x16x32_bf16 a[200:203], v[28:31], v[192:195], a[200:203]
    v_perm_b32 v26, v55, v51, s92
    v_perm_b32 v27, v63, v59, s92
    v_mfma_f32_16x16x32_bf16 a[204:207], v[28:31], v[196:199], a[204:207]
    ds_read_b128 v[180:183], v241 offset:19456
    v_mfma_f32_16x16x32_bf16 a[208:211], v[28:31], v[200:203], a[208:211]
    buffer_load_dwordx4 v[156:159], v229, s[36:39], s58 offen offset:3456
    v_mfma_f32_16x16x32_bf16 a[212:215], v[28:31], v[204:207], a[212:215]
    ds_read_b128 v[184:187], v241 offset:20480
    v_mfma_f32_16x16x32_bf16 a[216:219], v[28:31], v[208:211], a[216:219]
    v_mfma_f32_16x16x32_bf16 a[220:223], v[28:31], v[212:215], a[220:223]
    s_waitcnt lgkmcnt(7)
    v_mfma_f32_16x16x32_bf16 a[224:227], v[220:223], v[188:191], a[224:227]
    v_perm_b32 v28, v39, v35, s93
    v_perm_b32 v29, v47, v43, s93
    v_mfma_f32_16x16x32_bf16 a[228:231], v[220:223], v[192:195], a[228:231]
    v_perm_b32 v30, v55, v51, s93
    v_perm_b32 v31, v63, v59, s93
    v_mfma_f32_16x16x32_bf16 a[232:235], v[220:223], v[196:199], a[232:235]
    v_mfma_f32_16x16x32_bf16 a[236:239], v[220:223], v[200:203], a[236:239]
    s_waitcnt vmcnt(17)
    ds_write_b128 v235, v[216:219] offset:0
    v_mfma_f32_16x16x32_bf16 a[240:243], v[220:223], v[204:207], a[240:243]
    v_mfma_f32_16x16x32_bf16 a[244:247], v[220:223], v[208:211], a[244:247]
    v_mfma_f32_16x16x32_bf16 a[248:251], v[220:223], v[212:215], a[248:251]
    s_waitcnt lgkmcnt(1)
    v_mfma_f32_16x16x32_bf16 a[0:3], v[0:3], v[160:163], a[0:3]
    v_mfma_f32_16x16x32_bf16 a[4:7], v[0:3], v[164:167], a[4:7]
    v_mfma_f32_16x16x32_bf16 a[8:11], v[0:3], v[168:171], a[8:11]
    s_add_u32 s58, s18, 73728
    buffer_load_dwordx4 v[32:35], v229, s[36:39], s58 offen offset:0
    v_mfma_f32_16x16x32_bf16 a[12:15], v[0:3], v[172:175], a[12:15]
    v_mfma_f32_16x16x32_bf16 a[16:19], v[0:3], v[176:179], a[16:19]
    s_add_u32 s59, s18, 0
    buffer_load_dwordx4 v[216:219], v230, s[36:39], s59 offen
    v_mfma_f32_16x16x32_bf16 a[20:23], v[0:3], v[180:183], a[20:23]
    v_mfma_f32_16x16x32_bf16 a[24:27], v[0:3], v[184:187], a[24:27]
    v_mfma_f32_16x16x32_bf16 a[28:31], v[4:7], v[160:163], a[28:31]
    v_perm_b32 v0, v68, v64, s92
    v_perm_b32 v1, v76, v72, s92
    v_mfma_f32_16x16x32_bf16 a[32:35], v[4:7], v[164:167], a[32:35]
    v_perm_b32 v2, v84, v80, s92
    v_perm_b32 v3, v92, v88, s92
    v_mfma_f32_16x16x32_bf16 a[36:39], v[4:7], v[168:171], a[36:39]
    v_mfma_f32_16x16x32_bf16 a[40:43], v[4:7], v[172:175], a[40:43]
    buffer_load_dwordx4 v[36:39], v229, s[36:39], s58 offen offset:1152
    v_mfma_f32_16x16x32_bf16 a[44:47], v[4:7], v[176:179], a[44:47]
    v_mfma_f32_16x16x32_bf16 a[48:51], v[4:7], v[180:183], a[48:51]
    v_mfma_f32_16x16x32_bf16 a[52:55], v[4:7], v[184:187], a[52:55]
    v_mfma_f32_16x16x32_bf16 a[56:59], v[8:11], v[160:163], a[56:59]
    v_perm_b32 v4, v68, v64, s93
    v_perm_b32 v5, v76, v72, s93
    v_mfma_f32_16x16x32_bf16 a[60:63], v[8:11], v[164:167], a[60:63]
    v_perm_b32 v6, v84, v80, s93
    v_perm_b32 v7, v92, v88, s93
    v_mfma_f32_16x16x32_bf16 a[64:67], v[8:11], v[168:171], a[64:67]
    v_mfma_f32_16x16x32_bf16 a[68:71], v[8:11], v[172:175], a[68:71]
    buffer_load_dwordx4 v[40:43], v229, s[36:39], s58 offen offset:2304
    v_mfma_f32_16x16x32_bf16 a[72:75], v[8:11], v[176:179], a[72:75]
    v_mfma_f32_16x16x32_bf16 a[76:79], v[8:11], v[180:183], a[76:79]
    v_mfma_f32_16x16x32_bf16 a[80:83], v[8:11], v[184:187], a[80:83]
    v_mfma_f32_16x16x32_bf16 a[84:87], v[12:15], v[160:163], a[84:87]
    v_perm_b32 v8, v69, v65, s92
    v_perm_b32 v9, v77, v73, s92
    v_mfma_f32_16x16x32_bf16 a[88:91], v[12:15], v[164:167], a[88:91]
    v_perm_b32 v10, v85, v81, s92
    v_perm_b32 v11, v93, v89, s92
    v_mfma_f32_16x16x32_bf16 a[92:95], v[12:15], v[168:171], a[92:95]
    v_mfma_f32_16x16x32_bf16 a[96:99], v[12:15], v[172:175], a[96:99]
    buffer_load_dwordx4 v[44:47], v229, s[36:39], s58 offen offset:3456
    v_mfma_f32_16x16x32_bf16 a[100:103], v[12:15], v[176:179], a[100:103]
    v_mfma_f32_16x16x32_bf16 a[104:107], v[12:15], v[180:183], a[104:107]
    v_mfma_f32_16x16x32_bf16 a[108:111], v[12:15], v[184:187], a[108:111]
    v_mfma_f32_16x16x32_bf16 a[112:115], v[16:19], v[160:163], a[112:115]
    v_perm_b32 v12, v69, v65, s93
    v_perm_b32 v13, v77, v73, s93
    v_mfma_f32_16x16x32_bf16 a[116:119], v[16:19], v[164:167], a[116:119]
    v_perm_b32 v14, v85, v81, s93
    v_perm_b32 v15, v93, v89, s93
    v_mfma_f32_16x16x32_bf16 a[120:123], v[16:19], v[168:171], a[120:123]
    v_mfma_f32_16x16x32_bf16 a[124:127], v[16:19], v[172:175], a[124:127]
    s_add_u32 s58, s18, 92160
    buffer_load_dwordx4 v[48:51], v229, s[36:39], s58 offen offset:0
    v_mfma_f32_16x16x32_bf16 a[128:131], v[16:19], v[176:179], a[128:131]
    v_mfma_f32_16x16x32_bf16 a[132:135], v[16:19], v[180:183], a[132:135]
    ds_read_b64_tr_b16 v[220:221], v236 offset:0
    v_mfma_f32_16x16x32_bf16 a[136:139], v[16:19], v[184:187], a[136:139]
    ds_read_b64_tr_b16 v[222:223], v236 offset:512
    v_mfma_f32_16x16x32_bf16 a[140:143], v[20:23], v[160:163], a[140:143]
    v_perm_b32 v16, v70, v66, s92
    v_perm_b32 v17, v78, v74, s92
    v_mfma_f32_16x16x32_bf16 a[144:147], v[20:23], v[164:167], a[144:147]
    v_perm_b32 v18, v86, v82, s92
    v_perm_b32 v19, v94, v90, s92
    v_mfma_f32_16x16x32_bf16 a[148:151], v[20:23], v[168:171], a[148:151]
    v_mfma_f32_16x16x32_bf16 a[152:155], v[20:23], v[172:175], a[152:155]
    buffer_load_dwordx4 v[52:55], v229, s[36:39], s58 offen offset:1152
    v_mfma_f32_16x16x32_bf16 a[156:159], v[20:23], v[176:179], a[156:159]
    ds_read_b128 v[188:191], v241 offset:21504
    v_mfma_f32_16x16x32_bf16 a[160:163], v[20:23], v[180:183], a[160:163]
    v_mfma_f32_16x16x32_bf16 a[164:167], v[20:23], v[184:187], a[164:167]
    ds_read_b128 v[192:195], v241 offset:22528
    v_mfma_f32_16x16x32_bf16 a[168:171], v[24:27], v[160:163], a[168:171]
    v_perm_b32 v20, v70, v66, s93
    v_perm_b32 v21, v78, v74, s93
    v_mfma_f32_16x16x32_bf16 a[172:175], v[24:27], v[164:167], a[172:175]
    v_perm_b32 v22, v86, v82, s93
    v_perm_b32 v23, v94, v90, s93
    v_mfma_f32_16x16x32_bf16 a[176:179], v[24:27], v[168:171], a[176:179]
    ds_read_b128 v[196:199], v241 offset:23552
    v_mfma_f32_16x16x32_bf16 a[180:183], v[24:27], v[172:175], a[180:183]
    buffer_load_dwordx4 v[56:59], v229, s[36:39], s58 offen offset:2304
    v_mfma_f32_16x16x32_bf16 a[184:187], v[24:27], v[176:179], a[184:187]
    ds_read_b128 v[200:203], v241 offset:24576
    v_mfma_f32_16x16x32_bf16 a[188:191], v[24:27], v[180:183], a[188:191]
    v_mfma_f32_16x16x32_bf16 a[192:195], v[24:27], v[184:187], a[192:195]
    ds_read_b128 v[204:207], v241 offset:25600
    v_mfma_f32_16x16x32_bf16 a[196:199], v[28:31], v[160:163], a[196:199]
    v_perm_b32 v24, v71, v67, s92
    v_perm_b32 v25, v79, v75, s92
    v_mfma_f32_16x16x32_bf16 a[200:203], v[28:31], v[164:167], a[200:203]
    v_perm_b32 v26, v87, v83, s92
    v_perm_b32 v27, v95, v91, s92
    v_mfma_f32_16x16x32_bf16 a[204:207], v[28:31], v[168:171], a[204:207]
    ds_read_b128 v[208:211], v241 offset:26624
    v_mfma_f32_16x16x32_bf16 a[208:211], v[28:31], v[172:175], a[208:211]
    buffer_load_dwordx4 v[60:63], v229, s[36:39], s58 offen offset:3456
    v_mfma_f32_16x16x32_bf16 a[212:215], v[28:31], v[176:179], a[212:215]
    ds_read_b128 v[212:215], v241 offset:27648
    v_mfma_f32_16x16x32_bf16 a[216:219], v[28:31], v[180:183], a[216:219]
    v_mfma_f32_16x16x32_bf16 a[220:223], v[28:31], v[184:187], a[220:223]
    s_waitcnt lgkmcnt(7)
    v_mfma_f32_16x16x32_bf16 a[224:227], v[220:223], v[160:163], a[224:227]
    v_perm_b32 v28, v71, v67, s93
    v_perm_b32 v29, v79, v75, s93
    v_mfma_f32_16x16x32_bf16 a[228:231], v[220:223], v[164:167], a[228:231]
    v_perm_b32 v30, v87, v83, s93
    v_perm_b32 v31, v95, v91, s93
    v_mfma_f32_16x16x32_bf16 a[232:235], v[220:223], v[168:171], a[232:235]
    v_mfma_f32_16x16x32_bf16 a[236:239], v[220:223], v[172:175], a[236:239]
    s_waitcnt vmcnt(17)
    ds_write_b128 v235, a[252:255] offset:1024
    v_mfma_f32_16x16x32_bf16 a[240:243], v[220:223], v[176:179], a[240:243]
    v_mfma_f32_16x16x32_bf16 a[244:247], v[220:223], v[180:183], a[244:247]
    v_mfma_f32_16x16x32_bf16 a[248:251], v[220:223], v[184:187], a[248:251]
    s_waitcnt lgkmcnt(1)
    v_mfma_f32_16x16x32_bf16 a[0:3], v[0:3], v[188:191], a[0:3]
    v_mfma_f32_16x16x32_bf16 a[4:7], v[0:3], v[192:195], a[4:7]
    v_mfma_f32_16x16x32_bf16 a[8:11], v[0:3], v[196:199], a[8:11]
    s_add_u32 s58, s18, 110592
    buffer_load_dwordx4 v[64:67], v229, s[36:39], s58 offen offset:0
    v_mfma_f32_16x16x32_bf16 a[12:15], v[0:3], v[200:203], a[12:15]
    v_mfma_f32_16x16x32_bf16 a[16:19], v[0:3], v[204:207], a[16:19]
    s_add_u32 s59, s18, 36864
    buffer_load_dwordx4 a[252:255], v230, s[36:39], s59 offen
    v_mfma_f32_16x16x32_bf16 a[20:23], v[0:3], v[208:211], a[20:23]
    v_mfma_f32_16x16x32_bf16 a[24:27], v[0:3], v[212:215], a[24:27]
    v_mfma_f32_16x16x32_bf16 a[28:31], v[4:7], v[188:191], a[28:31]
    v_perm_b32 v0, v100, v96, s92
    v_perm_b32 v1, v108, v104, s92
    v_mfma_f32_16x16x32_bf16 a[32:35], v[4:7], v[192:195], a[32:35]
    v_perm_b32 v2, v116, v112, s92
    v_perm_b32 v3, v124, v120, s92
    v_mfma_f32_16x16x32_bf16 a[36:39], v[4:7], v[196:199], a[36:39]
    v_mfma_f32_16x16x32_bf16 a[40:43], v[4:7], v[200:203], a[40:43]
    buffer_load_dwordx4 v[68:71], v229, s[36:39], s58 offen offset:1152
    v_mfma_f32_16x16x32_bf16 a[44:47], v[4:7], v[204:207], a[44:47]
    v_mfma_f32_16x16x32_bf16 a[48:51], v[4:7], v[208:211], a[48:51]
    v_mfma_f32_16x16x32_bf16 a[52:55], v[4:7], v[212:215], a[52:55]
    v_mfma_f32_16x16x32_bf16 a[56:59], v[8:11], v[188:191], a[56:59]
    v_perm_b32 v4, v100, v96, s93
    v_perm_b32 v5, v108, v104, s93
    v_mfma_f32_16x16x32_bf16 a[60:63], v[8:11], v[192:195], a[60:63]
    v_perm_b32 v6, v116, v112, s93
    v_perm_b32 v7, v124, v120, s93
    v_mfma_f32_16x16x32_bf16 a[64:67], v[8:11], v[196:199], a[64:67]
    v_mfma_f32_16x16x32_bf16 a[68:71], v[8:11], v[200:203], a[68:71]
    buffer_load_dwordx4 v[72:75], v229, s[36:39], s58 offen offset:2304
    v_mfma_f32_16x16x32_bf16 a[72:75], v[8:11], v[204:207], a[72:75]
    v_mfma_f32_16x16x32_bf16 a[76:79], v[8:11], v[208:211], a[76:79]
    v_mfma_f32_16x16x32_bf16 a[80:83], v[8:11], v[212:215], a[80:83]
    v_mfma_f32_16x16x32_bf16 a[84:87], v[12:15], v[188:191], a[84:87]
    v_perm_b32 v8, v101, v97, s92
    v_perm_b32 v9, v109, v105, s92
    v_mfma_f32_16x16x32_bf16 a[88:91], v[12:15], v[192:195], a[88:91]
    v_perm_b32 v10, v117, v113, s92
    v_perm_b32 v11, v125, v121, s92
    v_mfma_f32_16x16x32_bf16 a[92:95], v[12:15], v[196:199], a[92:95]
    v_mfma_f32_16x16x32_bf16 a[96:99], v[12:15], v[200:203], a[96:99]
    buffer_load_dwordx4 v[76:79], v229, s[36:39], s58 offen offset:3456
    v_mfma_f32_16x16x32_bf16 a[100:103], v[12:15], v[204:207], a[100:103]
    v_mfma_f32_16x16x32_bf16 a[104:107], v[12:15], v[208:211], a[104:107]
    v_mfma_f32_16x16x32_bf16 a[108:111], v[12:15], v[212:215], a[108:111]
    v_mfma_f32_16x16x32_bf16 a[112:115], v[16:19], v[188:191], a[112:115]
    v_perm_b32 v12, v101, v97, s93
    v_perm_b32 v13, v109, v105, s93
    v_mfma_f32_16x16x32_bf16 a[116:119], v[16:19], v[192:195], a[116:119]
    v_perm_b32 v14, v117, v113, s93
    v_perm_b32 v15, v125, v121, s93
    v_mfma_f32_16x16x32_bf16 a[120:123], v[16:19], v[196:199], a[120:123]
    v_mfma_f32_16x16x32_bf16 a[124:127], v[16:19], v[200:203], a[124:127]
    s_add_u32 s58, s18, 129024
    buffer_load_dwordx4 v[80:83], v229, s[36:39], s58 offen offset:0
    v_mfma_f32_16x16x32_bf16 a[128:131], v[16:19], v[204:207], a[128:131]
    v_mfma_f32_16x16x32_bf16 a[132:135], v[16:19], v[208:211], a[132:135]
    ds_read_b64_tr_b16 v[220:221], v236 offset:1024
    v_mfma_f32_16x16x32_bf16 a[136:139], v[16:19], v[212:215], a[136:139]
    ds_read_b64_tr_b16 v[222:223], v236 offset:1536
    v_mfma_f32_16x16x32_bf16 a[140:143], v[20:23], v[188:191], a[140:143]
    v_perm_b32 v16, v102, v98, s92
    v_perm_b32 v17, v110, v106, s92
    v_mfma_f32_16x16x32_bf16 a[144:147], v[20:23], v[192:195], a[144:147]
    v_perm_b32 v18, v118, v114, s92
    v_perm_b32 v19, v126, v122, s92
    v_mfma_f32_16x16x32_bf16 a[148:151], v[20:23], v[196:199], a[148:151]
    v_mfma_f32_16x16x32_bf16 a[152:155], v[20:23], v[200:203], a[152:155]
    buffer_load_dwordx4 v[84:87], v229, s[36:39], s58 offen offset:1152
    v_mfma_f32_16x16x32_bf16 a[156:159], v[20:23], v[204:207], a[156:159]
    ds_read_b128 v[160:163], v242 offset:0
    v_mfma_f32_16x16x32_bf16 a[160:163], v[20:23], v[208:211], a[160:163]
    v_mfma_f32_16x16x32_bf16 a[164:167], v[20:23], v[212:215], a[164:167]
    ds_read_b128 v[164:167], v242 offset:1024
    v_mfma_f32_16x16x32_bf16 a[168:171], v[24:27], v[188:191], a[168:171]
    v_perm_b32 v20, v102, v98, s93
    v_perm_b32 v21, v110, v106, s93
    v_mfma_f32_16x16x32_bf16 a[172:175], v[24:27], v[192:195], a[172:175]
    v_perm_b32 v22, v118, v114, s93
    v_perm_b32 v23, v126, v122, s93
    v_mfma_f32_16x16x32_bf16 a[176:179], v[24:27], v[196:199], a[176:179]
    ds_read_b128 v[168:171], v242 offset:2048
    v_mfma_f32_16x16x32_bf16 a[180:183], v[24:27], v[200:203], a[180:183]
    buffer_load_dwordx4 v[88:91], v229, s[36:39], s58 offen offset:2304
    v_mfma_f32_16x16x32_bf16 a[184:187], v[24:27], v[204:207], a[184:187]
    ds_read_b128 v[172:175], v242 offset:3072
    v_mfma_f32_16x16x32_bf16 a[188:191], v[24:27], v[208:211], a[188:191]
    v_mfma_f32_16x16x32_bf16 a[192:195], v[24:27], v[212:215], a[192:195]
    ds_read_b128 v[176:179], v242 offset:4096
    v_mfma_f32_16x16x32_bf16 a[196:199], v[28:31], v[188:191], a[196:199]
    v_perm_b32 v24, v103, v99, s92
    v_perm_b32 v25, v111, v107, s92
    v_mfma_f32_16x16x32_bf16 a[200:203], v[28:31], v[192:195], a[200:203]
    v_perm_b32 v26, v119, v115, s92
    v_perm_b32 v27, v127, v123, s92
    v_mfma_f32_16x16x32_bf16 a[204:207], v[28:31], v[196:199], a[204:207]
    ds_read_b128 v[180:183], v242 offset:5120
    v_mfma_f32_16x16x32_bf16 a[208:211], v[28:31], v[200:203], a[208:211]
    buffer_load_dwordx4 v[92:95], v229, s[36:39], s58 offen offset:3456
    v_mfma_f32_16x16x32_bf16 a[212:215], v[28:31], v[204:207], a[212:215]
    ds_read_b128 v[184:187], v242 offset:6144
    v_mfma_f32_16x16x32_bf16 a[216:219], v[28:31], v[208:211], a[216:219]
    v_mfma_f32_16x16x32_bf16 a[220:223], v[28:31], v[212:215], a[220:223]
    s_waitcnt lgkmcnt(7)
    v_mfma_f32_16x16x32_bf16 a[224:227], v[220:223], v[188:191], a[224:227]
    v_perm_b32 v28, v103, v99, s93
    v_perm_b32 v29, v111, v107, s93
    v_mfma_f32_16x16x32_bf16 a[228:231], v[220:223], v[192:195], a[228:231]
    v_perm_b32 v30, v119, v115, s93
    v_perm_b32 v31, v127, v123, s93
    v_mfma_f32_16x16x32_bf16 a[232:235], v[220:223], v[196:199], a[232:235]
    v_mfma_f32_16x16x32_bf16 a[236:239], v[220:223], v[200:203], a[236:239]
    s_waitcnt vmcnt(16)
    ds_write_b128 v235, v[216:219] offset:0
    v_mfma_f32_16x16x32_bf16 a[240:243], v[220:223], v[204:207], a[240:243]
    v_mfma_f32_16x16x32_bf16 a[244:247], v[220:223], v[208:211], a[244:247]
    v_mfma_f32_16x16x32_bf16 a[248:251], v[220:223], v[212:215], a[248:251]
    s_waitcnt lgkmcnt(1)
    v_mfma_f32_16x16x32_bf16 a[0:3], v[0:3], v[160:163], a[0:3]
    v_mfma_f32_16x16x32_bf16 a[4:7], v[0:3], v[164:167], a[4:7]
    v_mfma_f32_16x16x32_bf16 a[8:11], v[0:3], v[168:171], a[8:11]
    s_add_u32 s58, s19, 0
    buffer_load_dwordx4 v[96:99], v229, s[36:39], s58 offen offset:0
    v_mfma_f32_16x16x32_bf16 a[12:15], v[0:3], v[172:175], a[12:15]
    v_mfma_f32_16x16x32_bf16 a[16:19], v[0:3], v[176:179], a[16:19]
    s_add_u32 s59, s18, 73728
    buffer_load_dwordx4 v[216:219], v230, s[36:39], s59 offen
    v_mfma_f32_16x16x32_bf16 a[20:23], v[0:3], v[180:183], a[20:23]
    v_mfma_f32_16x16x32_bf16 a[24:27], v[0:3], v[184:187], a[24:27]
    v_mfma_f32_16x16x32_bf16 a[28:31], v[4:7], v[160:163], a[28:31]
    v_perm_b32 v0, v132, v128, s92
    v_perm_b32 v1, v140, v136, s92
    v_mfma_f32_16x16x32_bf16 a[32:35], v[4:7], v[164:167], a[32:35]
    v_perm_b32 v2, v148, v144, s92
    v_perm_b32 v3, v156, v152, s92
    v_mfma_f32_16x16x32_bf16 a[36:39], v[4:7], v[168:171], a[36:39]
    v_mfma_f32_16x16x32_bf16 a[40:43], v[4:7], v[172:175], a[40:43]
    buffer_load_dwordx4 v[100:103], v229, s[36:39], s58 offen offset:1152
    v_mfma_f32_16x16x32_bf16 a[44:47], v[4:7], v[176:179], a[44:47]
    v_mfma_f32_16x16x32_bf16 a[48:51], v[4:7], v[180:183], a[48:51]
    v_mfma_f32_16x16x32_bf16 a[52:55], v[4:7], v[184:187], a[52:55]
    v_mfma_f32_16x16x32_bf16 a[56:59], v[8:11], v[160:163], a[56:59]
    v_perm_b32 v4, v132, v128, s93
    v_perm_b32 v5, v140, v136, s93
    v_mfma_f32_16x16x32_bf16 a[60:63], v[8:11], v[164:167], a[60:63]
    v_perm_b32 v6, v148, v144, s93
    v_perm_b32 v7, v156, v152, s93
    v_mfma_f32_16x16x32_bf16 a[64:67], v[8:11], v[168:171], a[64:67]
    v_mfma_f32_16x16x32_bf16 a[68:71], v[8:11], v[172:175], a[68:71]
    buffer_load_dwordx4 v[104:107], v229, s[36:39], s58 offen offset:2304
    v_mfma_f32_16x16x32_bf16 a[72:75], v[8:11], v[176:179], a[72:75]
    v_mfma_f32_16x16x32_bf16 a[76:79], v[8:11], v[180:183], a[76:79]
    v_mfma_f32_16x16x32_bf16 a[80:83], v[8:11], v[184:187], a[80:83]
    v_mfma_f32_16x16x32_bf16 a[84:87], v[12:15], v[160:163], a[84:87]
    v_perm_b32 v8, v133, v129, s92
    v_perm_b32 v9, v141, v137, s92
    v_mfma_f32_16x16x32_bf16 a[88:91], v[12:15], v[164:167], a[88:91]
    v_perm_b32 v10, v149, v145, s92
    v_perm_b32 v11, v157, v153, s92
    v_mfma_f32_16x16x32_bf16 a[92:95], v[12:15], v[168:171], a[92:95]
    v_mfma_f32_16x16x32_bf16 a[96:99], v[12:15], v[172:175], a[96:99]
    buffer_load_dwordx4 v[108:111], v229, s[36:39], s58 offen offset:3456
    v_mfma_f32_16x16x32_bf16 a[100:103], v[12:15], v[176:179], a[100:103]
    v_mfma_f32_16x16x32_bf16 a[104:107], v[12:15], v[180:183], a[104:107]
    v_mfma_f32_16x16x32_bf16 a[108:111], v[12:15], v[184:187], a[108:111]
    v_mfma_f32_16x16x32_bf16 a[112:115], v[16:19], v[160:163], a[112:115]
    v_perm_b32 v12, v133, v129, s93
    v_perm_b32 v13, v141, v137, s93
    v_mfma_f32_16x16x32_bf16 a[116:119], v[16:19], v[164:167], a[116:119]
    v_perm_b32 v14, v149, v145, s93
    v_perm_b32 v15, v157, v153, s93
    v_mfma_f32_16x16x32_bf16 a[120:123], v[16:19], v[168:171], a[120:123]
    v_mfma_f32_16x16x32_bf16 a[124:127], v[16:19], v[172:175], a[124:127]
    s_add_u32 s58, s19, 18432
    buffer_load_dwordx4 v[112:115], v229, s[36:39], s58 offen offset:0
    v_mfma_f32_16x16x32_bf16 a[128:131], v[16:19], v[176:179], a[128:131]
    v_mfma_f32_16x16x32_bf16 a[132:135], v[16:19], v[180:183], a[132:135]
    ds_read_b64_tr_b16 v[220:221], v236 offset:0
    v_mfma_f32_16x16x32_bf16 a[136:139], v[16:19], v[184:187], a[136:139]
    ds_read_b64_tr_b16 v[222:223], v236 offset:512
    v_mfma_f32_16x16x32_bf16 a[140:143], v[20:23], v[160:163], a[140:143]
    v_perm_b32 v16, v134, v130, s92
    v_perm_b32 v17, v142, v138, s92
    v_mfma_f32_16x16x32_bf16 a[144:147], v[20:23], v[164:167], a[144:147]
    v_perm_b32 v18, v150, v146, s92
    v_perm_b32 v19, v158, v154, s92
    v_mfma_f32_16x16x32_bf16 a[148:151], v[20:23], v[168:171], a[148:151]
    v_mfma_f32_16x16x32_bf16 a[152:155], v[20:23], v[172:175], a[152:155]
    buffer_load_dwordx4 v[116:119], v229, s[36:39], s58 offen offset:1152
    v_mfma_f32_16x16x32_bf16 a[156:159], v[20:23], v[176:179], a[156:159]
    ds_read_b128 v[188:191], v242 offset:7168
    v_mfma_f32_16x16x32_bf16 a[160:163], v[20:23], v[180:183], a[160:163]
    v_mfma_f32_16x16x32_bf16 a[164:167], v[20:23], v[184:187], a[164:167]
    ds_read_b128 v[192:195], v242 offset:8192
    v_mfma_f32_16x16x32_bf16 a[168:171], v[24:27], v[160:163], a[168:171]
    v_perm_b32 v20, v134, v130, s93
    v_perm_b32 v21, v142, v138, s93
    v_mfma_f32_16x16x32_bf16 a[172:175], v[24:27], v[164:167], a[172:175]
    v_perm_b32 v22, v150, v146, s93
    v_perm_b32 v23, v158, v154, s93
    v_mfma_f32_16x16x32_bf16 a[176:179], v[24:27], v[168:171], a[176:179]
    ds_read_b128 v[196:199], v242 offset:9216
    v_mfma_f32_16x16x32_bf16 a[180:183], v[24:27], v[172:175], a[180:183]
    buffer_load_dwordx4 v[120:123], v229, s[36:39], s58 offen offset:2304
    v_mfma_f32_16x16x32_bf16 a[184:187], v[24:27], v[176:179], a[184:187]
    ds_read_b128 v[200:203], v242 offset:10240
    v_mfma_f32_16x16x32_bf16 a[188:191], v[24:27], v[180:183], a[188:191]
    v_mfma_f32_16x16x32_bf16 a[192:195], v[24:27], v[184:187], a[192:195]
    ds_read_b128 v[204:207], v242 offset:11264
    v_mfma_f32_16x16x32_bf16 a[196:199], v[28:31], v[160:163], a[196:199]
    v_perm_b32 v24, v135, v131, s92
    v_perm_b32 v25, v143, v139, s92
    v_mfma_f32_16x16x32_bf16 a[200:203], v[28:31], v[164:167], a[200:203]
    v_perm_b32 v26, v151, v147, s92
    v_perm_b32 v27, v159, v155, s92
    v_mfma_f32_16x16x32_bf16 a[204:207], v[28:31], v[168:171], a[204:207]
    ds_read_b128 v[208:211], v242 offset:12288
    v_mfma_f32_16x16x32_bf16 a[208:211], v[28:31], v[172:175], a[208:211]
    buffer_load_dwordx4 v[124:127], v229, s[36:39], s58 offen offset:3456
    v_mfma_f32_16x16x32_bf16 a[212:215], v[28:31], v[176:179], a[212:215]
    ds_read_b128 v[212:215], v242 offset:13312
    v_mfma_f32_16x16x32_bf16 a[216:219], v[28:31], v[180:183], a[216:219]
    v_mfma_f32_16x16x32_bf16 a[220:223], v[28:31], v[184:187], a[220:223]
    s_waitcnt lgkmcnt(7)
    v_mfma_f32_16x16x32_bf16 a[224:227], v[220:223], v[160:163], a[224:227]
    v_perm_b32 v28, v135, v131, s93
    v_perm_b32 v29, v143, v139, s93
    v_mfma_f32_16x16x32_bf16 a[228:231], v[220:223], v[164:167], a[228:231]
    v_perm_b32 v30, v151, v147, s93
    v_perm_b32 v31, v159, v155, s93
    v_mfma_f32_16x16x32_bf16 a[232:235], v[220:223], v[168:171], a[232:235]
    v_mfma_f32_16x16x32_bf16 a[236:239], v[220:223], v[172:175], a[236:239]
    s_waitcnt vmcnt(16)
    ds_write_b128 v235, a[252:255] offset:1024
    v_mfma_f32_16x16x32_bf16 a[240:243], v[220:223], v[176:179], a[240:243]
    v_mfma_f32_16x16x32_bf16 a[244:247], v[220:223], v[180:183], a[244:247]
    v_mfma_f32_16x16x32_bf16 a[248:251], v[220:223], v[184:187], a[248:251]
    s_waitcnt lgkmcnt(1)
    v_mfma_f32_16x16x32_bf16 a[0:3], v[0:3], v[188:191], a[0:3]
    v_mfma_f32_16x16x32_bf16 a[4:7], v[0:3], v[192:195], a[4:7]
    v_mfma_f32_16x16x32_bf16 a[8:11], v[0:3], v[196:199], a[8:11]
    s_add_u32 s58, s19, 36864
    buffer_load_dwordx4 v[128:131], v229, s[36:39], s58 offen offset:0
    v_mfma_f32_16x16x32_bf16 a[12:15], v[0:3], v[200:203], a[12:15]
    v_mfma_f32_16x16x32_bf16 a[16:19], v[0:3], v[204:207], a[16:19]
    s_add_u32 s59, s18, 110592
    buffer_load_dwordx4 a[252:255], v230, s[36:39], s59 offen
    v_mfma_f32_16x16x32_bf16 a[20:23], v[0:3], v[208:211], a[20:23]
    v_mfma_f32_16x16x32_bf16 a[24:27], v[0:3], v[212:215], a[24:27]
    v_mfma_f32_16x16x32_bf16 a[28:31], v[4:7], v[188:191], a[28:31]
    v_perm_b32 v0, v36, v32, s92
    v_perm_b32 v1, v44, v40, s92
    v_mfma_f32_16x16x32_bf16 a[32:35], v[4:7], v[192:195], a[32:35]
    v_perm_b32 v2, v52, v48, s92
    v_perm_b32 v3, v60, v56, s92
    v_mfma_f32_16x16x32_bf16 a[36:39], v[4:7], v[196:199], a[36:39]
    v_mfma_f32_16x16x32_bf16 a[40:43], v[4:7], v[200:203], a[40:43]
    buffer_load_dwordx4 v[132:135], v229, s[36:39], s58 offen offset:1152
    v_mfma_f32_16x16x32_bf16 a[44:47], v[4:7], v[204:207], a[44:47]
    v_mfma_f32_16x16x32_bf16 a[48:51], v[4:7], v[208:211], a[48:51]
    v_mfma_f32_16x16x32_bf16 a[52:55], v[4:7], v[212:215], a[52:55]
    v_mfma_f32_16x16x32_bf16 a[56:59], v[8:11], v[188:191], a[56:59]
    v_perm_b32 v4, v36, v32, s93
    v_perm_b32 v5, v44, v40, s93
    v_mfma_f32_16x16x32_bf16 a[60:63], v[8:11], v[192:195], a[60:63]
    v_perm_b32 v6, v52, v48, s93
    v_perm_b32 v7, v60, v56, s93
    v_mfma_f32_16x16x32_bf16 a[64:67], v[8:11], v[196:199], a[64:67]
    v_mfma_f32_16x16x32_bf16 a[68:71], v[8:11], v[200:203], a[68:71]
    buffer_load_dwordx4 v[136:139], v229, s[36:39], s58 offen offset:2304
    v_mfma_f32_16x16x32_bf16 a[72:75], v[8:11], v[204:207], a[72:75]
    v_mfma_f32_16x16x32_bf16 a[76:79], v[8:11], v[208:211], a[76:79]
    v_mfma_f32_16x16x32_bf16 a[80:83], v[8:11], v[212:215], a[80:83]
    v_mfma_f32_16x16x32_bf16 a[84:87], v[12:15], v[188:191], a[84:87]
    v_perm_b32 v8, v37, v33, s92
    v_perm_b32 v9, v45, v41, s92
    v_mfma_f32_16x16x32_bf16 a[88:91], v[12:15], v[192:195], a[88:91]
    v_perm_b32 v10, v53, v49, s92
    v_perm_b32 v11, v61, v57, s92
    v_mfma_f32_16x16x32_bf16 a[92:95], v[12:15], v[196:199], a[92:95]
    v_mfma_f32_16x16x32_bf16 a[96:99], v[12:15], v[200:203], a[96:99]
    buffer_load_dwordx4 v[140:143], v229, s[36:39], s58 offen offset:3456
    v_mfma_f32_16x16x32_bf16 a[100:103], v[12:15], v[204:207], a[100:103]
    v_mfma_f32_16x16x32_bf16 a[104:107], v[12:15], v[208:211], a[104:107]
    v_mfma_f32_16x16x32_bf16 a[108:111], v[12:15], v[212:215], a[108:111]
    v_mfma_f32_16x16x32_bf16 a[112:115], v[16:19], v[188:191], a[112:115]
    v_perm_b32 v12, v37, v33, s93
    v_perm_b32 v13, v45, v41, s93
    v_mfma_f32_16x16x32_bf16 a[116:119], v[16:19], v[192:195], a[116:119]
    v_perm_b32 v14, v53, v49, s93
    v_perm_b32 v15, v61, v57, s93
    v_mfma_f32_16x16x32_bf16 a[120:123], v[16:19], v[196:199], a[120:123]
    v_mfma_f32_16x16x32_bf16 a[124:127], v[16:19], v[200:203], a[124:127]
    s_add_u32 s58, s19, 55296
    buffer_load_dwordx4 v[144:147], v229, s[36:39], s58 offen offset:0
    v_mfma_f32_16x16x32_bf16 a[128:131], v[16:19], v[204:207], a[128:131]
    v_mfma_f32_16x16x32_bf16 a[132:135], v[16:19], v[208:211], a[132:135]
    ds_read_b64_tr_b16 v[220:221], v236 offset:1024
    v_mfma_f32_16x16x32_bf16 a[136:139], v[16:19], v[212:215], a[136:139]
    ds_read_b64_tr_b16 v[222:223], v236 offset:1536
    v_mfma_f32_16x16x32_bf16 a[140:143], v[20:23], v[188:191], a[140:143]
    v_perm_b32 v16, v38, v34, s92
    v_perm_b32 v17, v46, v42, s92
    v_mfma_f32_16x16x32_bf16 a[144:147], v[20:23], v[192:195], a[144:147]
    v_perm_b32 v18, v54, v50, s92
    v_perm_b32 v19, v62, v58, s92
    v_mfma_f32_16x16x32_bf16 a[148:151], v[20:23], v[196:199], a[148:151]
    v_mfma_f32_16x16x32_bf16 a[152:155], v[20:23], v[200:203], a[152:155]
    buffer_load_dwordx4 v[148:151], v229, s[36:39], s58 offen offset:1152
    v_mfma_f32_16x16x32_bf16 a[156:159], v[20:23], v[204:207], a[156:159]
    ds_read_b128 v[160:163], v242 offset:14336
    v_mfma_f32_16x16x32_bf16 a[160:163], v[20:23], v[208:211], a[160:163]
    v_mfma_f32_16x16x32_bf16 a[164:167], v[20:23], v[212:215], a[164:167]
    ds_read_b128 v[164:167], v242 offset:15360
    v_mfma_f32_16x16x32_bf16 a[168:171], v[24:27], v[188:191], a[168:171]
    v_perm_b32 v20, v38, v34, s93
    v_perm_b32 v21, v46, v42, s93
    v_mfma_f32_16x16x32_bf16 a[172:175], v[24:27], v[192:195], a[172:175]
    v_perm_b32 v22, v54, v50, s93
    v_perm_b32 v23, v62, v58, s93
    v_mfma_f32_16x16x32_bf16 a[176:179], v[24:27], v[196:199], a[176:179]
    ds_read_b128 v[168:171], v242 offset:16384
    v_mfma_f32_16x16x32_bf16 a[180:183], v[24:27], v[200:203], a[180:183]
    buffer_load_dwordx4 v[152:155], v229, s[36:39], s58 offen offset:2304
    v_mfma_f32_16x16x32_bf16 a[184:187], v[24:27], v[204:207], a[184:187]
    ds_read_b128 v[172:175], v242 offset:17408
    v_mfma_f32_16x16x32_bf16 a[188:191], v[24:27], v[208:211], a[188:191]
    v_mfma_f32_16x16x32_bf16 a[192:195], v[24:27], v[212:215], a[192:195]
    ds_read_b128 v[176:179], v242 offset:18432
    v_mfma_f32_16x16x32_bf16 a[196:199], v[28:31], v[188:191], a[196:199]
    v_perm_b32 v24, v39, v35, s92
    v_perm_b32 v25, v47, v43, s92
    v_mfma_f32_16x16x32_bf16 a[200:203], v[28:31], v[192:195], a[200:203]
    v_perm_b32 v26, v55, v51, s92
    v_perm_b32 v27, v63, v59, s92
    v_mfma_f32_16x16x32_bf16 a[204:207], v[28:31], v[196:199], a[204:207]
    ds_read_b128 v[180:183], v242 offset:19456
    v_mfma_f32_16x16x32_bf16 a[208:211], v[28:31], v[200:203], a[208:211]
    buffer_load_dwordx4 v[156:159], v229, s[36:39], s58 offen offset:3456
    v_mfma_f32_16x16x32_bf16 a[212:215], v[28:31], v[204:207], a[212:215]
    ds_read_b128 v[184:187], v242 offset:20480
    v_mfma_f32_16x16x32_bf16 a[216:219], v[28:31], v[208:211], a[216:219]
    v_mfma_f32_16x16x32_bf16 a[220:223], v[28:31], v[212:215], a[220:223]
    s_waitcnt lgkmcnt(7)
    v_mfma_f32_16x16x32_bf16 a[224:227], v[220:223], v[188:191], a[224:227]
    v_perm_b32 v28, v39, v35, s93
    v_perm_b32 v29, v47, v43, s93
    v_mfma_f32_16x16x32_bf16 a[228:231], v[220:223], v[192:195], a[228:231]
    v_perm_b32 v30, v55, v51, s93
    v_perm_b32 v31, v63, v59, s93
    v_mfma_f32_16x16x32_bf16 a[232:235], v[220:223], v[196:199], a[232:235]
    v_mfma_f32_16x16x32_bf16 a[236:239], v[220:223], v[200:203], a[236:239]
    s_waitcnt vmcnt(16)
    ds_write_b128 v235, v[216:219] offset:0
    v_mfma_f32_16x16x32_bf16 a[240:243], v[220:223], v[204:207], a[240:243]
    v_mfma_f32_16x16x32_bf16 a[244:247], v[220:223], v[208:211], a[244:247]
    v_mfma_f32_16x16x32_bf16 a[248:251], v[220:223], v[212:215], a[248:251]
    s_waitcnt lgkmcnt(1)
    v_mfma_f32_16x16x32_bf16 a[0:3], v[0:3], v[160:163], a[0:3]
    v_mfma_f32_16x16x32_bf16 a[4:7], v[0:3], v[164:167], a[4:7]
    v_mfma_f32_16x16x32_bf16 a[8:11], v[0:3], v[168:171], a[8:11]
    s_add_u32 s58, s19, 73728
    buffer_load_dwordx4 v[32:35], v229, s[36:39], s58 offen offset:0
    v_mfma_f32_16x16x32_bf16 a[12:15], v[0:3], v[172:175], a[12:15]
    v_mfma_f32_16x16x32_bf16 a[16:19], v[0:3], v[176:179], a[16:19]
    s_add_u32 s59, s19, 0
    buffer_load_dwordx4 v[216:219], v230, s[36:39], s59 offen
    v_mfma_f32_16x16x32_bf16 a[20:23], v[0:3], v[180:183], a[20:23]
    v_mfma_f32_16x16x32_bf16 a[24:27], v[0:3], v[184:187], a[24:27]
    v_mfma_f32_16x16x32_bf16 a[28:31], v[4:7], v[160:163], a[28:31]
    v_perm_b32 v0, v68, v64, s92
    v_perm_b32 v1, v76, v72, s92
    v_mfma_f32_16x16x32_bf16 a[32:35], v[4:7], v[164:167], a[32:35]
    v_perm_b32 v2, v84, v80, s92
    v_perm_b32 v3, v92, v88, s92
    v_mfma_f32_16x16x32_bf16 a[36:39], v[4:7], v[168:171], a[36:39]
    v_mfma_f32_16x16x32_bf16 a[40:43], v[4:7], v[172:175], a[40:43]
    buffer_load_dwordx4 v[36:39], v229, s[36:39], s58 offen offset:1152
    v_mfma_f32_16x16x32_bf16 a[44:47], v[4:7], v[176:179], a[44:47]
    v_mfma_f32_16x16x32_bf16 a[48:51], v[4:7], v[180:183], a[48:51]
    v_mfma_f32_16x16x32_bf16 a[52:55], v[4:7], v[184:187], a[52:55]
    v_mfma_f32_16x16x32_bf16 a[56:59], v[8:11], v[160:163], a[56:59]
    v_perm_b32 v4, v68, v64, s93
    v_perm_b32 v5, v76, v72, s93
    v_mfma_f32_16x16x32_bf16 a[60:63], v[8:11], v[164:167], a[60:63]
    v_perm_b32 v6, v84, v80, s93
    v_perm_b32 v7, v92, v88, s93
    v_mfma_f32_16x16x32_bf16 a[64:67], v[8:11], v[168:171], a[64:67]
    v_mfma_f32_16x16x32_bf16 a[68:71], v[8:11], v[172:175], a[68:71]
    buffer_load_dwordx4 v[40:43], v229, s[36:39], s58 offen offset:2304
    v_mfma_f32_16x16x32_bf16 a[72:75], v[8:11], v[176:179], a[72:75]
    v_mfma_f32_16x16x32_bf16 a[76:79], v[8:11], v[180:183], a[76:79]
    v_mfma_f32_16x16x32_bf16 a[80:83], v[8:11], v[184:187], a[80:83]
    v_mfma_f32_16x16x32_bf16 a[84:87], v[12:15], v[160:163], a[84:87]
    v_perm_b32 v8, v69, v65, s92
    v_perm_b32 v9, v77, v73, s92
    v_mfma_f32_16x16x32_bf16 a[88:91], v[12:15], v[164:167], a[88:91]
    v_perm_b32 v10, v85, v81, s92
    v_perm_b32 v11, v93, v89, s92
    v_mfma_f32_16x16x32_bf16 a[92:95], v[12:15], v[168:171], a[92:95]
    v_mfma_f32_16x16x32_bf16 a[96:99], v[12:15], v[172:175], a[96:99]
    buffer_load_dwordx4 v[44:47], v229, s[36:39], s58 offen offset:3456
    v_mfma_f32_16x16x32_bf16 a[100:103], v[12:15], v[176:179], a[100:103]
    v_mfma_f32_16x16x32_bf16 a[104:107], v[12:15], v[180:183], a[104:107]
    v_mfma_f32_16x16x32_bf16 a[108:111], v[12:15], v[184:187], a[108:111]
    v_mfma_f32_16x16x32_bf16 a[112:115], v[16:19], v[160:163], a[112:115]
    v_perm_b32 v12, v69, v65, s93
    v_perm_b32 v13, v77, v73, s93
    v_mfma_f32_16x16x32_bf16 a[116:119], v[16:19], v[164:167], a[116:119]
    v_perm_b32 v14, v85, v81, s93
    v_perm_b32 v15, v93, v89, s93
    v_mfma_f32_16x16x32_bf16 a[120:123], v[16:19], v[168:171], a[120:123]
    v_mfma_f32_16x16x32_bf16 a[124:127], v[16:19], v[172:175], a[124:127]
    s_add_u32 s58, s19, 92160
    buffer_load_dwordx4 v[48:51], v229, s[36:39], s58 offen offset:0
    v_mfma_f32_16x16x32_bf16 a[128:131], v[16:19], v[176:179], a[128:131]
    v_mfma_f32_16x16x32_bf16 a[132:135], v[16:19], v[180:183], a[132:135]
    ds_read_b64_tr_b16 v[220:221], v236 offset:0
    v_mfma_f32_16x16x32_bf16 a[136:139], v[16:19], v[184:187], a[136:139]
    ds_read_b64_tr_b16 v[222:223], v236 offset:512
    v_mfma_f32_16x16x32_bf16 a[140:143], v[20:23], v[160:163], a[140:143]
    v_perm_b32 v16, v70, v66, s92
    v_perm_b32 v17, v78, v74, s92
    v_mfma_f32_16x16x32_bf16 a[144:147], v[20:23], v[164:167], a[144:147]
    v_perm_b32 v18, v86, v82, s92
    v_perm_b32 v19, v94, v90, s92
    v_mfma_f32_16x16x32_bf16 a[148:151], v[20:23], v[168:171], a[148:151]
    v_mfma_f32_16x16x32_bf16 a[152:155], v[20:23], v[172:175], a[152:155]
    buffer_load_dwordx4 v[52:55], v229, s[36:39], s58 offen offset:1152
    v_mfma_f32_16x16x32_bf16 a[156:159], v[20:23], v[176:179], a[156:159]
    ds_read_b128 v[188:191], v242 offset:21504
    v_mfma_f32_16x16x32_bf16 a[160:163], v[20:23], v[180:183], a[160:163]
    v_mfma_f32_16x16x32_bf16 a[164:167], v[20:23], v[184:187], a[164:167]
    ds_read_b128 v[192:195], v242 offset:22528
    v_mfma_f32_16x16x32_bf16 a[168:171], v[24:27], v[160:163], a[168:171]
    v_perm_b32 v20, v70, v66, s93
    v_perm_b32 v21, v78, v74, s93
    v_mfma_f32_16x16x32_bf16 a[172:175], v[24:27], v[164:167], a[172:175]
    v_perm_b32 v22, v86, v82, s93
    v_perm_b32 v23, v94, v90, s93
    v_mfma_f32_16x16x32_bf16 a[176:179], v[24:27], v[168:171], a[176:179]
    ds_read_b128 v[196:199], v242 offset:23552
    v_mfma_f32_16x16x32_bf16 a[180:183], v[24:27], v[172:175], a[180:183]
    buffer_load_dwordx4 v[56:59], v229, s[36:39], s58 offen offset:2304
    v_mfma_f32_16x16x32_bf16 a[184:187], v[24:27], v[176:179], a[184:187]
    ds_read_b128 v[200:203], v242 offset:24576
    v_mfma_f32_16x16x32_bf16 a[188:191], v[24:27], v[180:183], a[188:191]
    v_mfma_f32_16x16x32_bf16 a[192:195], v[24:27], v[184:187], a[192:195]
    ds_read_b128 v[204:207], v242 offset:25600
    v_mfma_f32_16x16x32_bf16 a[196:199], v[28:31], v[160:163], a[196:199]
    v_perm_b32 v24, v71, v67, s92
    v_perm_b32 v25, v79, v75, s92
    v_mfma_f32_16x16x32_bf16 a[200:203], v[28:31], v[164:167], a[200:203]
    v_perm_b32 v26, v87, v83, s92
    v_perm_b32 v27, v95, v91, s92
    v_mfma_f32_16x16x32_bf16 a[204:207], v[28:31], v[168:171], a[204:207]
    ds_read_b128 v[208:211], v242 offset:26624
    v_mfma_f32_16x16x32_bf16 a[208:211], v[28:31], v[172:175], a[208:211]
    buffer_load_dwordx4 v[60:63], v229, s[36:39], s58 offen offset:3456
    v_mfma_f32_16x16x32_bf16 a[212:215], v[28:31], v[176:179], a[212:215]
    ds_read_b128 v[212:215], v242 offset:27648
    v_mfma_f32_16x16x32_bf16 a[216:219], v[28:31], v[180:183], a[216:219]
    v_mfma_f32_16x16x32_bf16 a[220:223], v[28:31], v[184:187], a[220:223]
    s_waitcnt lgkmcnt(7)
    v_mfma_f32_16x16x32_bf16 a[224:227], v[220:223], v[160:163], a[224:227]
    v_perm_b32 v28, v71, v67, s93
    v_perm_b32 v29, v79, v75, s93
    v_mfma_f32_16x16x32_bf16 a[228:231], v[220:223], v[164:167], a[228:231]
    v_perm_b32 v30, v87, v83, s93
    v_perm_b32 v31, v95, v91, s93
    v_mfma_f32_16x16x32_bf16 a[232:235], v[220:223], v[168:171], a[232:235]
    v_mfma_f32_16x16x32_bf16 a[236:239], v[220:223], v[172:175], a[236:239]
    s_waitcnt vmcnt(16)
    ds_write_b128 v235, a[252:255] offset:1024
    v_mfma_f32_16x16x32_bf16 a[240:243], v[220:223], v[176:179], a[240:243]
    v_mfma_f32_16x16x32_bf16 a[244:247], v[220:223], v[180:183], a[244:247]
    v_mfma_f32_16x16x32_bf16 a[248:251], v[220:223], v[184:187], a[248:251]
    s_waitcnt lgkmcnt(1)
    v_mfma_f32_16x16x32_bf16 a[0:3], v[0:3], v[188:191], a[0:3]
    v_mfma_f32_16x16x32_bf16 a[4:7], v[0:3], v[192:195], a[4:7]
    v_mfma_f32_16x16x32_bf16 a[8:11], v[0:3], v[196:199], a[8:11]
    s_add_u32 s58, s19, 110592
    buffer_load_dwordx4 v[64:67], v229, s[36:39], s58 offen offset:0
    v_mfma_f32_16x16x32_bf16 a[12:15], v[0:3], v[200:203], a[12:15]
    v_mfma_f32_16x16x32_bf16 a[16:19], v[0:3], v[204:207], a[16:19]
    s_add_u32 s59, s19, 36864
    buffer_load_dwordx4 a[252:255], v230, s[36:39], s59 offen
    v_mfma_f32_16x16x32_bf16 a[20:23], v[0:3], v[208:211], a[20:23]
    v_mfma_f32_16x16x32_bf16 a[24:27], v[0:3], v[212:215], a[24:27]
    v_mfma_f32_16x16x32_bf16 a[28:31], v[4:7], v[188:191], a[28:31]
    v_perm_b32 v0, v100, v96, s92
    v_perm_b32 v1, v108, v104, s92
    v_mfma_f32_16x16x32_bf16 a[32:35], v[4:7], v[192:195], a[32:35]
    v_perm_b32 v2, v116, v112, s92
    v_perm_b32 v3, v124, v120, s92
    v_mfma_f32_16x16x32_bf16 a[36:39], v[4:7], v[196:199], a[36:39]
    s_waitcnt vmcnt(11)
    v_perm_b32 v227, v132, v128, s92
    v_perm_b32 v132, v132, v128, s93
    v_mov_b32 v128, v227
    v_mfma_f32_16x16x32_bf16 a[40:43], v[4:7], v[200:203], a[40:43]
    buffer_load_dwordx4 v[68:71], v229, s[36:39], s58 offen offset:1152
    v_perm_b32 v227, v141, v137, s92
    v_perm_b32 v141, v141, v137, s93
    v_mov_b32 v137, v227
    v_mfma_f32_16x16x32_bf16 a[44:47], v[4:7], v[204:207], a[44:47]
    v_perm_b32 v227, v150, v146, s92
    v_perm_b32 v150, v150, v146, s93
    v_mov_b32 v146, v227
    v_mfma_f32_16x16x32_bf16 a[48:51], v[4:7], v[208:211], a[48:51]
    v_perm_b32 v227, v159, v155, s92
    v_perm_b32 v159, v159, v155, s93
    v_mov_b32 v155, v227
    v_mfma_f32_16x16x32_bf16 a[52:55], v[4:7], v[212:215], a[52:55]
    v_perm_b32 v227, v133, v129, s92
    v_perm_b32 v228, v133, v129, s93
    v_perm_b32 v129, v140, v136, s92
    v_mfma_f32_16x16x32_bf16 a[56:59], v[8:11], v[188:191], a[56:59]
    v_perm_b32 v4, v100, v96, s93
    v_perm_b32 v5, v108, v104, s93
    v_mfma_f32_16x16x32_bf16 a[60:63], v[8:11], v[192:195], a[60:63]
    v_perm_b32 v6, v116, v112, s93
    v_perm_b32 v7, v124, v120, s93
    v_mfma_f32_16x16x32_bf16 a[64:67], v[8:11], v[196:199], a[64:67]
    v_perm_b32 v133, v140, v136, s93
    v_mov_b32 v136, v227
    v_mov_b32 v140, v228
    v_mfma_f32_16x16x32_bf16 a[68:71], v[8:11], v[200:203], a[68:71]
    buffer_load_dwordx4 v[72:75], v229, s[36:39], s58 offen offset:2304
    v_perm_b32 v227, v134, v130, s92
    v_perm_b32 v228, v134, v130, s93
    v_perm_b32 v130, v148, v144, s92
    v_mfma_f32_16x16x32_bf16 a[72:75], v[8:11], v[204:207], a[72:75]
    v_perm_b32 v134, v148, v144, s93
    v_mov_b32 v144, v227
    v_mov_b32 v148, v228
    v_mfma_f32_16x16x32_bf16 a[76:79], v[8:11], v[208:211], a[76:79]
    v_perm_b32 v227, v135, v131, s92
    v_perm_b32 v228, v135, v131, s93
    v_perm_b32 v131, v156, v152, s92
    v_mfma_f32_16x16x32_bf16 a[80:83], v[8:11], v[212:215], a[80:83]
    v_perm_b32 v135, v156, v152, s93
    v_mov_b32 v152, v227
    v_mov_b32 v156, v228
    v_mfma_f32_16x16x32_bf16 a[84:87], v[12:15], v[188:191], a[84:87]
    v_perm_b32 v8, v101, v97, s92
    v_perm_b32 v9, v109, v105, s92
    v_mfma_f32_16x16x32_bf16 a[88:91], v[12:15], v[192:195], a[88:91]
    v_perm_b32 v10, v117, v113, s92
    v_perm_b32 v11, v125, v121, s92
    v_mfma_f32_16x16x32_bf16 a[92:95], v[12:15], v[196:199], a[92:95]
    v_perm_b32 v227, v142, v138, s92
    v_perm_b32 v228, v142, v138, s93
    v_perm_b32 v138, v149, v145, s92
    v_mfma_f32_16x16x32_bf16 a[96:99], v[12:15], v[200:203], a[96:99]
    buffer_load_dwordx4 v[76:79], v229, s[36:39], s58 offen offset:3456
    v_perm_b32 v142, v149, v145, s93
    v_mov_b32 v145, v227
    v_mov_b32 v149, v228
    v_mfma_f32_16x16x32_bf16 a[100:103], v[12:15], v[204:207], a[100:103]
    v_perm_b32 v227, v143, v139, s92
    v_perm_b32 v228, v143, v139, s93
    v_perm_b32 v139, v157, v153, s92
    v_mfma_f32_16x16x32_bf16 a[104:107], v[12:15], v[208:211], a[104:107]
    v_perm_b32 v143, v157, v153, s93
    v_mov_b32 v153, v227
    v_mov_b32 v157, v228
    v_mfma_f32_16x16x32_bf16 a[108:111], v[12:15], v[212:215], a[108:111]
    v_perm_b32 v227, v151, v147, s92
    v_perm_b32 v228, v151, v147, s93
    v_perm_b32 v147, v158, v154, s92
    v_mfma_f32_16x16x32_bf16 a[112:115], v[16:19], v[188:191], a[112:115]
    v_perm_b32 v12, v101, v97, s93
    v_perm_b32 v13, v109, v105, s93
    v_mfma_f32_16x16x32_bf16 a[116:119], v[16:19], v[192:195], a[116:119]
    v_perm_b32 v14, v117, v113, s93
    v_perm_b32 v15, v125, v121, s93
    v_mfma_f32_16x16x32_bf16 a[120:123], v[16:19], v[196:199], a[120:123]
    v_perm_b32 v151, v158, v154, s93
    v_mov_b32 v154, v227
    v_mov_b32 v158, v228
    v_mfma_f32_16x16x32_bf16 a[124:127], v[16:19], v[200:203], a[124:127]
    s_add_u32 s58, s19, 129024
    buffer_load_dwordx4 v[80:83], v229, s[36:39], s58 offen offset:0
    v_mfma_f32_16x16x32_bf16 a[128:131], v[16:19], v[204:207], a[128:131]
    v_mfma_f32_16x16x32_bf16 a[132:135], v[16:19], v[208:211], a[132:135]
    ds_read_b64_tr_b16 v[220:221], v236 offset:1024
    v_mfma_f32_16x16x32_bf16 a[136:139], v[16:19], v[212:215], a[136:139]
    ds_read_b64_tr_b16 v[222:223], v236 offset:1536
    s_waitcnt vmcnt(6)
    v_perm_b32 v227, v36, v32, s92
    v_perm_b32 v36, v36, v32, s93
    v_mov_b32 v32, v227
    v_mfma_f32_16x16x32_bf16 a[140:143], v[20:23], v[188:191], a[140:143]
    v_perm_b32 v16, v102, v98, s92
    v_perm_b32 v17, v110, v106, s92
    v_mfma_f32_16x16x32_bf16 a[144:147], v[20:23], v[192:195], a[144:147]
    v_perm_b32 v18, v118, v114, s92
    v_perm_b32 v19, v126, v122, s92
    v_mfma_f32_16x16x32_bf16 a[148:151], v[20:23], v[196:199], a[148:151]
    v_perm_b32 v227, v45, v41, s92
    v_perm_b32 v45, v45, v41, s93
    v_mov_b32 v41, v227
    v_mfma_f32_16x16x32_bf16 a[152:155], v[20:23], v[200:203], a[152:155]
    buffer_load_dwordx4 v[84:87], v229, s[36:39], s58 offen offset:1152
    v_perm_b32 v227, v54, v50, s92
    v_perm_b32 v54, v54, v50, s93
    v_mov_b32 v50, v227
    v_mfma_f32_16x16x32_bf16 a[156:159], v[20:23], v[204:207], a[156:159]
    v_perm_b32 v227, v63, v59, s92
    v_perm_b32 v63, v63, v59, s93
    v_mov_b32 v59, v227
    v_mfma_f32_16x16x32_bf16 a[160:163], v[20:23], v[208:211], a[160:163]
    v_perm_b32 v227, v37, v33, s92
    v_perm_b32 v228, v37, v33, s93
    v_perm_b32 v33, v44, v40, s92
    v_mfma_f32_16x16x32_bf16 a[164:167], v[20:23], v[212:215], a[164:167]
    v_perm_b32 v37, v44, v40, s93
    v_mov_b32 v40, v227
    v_mov_b32 v44, v228
    v_mfma_f32_16x16x32_bf16 a[168:171], v[24:27], v[188:191], a[168:171]
    v_perm_b32 v20, v102, v98, s93
    v_perm_b32 v21, v110, v106, s93
    v_mfma_f32_16x16x32_bf16 a[172:175], v[24:27], v[192:195], a[172:175]
    v_perm_b32 v22, v118, v114, s93
    v_perm_b32 v23, v126, v122, s93
    v_mfma_f32_16x16x32_bf16 a[176:179], v[24:27], v[196:199], a[176:179]
    v_perm_b32 v227, v38, v34, s92
    v_perm_b32 v228, v38, v34, s93
    v_perm_b32 v34, v52, v48, s92
    v_mfma_f32_16x16x32_bf16 a[180:183], v[24:27], v[200:203], a[180:183]
    buffer_load_dwordx4 v[88:91], v229, s[36:39], s58 offen offset:2304
    v_perm_b32 v38, v52, v48, s93
    v_mov_b32 v48, v227
    v_mov_b32 v52, v228
    v_mfma_f32_16x16x32_bf16 a[184:187], v[24:27], v[204:207], a[184:187]
    v_perm_b32 v227, v39, v35, s92
    v_perm_b32 v228, v39, v35, s93
    v_perm_b32 v35, v60, v56, s92
    v_mfma_f32_16x16x32_bf16 a[188:191], v[24:27], v[208:211], a[188:191]
    v_perm_b32 v39, v60, v56, s93
    v_mov_b32 v56, v227
    v_mov_b32 v60, v228
    v_mfma_f32_16x16x32_bf16 a[192:195], v[24:27], v[212:215], a[192:195]
    v_perm_b32 v227, v46, v42, s92
    v_perm_b32 v228, v46, v42, s93
    v_perm_b32 v42, v53, v49, s92
    v_mfma_f32_16x16x32_bf16 a[196:199], v[28:31], v[188:191], a[196:199]
    v_perm_b32 v24, v103, v99, s92
    v_perm_b32 v25, v111, v107, s92
    v_mfma_f32_16x16x32_bf16 a[200:203], v[28:31], v[192:195], a[200:203]
    v_perm_b32 v26, v119, v115, s92
    v_perm_b32 v27, v127, v123, s92
    v_mfma_f32_16x16x32_bf16 a[204:207], v[28:31], v[196:199], a[204:207]
    v_perm_b32 v46, v53, v49, s93
    v_mov_b32 v49, v227
    v_mov_b32 v53, v228
    v_mfma_f32_16x16x32_bf16 a[208:211], v[28:31], v[200:203], a[208:211]
    buffer_load_dwordx4 v[92:95], v229, s[36:39], s58 offen offset:3456
    v_perm_b32 v227, v47, v43, s92
    v_perm_b32 v228, v47, v43, s93
    v_perm_b32 v43, v61, v57, s92
    v_mfma_f32_16x16x32_bf16 a[212:215], v[28:31], v[204:207], a[212:215]
    v_perm_b32 v47, v61, v57, s93
    v_mov_b32 v57, v227
    v_mov_b32 v61, v228
    v_mfma_f32_16x16x32_bf16 a[216:219], v[28:31], v[208:211], a[216:219]
    v_perm_b32 v227, v55, v51, s92
    v_perm_b32 v228, v55, v51, s93
    v_perm_b32 v51, v62, v58, s92
    v_mfma_f32_16x16x32_bf16 a[220:223], v[28:31], v[212:215], a[220:223]
    s_waitcnt lgkmcnt(0)
    v_perm_b32 v55, v62, v58, s93
    v_mov_b32 v58, v227
    v_mov_b32 v62, v228
    v_mfma_f32_16x16x32_bf16 a[224:227], v[220:223], v[188:191], a[224:227]
    v_perm_b32 v28, v103, v99, s93
    v_perm_b32 v29, v111, v107, s93
    v_mfma_f32_16x16x32_bf16 a[228:231], v[220:223], v[192:195], a[228:231]
    v_perm_b32 v30, v119, v115, s93
    v_perm_b32 v31, v127, v123, s93
    v_mfma_f32_16x16x32_bf16 a[232:235], v[220:223], v[196:199], a[232:235]
    v_mfma_f32_16x16x32_bf16 a[236:239], v[220:223], v[200:203], a[236:239]
    ds_write_b128 v235, v[216:219] offset:0
    v_mfma_f32_16x16x32_bf16 a[240:243], v[220:223], v[204:207], a[240:243]
    v_mfma_f32_16x16x32_bf16 a[244:247], v[220:223], v[208:211], a[244:247]
    v_mfma_f32_16x16x32_bf16 a[248:251], v[220:223], v[212:215], a[248:251]
    s_cmp_eq_u32 s31, 7
    s_cselect_b32 s71, s69, s71
    ds_read_b64_tr_b16 v[160:161], v236 offset:0
    ds_read_b64_tr_b16 v[162:163], v236 offset:512
    s_waitcnt vmcnt(7)
    ds_write_b128 v235, a[252:255] offset:1024
    s_add_u32 s59, s19, 73728
    buffer_load_dwordx4 v[216:219], v230, s[36:39], s59 offen
    ds_read_b64_tr_b16 v[164:165], v236 offset:1024
    ds_read_b64_tr_b16 v[166:167], v236 offset:1536
    s_add_u32 s59, s19, 110592
    buffer_load_dwordx4 a[252:255], v230, s[36:39], s59 offen
    ds_read_b128 v[176:179], v243 offset:0
    ds_read_b128 v[180:183], v243 offset:7168
    s_waitcnt lgkmcnt(1)
    v_mfma_f32_16x16x32_bf16 a[0:3], v[0:3], v[176:179], a[0:3]
    ds_read_b128 v[184:187], v243 offset:14336
    v_mfma_f32_16x16x32_bf16 a[28:31], v[4:7], v[176:179], a[28:31]
    s_waitcnt vmcnt(2)
    v_perm_b32 v227, v68, v64, s92
    v_perm_b32 v68, v68, v64, s93
    v_mfma_f32_16x16x32_bf16 a[56:59], v[8:11], v[176:179], a[56:59]
    v_mov_b32 v64, v227
    v_perm_b32 v227, v77, v73, s92
    v_mfma_f32_16x16x32_bf16 a[84:87], v[12:15], v[176:179], a[84:87]
    s_waitcnt vmcnt(1)
    ds_write_b128 v235, v[216:219] offset:0
    v_perm_b32 v77, v77, v73, s93
    v_mov_b32 v73, v227
    v_mfma_f32_16x16x32_bf16 a[112:115], v[16:19], v[176:179], a[112:115]
    v_perm_b32 v227, v86, v82, s92
    v_perm_b32 v86, v86, v82, s93
    v_mfma_f32_16x16x32_bf16 a[140:143], v[20:23], v[176:179], a[140:143]
    ds_read_b64_tr_b16 v[168:169], v236 offset:0
    v_mov_b32 v82, v227
    v_perm_b32 v227, v95, v91, s92
    v_mfma_f32_16x16x32_bf16 a[168:171], v[24:27], v[176:179], a[168:171]
    ds_read_b64_tr_b16 v[170:171], v236 offset:512
    v_perm_b32 v95, v95, v91, s93
    v_mov_b32 v91, v227
    v_mfma_f32_16x16x32_bf16 a[196:199], v[28:31], v[176:179], a[196:199]
    v_perm_b32 v227, v69, v65, s92
    v_perm_b32 v228, v69, v65, s93
    v_mfma_f32_16x16x32_bf16 a[224:227], v[160:163], v[176:179], a[224:227]
    s_waitcnt lgkmcnt(4)
    v_perm_b32 v65, v76, v72, s92
    v_perm_b32 v69, v76, v72, s93
    v_mfma_f32_16x16x32_bf16 a[0:3], v[128:131], v[180:183], a[0:3]
    ds_read_b128 v[176:179], v243 offset:21504
    v_mov_b32 v72, v227
    v_mov_b32 v76, v228
    v_mfma_f32_16x16x32_bf16 a[28:31], v[132:135], v[180:183], a[28:31]
    v_perm_b32 v227, v70, v66, s92
    v_perm_b32 v228, v70, v66, s93
    v_mfma_f32_16x16x32_bf16 a[56:59], v[136:139], v[180:183], a[56:59]
    s_waitcnt vmcnt(0)
    ds_write_b128 v235, a[252:255] offset:1024
    v_perm_b32 v66, v84, v80, s92
    v_perm_b32 v70, v84, v80, s93
    v_mfma_f32_16x16x32_bf16 a[84:87], v[140:143], v[180:183], a[84:87]
    v_mov_b32 v80, v227
    v_mov_b32 v84, v228
    v_mfma_f32_16x16x32_bf16 a[112:115], v[144:147], v[180:183], a[112:115]
    ds_read_b64_tr_b16 v[172:173], v236 offset:1024
    v_perm_b32 v227, v71, v67, s92
    v_perm_b32 v228, v71, v67, s93
    v_mfma_f32_16x16x32_bf16 a[140:143], v[148:151], v[180:183], a[140:143]
    ds_read_b64_tr_b16 v[174:175], v236 offset:1536
    v_perm_b32 v67, v92, v88, s92
    v_perm_b32 v71, v92, v88, s93
    v_mfma_f32_16x16x32_bf16 a[168:171], v[152:155], v[180:183], a[168:171]
    v_mov_b32 v88, v227
    v_mov_b32 v92, v228
    v_mfma_f32_16x16x32_bf16 a[196:199], v[156:159], v[180:183], a[196:199]
    v_perm_b32 v227, v78, v74, s92
    v_perm_b32 v228, v78, v74, s93
    v_mfma_f32_16x16x32_bf16 a[224:227], v[164:167], v[180:183], a[224:227]
    s_waitcnt lgkmcnt(7)
    v_perm_b32 v74, v85, v81, s92
    v_perm_b32 v78, v85, v81, s93
    v_mfma_f32_16x16x32_bf16 a[0:3], v[32:35], v[184:187], a[0:3]
    ds_read_b128 v[180:183], v243 offset:1024
    v_mov_b32 v81, v227
    v_mov_b32 v85, v228
    v_mfma_f32_16x16x32_bf16 a[28:31], v[36:39], v[184:187], a[28:31]
    v_perm_b32 v227, v79, v75, s92
    v_perm_b32 v228, v79, v75, s93
    v_mfma_f32_16x16x32_bf16 a[56:59], v[40:43], v[184:187], a[56:59]
    v_perm_b32 v75, v93, v89, s92
    v_perm_b32 v79, v93, v89, s93
    v_mfma_f32_16x16x32_bf16 a[84:87], v[44:47], v[184:187], a[84:87]
    v_mov_b32 v89, v227
    v_mov_b32 v93, v228
    v_mfma_f32_16x16x32_bf16 a[112:115], v[48:51], v[184:187], a[112:115]
    v_perm_b32 v227, v87, v83, s92
    v_perm_b32 v228, v87, v83, s93
    v_mfma_f32_16x16x32_bf16 a[140:143], v[52:55], v[184:187], a[140:143]
    v_perm_b32 v83, v94, v90, s92
    v_perm_b32 v87, v94, v90, s93
    v_mfma_f32_16x16x32_bf16 a[168:171], v[56:59], v[184:187], a[168:171]
    s_waitcnt lgkmcnt(5)
    v_mov_b32 v90, v227
    v_mov_b32 v94, v228
    v_mfma_f32_16x16x32_bf16 a[196:199], v[60:63], v[184:187], a[196:199]
    v_mfma_f32_16x16x32_bf16 a[224:227], v[168:171], v[184:187], a[224:227]
    s_waitcnt lgkmcnt(4)
    v_mfma_f32_16x16x32_bf16 a[0:3], v[64:67], v[176:179], a[0:3]
    ds_read_b128 v[184:187], v243 offset:8192
    v_mfma_f32_16x16x32_bf16 a[28:31], v[68:71], v[176:179], a[28:31]
    v_mfma_f32_16x16x32_bf16 a[56:59], v[72:75], v[176:179], a[56:59]
    v_mfma_f32_16x16x32_bf16 a[84:87], v[76:79], v[176:179], a[84:87]
    v_mfma_f32_16x16x32_bf16 a[112:115], v[80:83], v[176:179], a[112:115]
    v_mfma_f32_16x16x32_bf16 a[140:143], v[84:87], v[176:179], a[140:143]
    v_mfma_f32_16x16x32_bf16 a[168:171], v[88:91], v[176:179], a[168:171]
    s_waitcnt lgkmcnt(2)
    v_mfma_f32_16x16x32_bf16 a[196:199], v[92:95], v[176:179], a[196:199]
    v_mfma_f32_16x16x32_bf16 a[224:227], v[172:175], v[176:179], a[224:227]
    s_waitcnt lgkmcnt(1)
    v_mfma_f32_16x16x32_bf16 a[4:7], v[0:3], v[180:183], a[4:7]
    ds_read_b128 v[176:179], v243 offset:15360
    v_mfma_f32_16x16x32_bf16 a[32:35], v[4:7], v[180:183], a[32:35]
    buffer_load_dword v228, v244, s[76:79], 0 offen sc1
    v_mfma_f32_16x16x32_bf16 a[60:63], v[8:11], v[180:183], a[60:63]
    v_mfma_f32_16x16x32_bf16 a[88:91], v[12:15], v[180:183], a[88:91]
    v_accvgpr_read_b32 v96, a0
    v_accvgpr_read_b32 v97, a28
    v_mfma_f32_16x16x32_bf16 a[116:119], v[16:19], v[180:183], a[116:119]
    v_accvgpr_read_b32 v98, a56
    v_accvgpr_read_b32 v99, a84
    v_mfma_f32_16x16x32_bf16 a[144:147], v[20:23], v[180:183], a[144:147]
    v_accvgpr_read_b32 v100, a112
    v_accvgpr_read_b32 v101, a140
    v_mfma_f32_16x16x32_bf16 a[172:175], v[24:27], v[180:183], a[172:175]
    v_accvgpr_read_b32 v102, a168
    v_accvgpr_read_b32 v103, a196
    v_mfma_f32_16x16x32_bf16 a[200:203], v[28:31], v[180:183], a[200:203]
    v_cvt_pk_bf16_f32 v104, v96, v97
    v_cvt_pk_bf16_f32 v105, v98, v99
    v_mfma_f32_16x16x32_bf16 a[228:231], v[160:163], v[180:183], a[228:231]
    s_waitcnt lgkmcnt(1)
    v_cvt_pk_bf16_f32 v106, v100, v101
    v_cvt_pk_bf16_f32 v107, v102, v103
    v_mfma_f32_16x16x32_bf16 a[4:7], v[128:131], v[184:187], a[4:7]
    ds_read_b128 v[180:183], v243 offset:22528
    v_accvgpr_read_b32 v108, a1
    v_accvgpr_read_b32 v109, a29
    v_mfma_f32_16x16x32_bf16 a[32:35], v[132:135], v[184:187], a[32:35]
    s_add_u32 s72, s70, 0
    s_cmp_eq_u32 s31, 0
    s_cselect_b32 s72, s69, s72
    buffer_store_dwordx4 v[104:107], v237, s[40:43], s72 offen offset:0 sc1
    s_cmp_eq_u32 s31, 0
    s_cbranch_scc0 L_keep1
    v_mov_b32 v188, v104
    v_mov_b32 v189, v105
    v_mov_b32 v190, v106
    v_mov_b32 v191, v107
L_keep1:
    v_accvgpr_read_b32 v110, a57
    v_accvgpr_read_b32 v111, a85
    v_mfma_f32_16x16x32_bf16 a[60:63], v[136:139], v[184:187], a[60:63]
    v_accvgpr_read_b32 v112, a113
    v_accvgpr_read_b32 v113, a141
    v_mfma_f32_16x16x32_bf16 a[88:91], v[140:143], v[184:187], a[88:91]
    v_accvgpr_read_b32 v114, a169
    v_accvgpr_read_b32 v115, a197
    v_mfma_f32_16x16x32_bf16 a[116:119], v[144:147], v[184:187], a[116:119]
    v_cvt_pk_bf16_f32 v116, v108, v109
    v_cvt_pk_bf16_f32 v117, v110, v111
    v_mfma_f32_16x16x32_bf16 a[144:147], v[148:151], v[184:187], a[144:147]
    v_cvt_pk_bf16_f32 v118, v112, v113
    v_cvt_pk_bf16_f32 v119, v114, v115
    v_mfma_f32_16x16x32_bf16 a[172:175], v[152:155], v[184:187], a[172:175]
    v_accvgpr_read_b32 v96, a2
    v_accvgpr_read_b32 v97, a30
    v_mfma_f32_16x16x32_bf16 a[200:203], v[156:159], v[184:187], a[200:203]
    s_add_u32 s72, s70, 0
    s_cmp_eq_u32 s31, 0
    s_cselect_b32 s72, s69, s72
    buffer_store_dwordx4 v[116:119], v237, s[40:43], s72 offen offset:1024 sc1
    s_cmp_eq_u32 s31, 0
    s_cbranch_scc0 L_keep2
    v_mov_b32 v192, v116
    v_mov_b32 v193, v117
    v_mov_b32 v194, v118
    v_mov_b32 v195, v119
L_keep2:
    v_accvgpr_read_b32 v98, a58
    v_accvgpr_read_b32 v99, a86
    v_mfma_f32_16x16x32_bf16 a[228:231], v[164:167], v[184:187], a[228:231]
    s_waitcnt lgkmcnt(1)
    v_accvgpr_read_b32 v100, a114
    v_accvgpr_read_b32 v101, a142
    v_mfma_f32_16x16x32_bf16 a[4:7], v[32:35], v[176:179], a[4:7]
    ds_read_b128 v[184:187], v243 offset:2048
    v_accvgpr_read_b32 v102, a170
    v_accvgpr_read_b32 v103, a198
    v_mfma_f32_16x16x32_bf16 a[32:35], v[36:39], v[176:179], a[32:35]
    v_cvt_pk_bf16_f32 v104, v96, v97
    v_cvt_pk_bf16_f32 v105, v98, v99
    v_mfma_f32_16x16x32_bf16 a[60:63], v[40:43], v[176:179], a[60:63]
    v_cvt_pk_bf16_f32 v106, v100, v101
    v_cvt_pk_bf16_f32 v107, v102, v103
    v_mfma_f32_16x16x32_bf16 a[88:91], v[44:47], v[176:179], a[88:91]
    v_accvgpr_read_b32 v108, a3
    v_accvgpr_read_b32 v109, a31
    v_mfma_f32_16x16x32_bf16 a[116:119], v[48:51], v[176:179], a[116:119]
    s_add_u32 s72, s70, 0
    s_cmp_eq_u32 s31, 0
    s_cselect_b32 s72, s69, s72
    buffer_store_dwordx4 v[104:107], v237, s[40:43], s72 offen offset:2048 sc1
    s_cmp_eq_u32 s31, 0
    s_cbranch_scc0 L_keep3
    v_mov_b32 v196, v104
    v_mov_b32 v197, v105
    v_mov_b32 v198, v106
    v_mov_b32 v199, v107
L_keep3:
    v_accvgpr_read_b32 v110, a59
    v_accvgpr_read_b32 v111, a87
    v_mfma_f32_16x16x32_bf16 a[144:147], v[52:55], v[176:179], a[144:147]
    v_accvgpr_read_b32 v112, a115
    v_accvgpr_read_b32 v113, a143
    v_mfma_f32_16x16x32_bf16 a[172:175], v[56:59], v[176:179], a[172:175]
    v_accvgpr_read_b32 v114, a171
    v_accvgpr_read_b32 v115, a199
    v_mfma_f32_16x16x32_bf16 a[200:203], v[60:63], v[176:179], a[200:203]
    v_cvt_pk_bf16_f32 v116, v108, v109
    v_cvt_pk_bf16_f32 v117, v110, v111
    v_mfma_f32_16x16x32_bf16 a[228:231], v[168:171], v[176:179], a[228:231]
    s_waitcnt lgkmcnt(1)
    v_cvt_pk_bf16_f32 v118, v112, v113
    v_cvt_pk_bf16_f32 v119, v114, v115
    v_mfma_f32_16x16x32_bf16 a[4:7], v[64:67], v[180:183], a[4:7]
    ds_read_b128 v[176:179], v243 offset:9216
    v_accvgpr_read_b32 v96, a224
    v_accvgpr_read_b32 v97, a225
    v_mfma_f32_16x16x32_bf16 a[32:35], v[68:71], v[180:183], a[32:35]
    s_add_u32 s72, s70, 0
    s_cmp_eq_u32 s31, 0
    s_cselect_b32 s72, s69, s72
    buffer_store_dwordx4 v[116:119], v237, s[40:43], s72 offen offset:3072 sc1
    s_cmp_eq_u32 s31, 0
    s_cbranch_scc0 L_keep4
    v_mov_b32 v200, v116
    v_mov_b32 v201, v117
    v_mov_b32 v202, v118
    v_mov_b32 v203, v119
L_keep4:
    v_accvgpr_read_b32 v98, a226
    v_accvgpr_read_b32 v99, a227
    v_mfma_f32_16x16x32_bf16 a[60:63], v[72:75], v[180:183], a[60:63]
    v_cvt_pk_bf16_f32 v120, v96, v97
    v_cvt_pk_bf16_f32 v121, v98, v99
    v_mfma_f32_16x16x32_bf16 a[88:91], v[76:79], v[180:183], a[88:91]
    v_mfma_f32_16x16x32_bf16 a[116:119], v[80:83], v[180:183], a[116:119]
    v_mfma_f32_16x16x32_bf16 a[144:147], v[84:87], v[180:183], a[144:147]
    v_mfma_f32_16x16x32_bf16 a[172:175], v[88:91], v[180:183], a[172:175]
    v_mfma_f32_16x16x32_bf16 a[200:203], v[92:95], v[180:183], a[200:203]
    v_mfma_f32_16x16x32_bf16 a[228:231], v[172:175], v[180:183], a[228:231]
    s_waitcnt lgkmcnt(1)
    v_mfma_f32_16x16x32_bf16 a[8:11], v[0:3], v[184:187], a[8:11]
    ds_read_b128 v[180:183], v243 offset:16384
    v_mfma_f32_16x16x32_bf16 a[36:39], v[4:7], v[184:187], a[36:39]
    v_mfma_f32_16x16x32_bf16 a[64:67], v[8:11], v[184:187], a[64:67]
    v_mfma_f32_16x16x32_bf16 a[92:95], v[12:15], v[184:187], a[92:95]
    v_accvgpr_read_b32 v96, a4
    v_accvgpr_read_b32 v97, a32
    v_mfma_f32_16x16x32_bf16 a[120:123], v[16:19], v[184:187], a[120:123]
    v_accvgpr_read_b32 v98, a60
    v_accvgpr_read_b32 v99, a88
    v_mfma_f32_16x16x32_bf16 a[148:151], v[20:23], v[184:187], a[148:151]
    v_accvgpr_read_b32 v100, a116
    v_accvgpr_read_b32 v101, a144
    v_mfma_f32_16x16x32_bf16 a[176:179], v[24:27], v[184:187], a[176:179]
    v_accvgpr_read_b32 v102, a172
    v_accvgpr_read_b32 v103, a200
    v_mfma_f32_16x16x32_bf16 a[204:207], v[28:31], v[184:187], a[204:207]
    v_cvt_pk_bf16_f32 v104, v96, v97
    v_cvt_pk_bf16_f32 v105, v98, v99
    v_mfma_f32_16x16x32_bf16 a[232:235], v[160:163], v[184:187], a[232:235]
    s_waitcnt lgkmcnt(1)
    v_cvt_pk_bf16_f32 v106, v100, v101
    v_cvt_pk_bf16_f32 v107, v102, v103
    v_mfma_f32_16x16x32_bf16 a[8:11], v[128:131], v[176:179], a[8:11]
    ds_read_b128 v[184:187], v243 offset:23552
    v_accvgpr_read_b32 v108, a5
    v_accvgpr_read_b32 v109, a33
    v_mfma_f32_16x16x32_bf16 a[36:39], v[132:135], v[176:179], a[36:39]
    s_add_u32 s72, s70, 16384
    s_cmp_eq_u32 s31, 1
    s_cselect_b32 s72, s69, s72
    buffer_store_dwordx4 v[104:107], v237, s[40:43], s72 offen offset:0 sc1
    s_cmp_eq_u32 s31, 1
    s_cbranch_scc0 L_keep5
    v_mov_b32 v188, v104
    v_mov_b32 v189, v105
    v_mov_b32 v190, v106
    v_mov_b32 v191, v107
L_keep5:
    v_accvgpr_read_b32 v110, a61
    v_accvgpr_read_b32 v111, a89
    v_mfma_f32_16x16x32_bf16 a[64:67], v[136:139], v[176:179], a[64:67]
    v_accvgpr_read_b32 v112, a117
    v_accvgpr_read_b32 v113, a145
    v_mfma_f32_16x16x32_bf16 a[92:95], v[140:143], v[176:179], a[92:95]
    v_accvgpr_read_b32 v114, a173
    v_accvgpr_read_b32 v115, a201
    v_mfma_f32_16x16x32_bf16 a[120:123], v[144:147], v[176:179], a[120:123]
    v_cvt_pk_bf16_f32 v116, v108, v109
    v_cvt_pk_bf16_f32 v117, v110, v111
    v_mfma_f32_16x16x32_bf16 a[148:151], v[148:151], v[176:179], a[148:151]
    v_cvt_pk_bf16_f32 v118, v112, v113
    v_cvt_pk_bf16_f32 v119, v114, v115
    v_mfma_f32_16x16x32_bf16 a[176:179], v[152:155], v[176:179], a[176:179]
    v_accvgpr_read_b32 v96, a6
    v_accvgpr_read_b32 v97, a34
    v_mfma_f32_16x16x32_bf16 a[204:207], v[156:159], v[176:179], a[204:207]
    s_add_u32 s72, s70, 16384
    s_cmp_eq_u32 s31, 1
    s_cselect_b32 s72, s69, s72
    buffer_store_dwordx4 v[116:119], v237, s[40:43], s72 offen offset:1024 sc1
    s_cmp_eq_u32 s31, 1
    s_cbranch_scc0 L_keep6
    v_mov_b32 v192, v116
    v_mov_b32 v193, v117
    v_mov_b32 v194, v118
    v_mov_b32 v195, v119
L_keep6:
    v_accvgpr_read_b32 v98, a62
    v_accvgpr_read_b32 v99, a90
    v_mfma_f32_16x16x32_bf16 a[232:235], v[164:167], v[176:179], a[232:235]
    s_waitcnt lgkmcnt(1)
    v_accvgpr_read_b32 v100, a118
    v_accvgpr_read_b32 v101, a146
    v_mfma_f32_16x16x32_bf16 a[8:11], v[32:35], v[180:183], a[8:11]
    ds_read_b128 v[176:179], v243 offset:3072
    v_accvgpr_read_b32 v102, a174
    v_accvgpr_read_b32 v103, a202
    v_mfma_f32_16x16x32_bf16 a[36:39], v[36:39], v[180:183], a[36:39]
    v_cvt_pk_bf16_f32 v104, v96, v97
    v_cvt_pk_bf16_f32 v105, v98, v99
    v_mfma_f32_16x16x32_bf16 a[64:67], v[40:43], v[180:183], a[64:67]
    v_cvt_pk_bf16_f32 v106, v100, v101
    v_cvt_pk_bf16_f32 v107, v102, v103
    v_mfma_f32_16x16x32_bf16 a[92:95], v[44:47], v[180:183], a[92:95]
    v_accvgpr_read_b32 v108, a7
    v_accvgpr_read_b32 v109, a35
    v_mfma_f32_16x16x32_bf16 a[120:123], v[48:51], v[180:183], a[120:123]
    s_add_u32 s72, s70, 16384
    s_cmp_eq_u32 s31, 1
    s_cselect_b32 s72, s69, s72
    buffer_store_dwordx4 v[104:107], v237, s[40:43], s72 offen offset:2048 sc1
    s_cmp_eq_u32 s31, 1
    s_cbranch_scc0 L_keep7
    v_mov_b32 v196, v104
    v_mov_b32 v197, v105
    v_mov_b32 v198, v106
    v_mov_b32 v199, v107
L_keep7:
    v_accvgpr_read_b32 v110, a63
    v_accvgpr_read_b32 v111, a91
    v_mfma_f32_16x16x32_bf16 a[148:151], v[52:55], v[180:183], a[148:151]
    v_accvgpr_read_b32 v112, a119
    v_accvgpr_read_b32 v113, a147
    v_mfma_f32_16x16x32_bf16 a[176:179], v[56:59], v[180:183], a[176:179]
    v_accvgpr_read_b32 v114, a175
    v_accvgpr_read_b32 v115, a203
    v_mfma_f32_16x16x32_bf16 a[204:207], v[60:63], v[180:183], a[204:207]
    v_cvt_pk_bf16_f32 v116, v108, v109
    v_cvt_pk_bf16_f32 v117, v110, v111
    v_mfma_f32_16x16x32_bf16 a[232:235], v[168:171], v[180:183], a[232:235]
    s_waitcnt lgkmcnt(1)
    v_cvt_pk_bf16_f32 v118, v112, v113
    v_cvt_pk_bf16_f32 v119, v114, v115
    v_mfma_f32_16x16x32_bf16 a[8:11], v[64:67], v[184:187], a[8:11]
    ds_read_b128 v[180:183], v243 offset:10240
    v_accvgpr_read_b32 v96, a228
    v_accvgpr_read_b32 v97, a229
    v_mfma_f32_16x16x32_bf16 a[36:39], v[68:71], v[184:187], a[36:39]
    s_add_u32 s72, s70, 16384
    s_cmp_eq_u32 s31, 1
    s_cselect_b32 s72, s69, s72
    buffer_store_dwordx4 v[116:119], v237, s[40:43], s72 offen offset:3072 sc1
    s_cmp_eq_u32 s31, 1
    s_cbranch_scc0 L_keep8
    v_mov_b32 v200, v116
    v_mov_b32 v201, v117
    v_mov_b32 v202, v118
    v_mov_b32 v203, v119
L_keep8:
    v_accvgpr_read_b32 v98, a230
    v_accvgpr_read_b32 v99, a231
    v_mfma_f32_16x16x32_bf16 a[64:67], v[72:75], v[184:187], a[64:67]
    v_cvt_pk_bf16_f32 v122, v96, v97
    v_cvt_pk_bf16_f32 v123, v98, v99
    v_mfma_f32_16x16x32_bf16 a[92:95], v[76:79], v[184:187], a[92:95]
    v_mfma_f32_16x16x32_bf16 a[120:123], v[80:83], v[184:187], a[120:123]
    buffer_store_dwordx4 v[120:123], v237, s[40:43], s71 offen offset:0 sc1
    s_cmp_eq_u32 s31, 7
    s_cbranch_scc0 L_keep9
    v_mov_b32 v188, v120
    v_mov_b32 v189, v121
    v_mov_b32 v190, v122
    v_mov_b32 v191, v123
L_keep9:
    v_mfma_f32_16x16x32_bf16 a[148:151], v[84:87], v[184:187], a[148:151]
    v_mfma_f32_16x16x32_bf16 a[176:179], v[88:91], v[184:187], a[176:179]
    v_mfma_f32_16x16x32_bf16 a[204:207], v[92:95], v[184:187], a[204:207]
    v_mfma_f32_16x16x32_bf16 a[232:235], v[172:175], v[184:187], a[232:235]
    s_waitcnt lgkmcnt(1)
    v_mfma_f32_16x16x32_bf16 a[12:15], v[0:3], v[176:179], a[12:15]
    ds_read_b128 v[184:187], v243 offset:17408
    v_mfma_f32_16x16x32_bf16 a[40:43], v[4:7], v[176:179], a[40:43]
    v_mfma_f32_16x16x32_bf16 a[68:71], v[8:11], v[176:179], a[68:71]
    v_mfma_f32_16x16x32_bf16 a[96:99], v[12:15], v[176:179], a[96:99]
    v_accvgpr_read_b32 v96, a8
    v_accvgpr_read_b32 v97, a36
    v_mfma_f32_16x16x32_bf16 a[124:127], v[16:19], v[176:179], a[124:127]
    v_accvgpr_read_b32 v98, a64
    v_accvgpr_read_b32 v99, a92
    v_mfma_f32_16x16x32_bf16 a[152:155], v[20:23], v[176:179], a[152:155]
    v_accvgpr_read_b32 v100, a120
    v_accvgpr_read_b32 v101, a148
    v_mfma_f32_16x16x32_bf16 a[180:183], v[24:27], v[176:179], a[180:183]
    v_accvgpr_read_b32 v102, a176
    v_accvgpr_read_b32 v103, a204
    v_mfma_f32_16x16x32_bf16 a[208:211], v[28:31], v[176:179], a[208:211]
    v_cvt_pk_bf16_f32 v104, v96, v97
    v_cvt_pk_bf16_f32 v105, v98, v99
    v_mfma_f32_16x16x32_bf16 a[236:239], v[160:163], v[176:179], a[236:239]
    s_waitcnt lgkmcnt(1)
    v_cvt_pk_bf16_f32 v106, v100, v101
    v_cvt_pk_bf16_f32 v107, v102, v103
    v_mfma_f32_16x16x32_bf16 a[12:15], v[128:131], v[180:183], a[12:15]
    ds_read_b128 v[176:179], v243 offset:24576
    v_accvgpr_read_b32 v108, a9
    v_accvgpr_read_b32 v109, a37
    v_mfma_f32_16x16x32_bf16 a[40:43], v[132:135], v[180:183], a[40:43]
    s_add_u32 s72, s70, 32768
    s_cmp_eq_u32 s31, 2
    s_cselect_b32 s72, s69, s72
    buffer_store_dwordx4 v[104:107], v237, s[40:43], s72 offen offset:0 sc1
    s_cmp_eq_u32 s31, 2
    s_cbranch_scc0 L_keep10
    v_mov_b32 v188, v104
    v_mov_b32 v189, v105
    v_mov_b32 v190, v106
    v_mov_b32 v191, v107
L_keep10:
    v_accvgpr_read_b32 v110, a65
    v_accvgpr_read_b32 v111, a93
    v_mfma_f32_16x16x32_bf16 a[68:71], v[136:139], v[180:183], a[68:71]
    v_accvgpr_read_b32 v112, a121
    v_accvgpr_read_b32 v113, a149
    v_mfma_f32_16x16x32_bf16 a[96:99], v[140:143], v[180:183], a[96:99]
    v_accvgpr_read_b32 v114, a177
    v_accvgpr_read_b32 v115, a205
    v_mfma_f32_16x16x32_bf16 a[124:127], v[144:147], v[180:183], a[124:127]
    v_cvt_pk_bf16_f32 v116, v108, v109
    v_cvt_pk_bf16_f32 v117, v110, v111
    v_mfma_f32_16x16x32_bf16 a[152:155], v[148:151], v[180:183], a[152:155]
    v_cvt_pk_bf16_f32 v118, v112, v113
    v_cvt_pk_bf16_f32 v119, v114, v115
    v_mfma_f32_16x16x32_bf16 a[180:183], v[152:155], v[180:183], a[180:183]
    v_accvgpr_read_b32 v96, a10
    v_accvgpr_read_b32 v97, a38
    v_mfma_f32_16x16x32_bf16 a[208:211], v[156:159], v[180:183], a[208:211]
    s_add_u32 s72, s70, 32768
    s_cmp_eq_u32 s31, 2
    s_cselect_b32 s72, s69, s72
    buffer_store_dwordx4 v[116:119], v237, s[40:43], s72 offen offset:1024 sc1
    s_cmp_eq_u32 s31, 2
    s_cbranch_scc0 L_keep11
    v_mov_b32 v192, v116
    v_mov_b32 v193, v117
    v_mov_b32 v194, v118
    v_mov_b32 v195, v119
L_keep11:
    v_accvgpr_read_b32 v98, a66
    v_accvgpr_read_b32 v99, a94
    v_mfma_f32_16x16x32_bf16 a[236:239], v[164:167], v[180:183], a[236:239]
    s_waitcnt lgkmcnt(1)
    v_accvgpr_read_b32 v100, a122
    v_accvgpr_read_b32 v101, a150
    v_mfma_f32_16x16x32_bf16 a[12:15], v[32:35], v[184:187], a[12:15]
    ds_read_b128 v[180:183], v243 offset:4096
    v_accvgpr_read_b32 v102, a178
    v_accvgpr_read_b32 v103, a206
    v_mfma_f32_16x16x32_bf16 a[40:43], v[36:39], v[184:187], a[40:43]
    v_cvt_pk_bf16_f32 v104, v96, v97
    v_cvt_pk_bf16_f32 v105, v98, v99
    v_mfma_f32_16x16x32_bf16 a[68:71], v[40:43], v[184:187], a[68:71]
    v_cvt_pk_bf16_f32 v106, v100, v101
    v_cvt_pk_bf16_f32 v107, v102, v103
    v_mfma_f32_16x16x32_bf16 a[96:99], v[44:47], v[184:187], a[96:99]
    v_accvgpr_read_b32 v108, a11
    v_accvgpr_read_b32 v109, a39
    v_mfma_f32_16x16x32_bf16 a[124:127], v[48:51], v[184:187], a[124:127]
    s_add_u32 s72, s70, 32768
    s_cmp_eq_u32 s31, 2
    s_cselect_b32 s72, s69, s72
    buffer_store_dwordx4 v[104:107], v237, s[40:43], s72 offen offset:2048 sc1
    s_cmp_eq_u32 s31, 2
    s_cbranch_scc0 L_keep12
    v_mov_b32 v196, v104
    v_mov_b32 v197, v105
    v_mov_b32 v198, v106
    v_mov_b32 v199, v107
L_keep12:
    v_accvgpr_read_b32 v110, a67
    v_accvgpr_read_b32 v111, a95
    v_mfma_f32_16x16x32_bf16 a[152:155], v[52:55], v[184:187], a[152:155]
    v_accvgpr_read_b32 v112, a123
    v_accvgpr_read_b32 v113, a151
    v_mfma_f32_16x16x32_bf16 a[180:183], v[56:59], v[184:187], a[180:183]
    v_accvgpr_read_b32 v114, a179
    v_accvgpr_read_b32 v115, a207
    v_mfma_f32_16x16x32_bf16 a[208:211], v[60:63], v[184:187], a[208:211]
    v_cvt_pk_bf16_f32 v116, v108, v109
    v_cvt_pk_bf16_f32 v117, v110, v111
    v_mfma_f32_16x16x32_bf16 a[236:239], v[168:171], v[184:187], a[236:239]
    s_waitcnt lgkmcnt(1)
    v_cvt_pk_bf16_f32 v118, v112, v113
    v_cvt_pk_bf16_f32 v119, v114, v115
    v_mfma_f32_16x16x32_bf16 a[12:15], v[64:67], v[176:179], a[12:15]
    ds_read_b128 v[184:187], v243 offset:11264
    v_accvgpr_read_b32 v96, a232
    v_accvgpr_read_b32 v97, a233
    v_mfma_f32_16x16x32_bf16 a[40:43], v[68:71], v[176:179], a[40:43]
    s_add_u32 s72, s70, 32768
    s_cmp_eq_u32 s31, 2
    s_cselect_b32 s72, s69, s72
    buffer_store_dwordx4 v[116:119], v237, s[40:43], s72 offen offset:3072 sc1
    s_cmp_eq_u32 s31, 2
    s_cbranch_scc0 L_keep13
    v_mov_b32 v200, v116
    v_mov_b32 v201, v117
    v_mov_b32 v202, v118
    v_mov_b32 v203, v119
L_keep13:
    v_accvgpr_read_b32 v98, a234
    v_accvgpr_read_b32 v99, a235
    v_mfma_f32_16x16x32_bf16 a[68:71], v[72:75], v[176:179], a[68:71]
    v_cvt_pk_bf16_f32 v120, v96, v97
    v_cvt_pk_bf16_f32 v121, v98, v99
    v_mfma_f32_16x16x32_bf16 a[96:99], v[76:79], v[176:179], a[96:99]
    v_mfma_f32_16x16x32_bf16 a[124:127], v[80:83], v[176:179], a[124:127]
    v_mfma_f32_16x16x32_bf16 a[152:155], v[84:87], v[176:179], a[152:155]
    v_mfma_f32_16x16x32_bf16 a[180:183], v[88:91], v[176:179], a[180:183]
    v_mfma_f32_16x16x32_bf16 a[208:211], v[92:95], v[176:179], a[208:211]
    v_mfma_f32_16x16x32_bf16 a[236:239], v[172:175], v[176:179], a[236:239]
    s_waitcnt lgkmcnt(1)
    v_mfma_f32_16x16x32_bf16 a[16:19], v[0:3], v[180:183], a[16:19]
    ds_read_b128 v[176:179], v243 offset:18432
    v_mfma_f32_16x16x32_bf16 a[44:47], v[4:7], v[180:183], a[44:47]
    v_mfma_f32_16x16x32_bf16 a[72:75], v[8:11], v[180:183], a[72:75]
    v_mfma_f32_16x16x32_bf16 a[100:103], v[12:15], v[180:183], a[100:103]
    v_accvgpr_read_b32 v96, a12
    v_accvgpr_read_b32 v97, a40
    v_mfma_f32_16x16x32_bf16 a[128:131], v[16:19], v[180:183], a[128:131]
    v_accvgpr_read_b32 v98, a68
    v_accvgpr_read_b32 v99, a96
    v_mfma_f32_16x16x32_bf16 a[156:159], v[20:23], v[180:183], a[156:159]
    v_accvgpr_read_b32 v100, a124
    v_accvgpr_read_b32 v101, a152
    v_mfma_f32_16x16x32_bf16 a[184:187], v[24:27], v[180:183], a[184:187]
    v_accvgpr_read_b32 v102, a180
    v_accvgpr_read_b32 v103, a208
    v_mfma_f32_16x16x32_bf16 a[212:215], v[28:31], v[180:183], a[212:215]
    v_cvt_pk_bf16_f32 v104, v96, v97
    v_cvt_pk_bf16_f32 v105, v98, v99
    v_mfma_f32_16x16x32_bf16 a[240:243], v[160:163], v[180:183], a[240:243]
    s_waitcnt lgkmcnt(1)
    v_cvt_pk_bf16_f32 v106, v100, v101
    v_cvt_pk_bf16_f32 v107, v102, v103
    v_mfma_f32_16x16x32_bf16 a[16:19], v[128:131], v[184:187], a[16:19]
    ds_read_b128 v[180:183], v243 offset:25600
    v_accvgpr_read_b32 v108, a13
    v_accvgpr_read_b32 v109, a41
    v_mfma_f32_16x16x32_bf16 a[44:47], v[132:135], v[184:187], a[44:47]
    s_add_u32 s72, s70, 49152
    s_cmp_eq_u32 s31, 3
    s_cselect_b32 s72, s69, s72
    buffer_store_dwordx4 v[104:107], v237, s[40:43], s72 offen offset:0 sc1
    s_cmp_eq_u32 s31, 3
    s_cbranch_scc0 L_keep14
    v_mov_b32 v188, v104
    v_mov_b32 v189, v105
    v_mov_b32 v190, v106
    v_mov_b32 v191, v107
L_keep14:
    v_accvgpr_read_b32 v110, a69
    v_accvgpr_read_b32 v111, a97
    v_mfma_f32_16x16x32_bf16 a[72:75], v[136:139], v[184:187], a[72:75]
    v_accvgpr_read_b32 v112, a125
    v_accvgpr_read_b32 v113, a153
    v_mfma_f32_16x16x32_bf16 a[100:103], v[140:143], v[184:187], a[100:103]
    v_accvgpr_read_b32 v114, a181
    v_accvgpr_read_b32 v115, a209
    v_mfma_f32_16x16x32_bf16 a[128:131], v[144:147], v[184:187], a[128:131]
    v_cvt_pk_bf16_f32 v116, v108, v109
    v_cvt_pk_bf16_f32 v117, v110, v111
    v_mfma_f32_16x16x32_bf16 a[156:159], v[148:151], v[184:187], a[156:159]
    v_cvt_pk_bf16_f32 v118, v112, v113
    v_cvt_pk_bf16_f32 v119, v114, v115
    v_mfma_f32_16x16x32_bf16 a[184:187], v[152:155], v[184:187], a[184:187]
    v_accvgpr_read_b32 v96, a14
    v_accvgpr_read_b32 v97, a42
    v_mfma_f32_16x16x32_bf16 a[212:215], v[156:159], v[184:187], a[212:215]
    s_add_u32 s72, s70, 49152
    s_cmp_eq_u32 s31, 3
    s_cselect_b32 s72, s69, s72
    buffer_store_dwordx4 v[116:119], v237, s[40:43], s72 offen offset:1024 sc1
    s_cmp_eq_u32 s31, 3
    s_cbranch_scc0 L_keep15
    v_mov_b32 v192, v116
    v_mov_b32 v193, v117
    v_mov_b32 v194, v118
    v_mov_b32 v195, v119
L_keep15:
    v_accvgpr_read_b32 v98, a70
    v_accvgpr_read_b32 v99, a98
    v_mfma_f32_16x16x32_bf16 a[240:243], v[164:167], v[184:187], a[240:243]
    s_waitcnt lgkmcnt(1)
    v_accvgpr_read_b32 v100, a126
    v_accvgpr_read_b32 v101, a154
    v_mfma_f32_16x16x32_bf16 a[16:19], v[32:35], v[176:179], a[16:19]
    ds_read_b128 v[184:187], v243 offset:5120
    v_accvgpr_read_b32 v102, a182
    v_accvgpr_read_b32 v103, a210
    v_mfma_f32_16x16x32_bf16 a[44:47], v[36:39], v[176:179], a[44:47]
    v_cvt_pk_bf16_f32 v104, v96, v97
    v_cvt_pk_bf16_f32 v105, v98, v99
    v_mfma_f32_16x16x32_bf16 a[72:75], v[40:43], v[176:179], a[72:75]
    v_cvt_pk_bf16_f32 v106, v100, v101
    v_cvt_pk_bf16_f32 v107, v102, v103
    v_mfma_f32_16x16x32_bf16 a[100:103], v[44:47], v[176:179], a[100:103]
    v_accvgpr_read_b32 v108, a15
    v_accvgpr_read_b32 v109, a43
    v_mfma_f32_16x16x32_bf16 a[128:131], v[48:51], v[176:179], a[128:131]
    s_add_u32 s72, s70, 49152
    s_cmp_eq_u32 s31, 3
    s_cselect_b32 s72, s69, s72
    buffer_store_dwordx4 v[104:107], v237, s[40:43], s72 offen offset:2048 sc1
    s_cmp_eq_u32 s31, 3
    s_cbranch_scc0 L_keep16
    v_mov_b32 v196, v104
    v_mov_b32 v197, v105
    v_mov_b32 v198, v106
    v_mov_b32 v199, v107
L_keep16:
    v_accvgpr_read_b32 v110, a71
    v_accvgpr_read_b32 v111, a99
    v_mfma_f32_16x16x32_bf16 a[156:159], v[52:55], v[176:179], a[156:159]
    v_accvgpr_read_b32 v112, a127
    v_accvgpr_read_b32 v113, a155
    v_mfma_f32_16x16x32_bf16 a[184:187], v[56:59], v[176:179], a[184:187]
    v_accvgpr_read_b32 v114, a183
    v_accvgpr_read_b32 v115, a211
    v_mfma_f32_16x16x32_bf16 a[212:215], v[60:63], v[176:179], a[212:215]
    v_cvt_pk_bf16_f32 v116, v108, v109
    v_cvt_pk_bf16_f32 v117, v110, v111
    v_mfma_f32_16x16x32_bf16 a[240:243], v[168:171], v[176:179], a[240:243]
    s_waitcnt lgkmcnt(1)
    v_cvt_pk_bf16_f32 v118, v112, v113
    v_cvt_pk_bf16_f32 v119, v114, v115
    v_mfma_f32_16x16x32_bf16 a[16:19], v[64:67], v[180:183], a[16:19]
    ds_read_b128 v[176:179], v243 offset:12288
    v_accvgpr_read_b32 v96, a236
    v_accvgpr_read_b32 v97, a237
    v_mfma_f32_16x16x32_bf16 a[44:47], v[68:71], v[180:183], a[44:47]
    s_add_u32 s72, s70, 49152
    s_cmp_eq_u32 s31, 3
    s_cselect_b32 s72, s69, s72
    buffer_store_dwordx4 v[116:119], v237, s[40:43], s72 offen offset:3072 sc1
    s_cmp_eq_u32 s31, 3
    s_cbranch_scc0 L_keep17
    v_mov_b32 v200, v116
    v_mov_b32 v201, v117
    v_mov_b32 v202, v118
    v_mov_b32 v203, v119
L_keep17:
    v_accvgpr_read_b32 v98, a238
    v_accvgpr_read_b32 v99, a239
    v_mfma_f32_16x16x32_bf16 a[72:75], v[72:75], v[180:183], a[72:75]
    v_cvt_pk_bf16_f32 v122, v96, v97
    v_cvt_pk_bf16_f32 v123, v98, v99
    v_mfma_f32_16x16x32_bf16 a[100:103], v[76:79], v[180:183], a[100:103]
    v_mfma_f32_16x16x32_bf16 a[128:131], v[80:83], v[180:183], a[128:131]
    buffer_store_dwordx4 v[120:123], v237, s[40:43], s71 offen offset:1024 sc1
    s_cmp_eq_u32 s31, 7
    s_cbranch_scc0 L_keep18
    v_mov_b32 v192, v120
    v_mov_b32 v193, v121
    v_mov_b32 v194, v122
    v_mov_b32 v195, v123
L_keep18:
    v_mfma_f32_16x16x32_bf16 a[156:159], v[84:87], v[180:183], a[156:159]
    v_mfma_f32_16x16x32_bf16 a[184:187], v[88:91], v[180:183], a[184:187]
    v_mfma_f32_16x16x32_bf16 a[212:215], v[92:95], v[180:183], a[212:215]
    v_mfma_f32_16x16x32_bf16 a[240:243], v[172:175], v[180:183], a[240:243]
    s_waitcnt lgkmcnt(1)
    v_mfma_f32_16x16x32_bf16 a[20:23], v[0:3], v[184:187], a[20:23]
    ds_read_b128 v[180:183], v243 offset:19456
    v_mfma_f32_16x16x32_bf16 a[48:51], v[4:7], v[184:187], a[48:51]
    v_mfma_f32_16x16x32_bf16 a[76:79], v[8:11], v[184:187], a[76:79]
    v_mfma_f32_16x16x32_bf16 a[104:107], v[12:15], v[184:187], a[104:107]
    v_accvgpr_read_b32 v96, a16
    v_accvgpr_read_b32 v97, a44
    v_mfma_f32_16x16x32_bf16 a[132:135], v[16:19], v[184:187], a[132:135]
    v_accvgpr_read_b32 v98, a72
    v_accvgpr_read_b32 v99, a100
    v_mfma_f32_16x16x32_bf16 a[160:163], v[20:23], v[184:187], a[160:163]
    v_accvgpr_read_b32 v100, a128
    v_accvgpr_read_b32 v101, a156
    v_mfma_f32_16x16x32_bf16 a[188:191], v[24:27], v[184:187], a[188:191]
    v_accvgpr_read_b32 v102, a184
    v_accvgpr_read_b32 v103, a212
    v_mfma_f32_16x16x32_bf16 a[216:219], v[28:31], v[184:187], a[216:219]
    v_cvt_pk_bf16_f32 v104, v96, v97
    v_cvt_pk_bf16_f32 v105, v98, v99
    v_mfma_f32_16x16x32_bf16 a[244:247], v[160:163], v[184:187], a[244:247]
    s_waitcnt lgkmcnt(1)
    v_cvt_pk_bf16_f32 v106, v100, v101
    v_cvt_pk_bf16_f32 v107, v102, v103
    v_mfma_f32_16x16x32_bf16 a[20:23], v[128:131], v[176:179], a[20:23]
    ds_read_b128 v[184:187], v243 offset:26624
    v_accvgpr_read_b32 v108, a17
    v_accvgpr_read_b32 v109, a45
    v_mfma_f32_16x16x32_bf16 a[48:51], v[132:135], v[176:179], a[48:51]
    s_add_u32 s72, s70, 65536
    s_cmp_eq_u32 s31, 4
    s_cselect_b32 s72, s69, s72
    buffer_store_dwordx4 v[104:107], v237, s[40:43], s72 offen offset:0 sc1
    s_cmp_eq_u32 s31, 4
    s_cbranch_scc0 L_keep19
    v_mov_b32 v188, v104
    v_mov_b32 v189, v105
    v_mov_b32 v190, v106
    v_mov_b32 v191, v107
L_keep19:
    v_accvgpr_read_b32 v110, a73
    v_accvgpr_read_b32 v111, a101
    v_mfma_f32_16x16x32_bf16 a[76:79], v[136:139], v[176:179], a[76:79]
    v_accvgpr_read_b32 v112, a129
    v_accvgpr_read_b32 v113, a157
    v_mfma_f32_16x16x32_bf16 a[104:107], v[140:143], v[176:179], a[104:107]
    v_accvgpr_read_b32 v114, a185
    v_accvgpr_read_b32 v115, a213
    v_mfma_f32_16x16x32_bf16 a[132:135], v[144:147], v[176:179], a[132:135]
    v_cvt_pk_bf16_f32 v116, v108, v109
    v_cvt_pk_bf16_f32 v117, v110, v111
    v_mfma_f32_16x16x32_bf16 a[160:163], v[148:151], v[176:179], a[160:163]
    v_cvt_pk_bf16_f32 v118, v112, v113
    v_cvt_pk_bf16_f32 v119, v114, v115
    v_mfma_f32_16x16x32_bf16 a[188:191], v[152:155], v[176:179], a[188:191]
    v_accvgpr_read_b32 v96, a18
    v_accvgpr_read_b32 v97, a46
    v_mfma_f32_16x16x32_bf16 a[216:219], v[156:159], v[176:179], a[216:219]
    s_add_u32 s72, s70, 65536
    s_cmp_eq_u32 s31, 4
    s_cselect_b32 s72, s69, s72
    buffer_store_dwordx4 v[116:119], v237, s[40:43], s72 offen offset:1024 sc1
    s_cmp_eq_u32 s31, 4
    s_cbranch_scc0 L_keep20
    v_mov_b32 v192, v116
    v_mov_b32 v193, v117
    v_mov_b32 v194, v118
    v_mov_b32 v195, v119
L_keep20:
    v_accvgpr_read_b32 v98, a74
    v_accvgpr_read_b32 v99, a102
    v_mfma_f32_16x16x32_bf16 a[244:247], v[164:167], v[176:179], a[244:247]
    s_waitcnt lgkmcnt(1)
    v_accvgpr_read_b32 v100, a130
    v_accvgpr_read_b32 v101, a158
    v_mfma_f32_16x16x32_bf16 a[20:23], v[32:35], v[180:183], a[20:23]
    ds_read_b128 v[176:179], v243 offset:6144
    v_accvgpr_read_b32 v102, a186
    v_accvgpr_read_b32 v103, a214
    v_mfma_f32_16x16x32_bf16 a[48:51], v[36:39], v[180:183], a[48:51]
    v_cvt_pk_bf16_f32 v104, v96, v97
    v_cvt_pk_bf16_f32 v105, v98, v99
    v_mfma_f32_16x16x32_bf16 a[76:79], v[40:43], v[180:183], a[76:79]
    v_cvt_pk_bf16_f32 v106, v100, v101
    v_cvt_pk_bf16_f32 v107, v102, v103
    v_mfma_f32_16x16x32_bf16 a[104:107], v[44:47], v[180:183], a[104:107]
    v_accvgpr_read_b32 v108, a19
    v_accvgpr_read_b32 v109, a47
    v_mfma_f32_16x16x32_bf16 a[132:135], v[48:51], v[180:183], a[132:135]
    s_add_u32 s72, s70, 65536
    s_cmp_eq_u32 s31, 4
    s_cselect_b32 s72, s69, s72
    buffer_store_dwordx4 v[104:107], v237, s[40:43], s72 offen offset:2048 sc1
    s_cmp_eq_u32 s31, 4
    s_cbranch_scc0 L_keep21
    v_mov_b32 v196, v104
    v_mov_b32 v197, v105
    v_mov_b32 v198, v106
    v_mov_b32 v199, v107
L_keep21:
    v_accvgpr_read_b32 v110, a75
    v_accvgpr_read_b32 v111, a103
    v_mfma_f32_16x16x32_bf16 a[160:163], v[52:55], v[180:183], a[160:163]
    v_accvgpr_read_b32 v112, a131
    v_accvgpr_read_b32 v113, a159
    v_mfma_f32_16x16x32_bf16 a[188:191], v[56:59], v[180:183], a[188:191]
    v_accvgpr_read_b32 v114, a187
    v_accvgpr_read_b32 v115, a215
    v_mfma_f32_16x16x32_bf16 a[216:219], v[60:63], v[180:183], a[216:219]
    v_cvt_pk_bf16_f32 v116, v108, v109
    v_cvt_pk_bf16_f32 v117, v110, v111
    v_mfma_f32_16x16x32_bf16 a[244:247], v[168:171], v[180:183], a[244:247]
    s_waitcnt lgkmcnt(1)
    v_cvt_pk_bf16_f32 v118, v112, v113
    v_cvt_pk_bf16_f32 v119, v114, v115
    v_mfma_f32_16x16x32_bf16 a[20:23], v[64:67], v[184:187], a[20:23]
    ds_read_b128 v[180:183], v243 offset:13312
    v_accvgpr_read_b32 v96, a240
    v_accvgpr_read_b32 v97, a241
    v_mfma_f32_16x16x32_bf16 a[48:51], v[68:71], v[184:187], a[48:51]
    s_add_u32 s72, s70, 65536
    s_cmp_eq_u32 s31, 4
    s_cselect_b32 s72, s69, s72
    buffer_store_dwordx4 v[116:119], v237, s[40:43], s72 offen offset:3072 sc1
    s_cmp_eq_u32 s31, 4
    s_cbranch_scc0 L_keep22
    v_mov_b32 v200, v116
    v_mov_b32 v201, v117
    v_mov_b32 v202, v118
    v_mov_b32 v203, v119
L_keep22:
    v_accvgpr_read_b32 v98, a242
    v_accvgpr_read_b32 v99, a243
    v_mfma_f32_16x16x32_bf16 a[76:79], v[72:75], v[184:187], a[76:79]
    v_cvt_pk_bf16_f32 v120, v96, v97
    v_cvt_pk_bf16_f32 v121, v98, v99
    v_mfma_f32_16x16x32_bf16 a[104:107], v[76:79], v[184:187], a[104:107]
    v_mfma_f32_16x16x32_bf16 a[132:135], v[80:83], v[184:187], a[132:135]
    v_mfma_f32_16x16x32_bf16 a[160:163], v[84:87], v[184:187], a[160:163]
    v_mfma_f32_16x16x32_bf16 a[188:191], v[88:91], v[184:187], a[188:191]
    v_mfma_f32_16x16x32_bf16 a[216:219], v[92:95], v[184:187], a[216:219]
    v_mfma_f32_16x16x32_bf16 a[244:247], v[172:175], v[184:187], a[244:247]
    s_waitcnt lgkmcnt(1)
    v_mfma_f32_16x16x32_bf16 a[24:27], v[0:3], v[176:179], a[24:27]
    ds_read_b128 v[184:187], v243 offset:20480
    v_mfma_f32_16x16x32_bf16 a[52:55], v[4:7], v[176:179], a[52:55]
    v_mfma_f32_16x16x32_bf16 a[80:83], v[8:11], v[176:179], a[80:83]
    s_waitcnt vmcnt(4)
    v_mfma_f32_16x16x32_bf16 a[108:111], v[12:15], v[176:179], a[108:111]
    v_accvgpr_read_b32 v96, a20
    v_accvgpr_read_b32 v97, a48
    v_mfma_f32_16x16x32_bf16 a[136:139], v[16:19], v[176:179], a[136:139]
    buffer_store_dword v234, v233, s[52:55], s25 offen offset:0 sc1
    v_accvgpr_read_b32 v98, a76
    v_accvgpr_read_b32 v99, a104
    v_mfma_f32_16x16x32_bf16 a[164:167], v[20:23], v[176:179], a[164:167]
    v_accvgpr_read_b32 v100, a132
    v_accvgpr_read_b32 v101, a160
    v_mfma_f32_16x16x32_bf16 a[192:195], v[24:27], v[176:179], a[192:195]
    v_accvgpr_read_b32 v102, a188
    v_accvgpr_read_b32 v103, a216
    v_mfma_f32_16x16x32_bf16 a[220:223], v[28:31], v[176:179], a[220:223]
    v_cvt_pk_bf16_f32 v104, v96, v97
    v_cvt_pk_bf16_f32 v105, v98, v99
    v_mfma_f32_16x16x32_bf16 a[248:251], v[160:163], v[176:179], a[248:251]
    s_waitcnt lgkmcnt(1)
    v_cvt_pk_bf16_f32 v106, v100, v101
    v_cvt_pk_bf16_f32 v107, v102, v103
    v_mfma_f32_16x16x32_bf16 a[24:27], v[128:131], v[180:183], a[24:27]
    ds_read_b128 v[176:179], v243 offset:27648
    v_accvgpr_read_b32 v108, a21
    v_accvgpr_read_b32 v109, a49
    v_mfma_f32_16x16x32_bf16 a[52:55], v[132:135], v[180:183], a[52:55]
    s_add_u32 s72, s70, 81920
    s_cmp_eq_u32 s31, 5
    s_cselect_b32 s72, s69, s72
    buffer_store_dwordx4 v[104:107], v237, s[40:43], s72 offen offset:0 sc1
    s_cmp_eq_u32 s31, 5
    s_cbranch_scc0 L_keep23
    v_mov_b32 v188, v104
    v_mov_b32 v189, v105
    v_mov_b32 v190, v106
    v_mov_b32 v191, v107
L_keep23:
    v_accvgpr_read_b32 v110, a77
    v_accvgpr_read_b32 v111, a105
    v_mfma_f32_16x16x32_bf16 a[80:83], v[136:139], v[180:183], a[80:83]
    v_accvgpr_read_b32 v112, a133
    v_accvgpr_read_b32 v113, a161
    v_mfma_f32_16x16x32_bf16 a[108:111], v[140:143], v[180:183], a[108:111]
    v_accvgpr_read_b32 v114, a189
    v_accvgpr_read_b32 v115, a217
    v_mfma_f32_16x16x32_bf16 a[136:139], v[144:147], v[180:183], a[136:139]
    v_cvt_pk_bf16_f32 v116, v108, v109
    v_cvt_pk_bf16_f32 v117, v110, v111
    v_mfma_f32_16x16x32_bf16 a[164:167], v[148:151], v[180:183], a[164:167]
    v_cvt_pk_bf16_f32 v118, v112, v113
    v_cvt_pk_bf16_f32 v119, v114, v115
    v_mfma_f32_16x16x32_bf16 a[192:195], v[152:155], v[180:183], a[192:195]
    v_accvgpr_read_b32 v96, a22
    v_accvgpr_read_b32 v97, a50
    v_mfma_f32_16x16x32_bf16 a[220:223], v[156:159], v[180:183], a[220:223]
    s_add_u32 s72, s70, 81920
    s_cmp_eq_u32 s31, 5
    s_cselect_b32 s72, s69, s72
    buffer_store_dwordx4 v[116:119], v237, s[40:43], s72 offen offset:1024 sc1
    s_cmp_eq_u32 s31, 5
    s_cbranch_scc0 L_keep24
    v_mov_b32 v192, v116
    v_mov_b32 v193, v117
    v_mov_b32 v194, v118
    v_mov_b32 v195, v119
L_keep24:
    v_accvgpr_read_b32 v98, a78
    v_accvgpr_read_b32 v99, a106
    v_mfma_f32_16x16x32_bf16 a[248:251], v[164:167], v[180:183], a[248:251]
    s_waitcnt lgkmcnt(1)
    v_accvgpr_read_b32 v100, a134
    v_accvgpr_read_b32 v101, a162
    v_mfma_f32_16x16x32_bf16 a[24:27], v[32:35], v[184:187], a[24:27]
    v_accvgpr_read_b32 v102, a190
    v_accvgpr_read_b32 v103, a218
    v_mfma_f32_16x16x32_bf16 a[52:55], v[36:39], v[184:187], a[52:55]
    v_cvt_pk_bf16_f32 v104, v96, v97
    v_cvt_pk_bf16_f32 v105, v98, v99
    v_mfma_f32_16x16x32_bf16 a[80:83], v[40:43], v[184:187], a[80:83]
    v_cvt_pk_bf16_f32 v106, v100, v101
    v_cvt_pk_bf16_f32 v107, v102, v103
    v_mfma_f32_16x16x32_bf16 a[108:111], v[44:47], v[184:187], a[108:111]
    v_accvgpr_read_b32 v108, a23
    v_accvgpr_read_b32 v109, a51
    v_mfma_f32_16x16x32_bf16 a[136:139], v[48:51], v[184:187], a[136:139]
    s_add_u32 s72, s70, 81920
    s_cmp_eq_u32 s31, 5
    s_cselect_b32 s72, s69, s72
    buffer_store_dwordx4 v[104:107], v237, s[40:43], s72 offen offset:2048 sc1
    s_cmp_eq_u32 s31, 5
    s_cbranch_scc0 L_keep25
    v_mov_b32 v196, v104
    v_mov_b32 v197, v105
    v_mov_b32 v198, v106
    v_mov_b32 v199, v107
L_keep25:
    v_accvgpr_read_b32 v110, a79
    v_accvgpr_read_b32 v111, a107
    v_mfma_f32_16x16x32_bf16 a[164:167], v[52:55], v[184:187], a[164:167]
    v_accvgpr_read_b32 v112, a135
    v_accvgpr_read_b32 v113, a163
    v_mfma_f32_16x16x32_bf16 a[192:195], v[56:59], v[184:187], a[192:195]
    v_accvgpr_read_b32 v114, a191
    v_accvgpr_read_b32 v115, a219
    v_mfma_f32_16x16x32_bf16 a[220:223], v[60:63], v[184:187], a[220:223]
    v_cvt_pk_bf16_f32 v116, v108, v109
    v_cvt_pk_bf16_f32 v117, v110, v111
    v_mfma_f32_16x16x32_bf16 a[248:251], v[168:171], v[184:187], a[248:251]
    s_waitcnt lgkmcnt(0)
    v_cvt_pk_bf16_f32 v118, v112, v113
    v_cvt_pk_bf16_f32 v119, v114, v115
    v_mfma_f32_16x16x32_bf16 a[24:27], v[64:67], v[176:179], a[24:27]
    v_accvgpr_read_b32 v96, a244
    v_accvgpr_read_b32 v97, a245
    v_mfma_f32_16x16x32_bf16 a[52:55], v[68:71], v[176:179], a[52:55]
    s_add_u32 s72, s70, 81920
    s_cmp_eq_u32 s31, 5
    s_cselect_b32 s72, s69, s72
    buffer_store_dwordx4 v[116:119], v237, s[40:43], s72 offen offset:3072 sc1
    s_cmp_eq_u32 s31, 5
    s_cbranch_scc0 L_keep26
    v_mov_b32 v200, v116
    v_mov_b32 v201, v117
    v_mov_b32 v202, v118
    v_mov_b32 v203, v119
L_keep26:
    v_accvgpr_read_b32 v98, a246
    v_accvgpr_read_b32 v99, a247
    v_mfma_f32_16x16x32_bf16 a[80:83], v[72:75], v[176:179], a[80:83]
    v_cvt_pk_bf16_f32 v122, v96, v97
    v_cvt_pk_bf16_f32 v123, v98, v99
    v_mfma_f32_16x16x32_bf16 a[108:111], v[76:79], v[176:179], a[108:111]
    v_mfma_f32_16x16x32_bf16 a[136:139], v[80:83], v[176:179], a[136:139]
    buffer_store_dwordx4 v[120:123], v237, s[40:43], s71 offen offset:2048 sc1
    s_cmp_eq_u32 s31, 7
    s_cbranch_scc0 L_keep27
    v_mov_b32 v196, v120
    v_mov_b32 v197, v121
    v_mov_b32 v198, v122
    v_mov_b32 v199, v123
L_keep27:
    v_mfma_f32_16x16x32_bf16 a[164:167], v[84:87], v[176:179], a[164:167]
    v_mfma_f32_16x16x32_bf16 a[192:195], v[88:91], v[176:179], a[192:195]
    v_mfma_f32_16x16x32_bf16 a[220:223], v[92:95], v[176:179], a[220:223]
    v_mfma_f32_16x16x32_bf16 a[248:251], v[172:175], v[176:179], a[248:251]
    v_accvgpr_read_b32 v96, a24
    v_accvgpr_read_b32 v97, a52
    v_accvgpr_read_b32 v98, a80
    v_accvgpr_read_b32 v99, a108
    v_accvgpr_read_b32 v100, a136
    v_accvgpr_read_b32 v101, a164
    v_accvgpr_read_b32 v102, a192
    v_accvgpr_read_b32 v103, a220
    v_cvt_pk_bf16_f32 v104, v96, v97
    v_cvt_pk_bf16_f32 v105, v98, v99
    v_cvt_pk_bf16_f32 v106, v100, v101
    v_cvt_pk_bf16_f32 v107, v102, v103
    s_add_u32 s72, s70, 98304
    s_cmp_eq_u32 s31, 6
    s_cselect_b32 s72, s69, s72
    buffer_store_dwordx4 v[104:107], v237, s[40:43], s72 offen offset:0 sc1
    s_cmp_eq_u32 s31, 6
    s_cbranch_scc0 L_keep28
    v_mov_b32 v188, v104
    v_mov_b32 v189, v105
    v_mov_b32 v190, v106
    v_mov_b32 v191, v107
L_keep28:
    v_accvgpr_read_b32 v108, a25
    v_accvgpr_read_b32 v109, a53
    v_accvgpr_read_b32 v110, a81
    v_accvgpr_read_b32 v111, a109
    v_accvgpr_read_b32 v112, a137
    v_accvgpr_read_b32 v113, a165
    v_accvgpr_read_b32 v114, a193
    v_accvgpr_read_b32 v115, a221
    v_cvt_pk_bf16_f32 v116, v108, v109
    v_cvt_pk_bf16_f32 v117, v110, v111
    v_cvt_pk_bf16_f32 v118, v112, v113
    v_cvt_pk_bf16_f32 v119, v114, v115
    s_add_u32 s72, s70, 98304
    s_cmp_eq_u32 s31, 6
    s_cselect_b32 s72, s69, s72
    buffer_store_dwordx4 v[116:119], v237, s[40:43], s72 offen offset:1024 sc1
    s_cmp_eq_u32 s31, 6
    s_cbranch_scc0 L_keep29
    v_mov_b32 v192, v116
    v_mov_b32 v193, v117
    v_mov_b32 v194, v118
    v_mov_b32 v195, v119
L_keep29:
    v_accvgpr_read_b32 v96, a26
    v_accvgpr_read_b32 v97, a54
    v_accvgpr_read_b32 v98, a82
    v_accvgpr_read_b32 v99, a110
    v_accvgpr_read_b32 v100, a138
    v_accvgpr_read_b32 v101, a166
    v_accvgpr_read_b32 v102, a194
    v_accvgpr_read_b32 v103, a222
    v_cvt_pk_bf16_f32 v104, v96, v97
    v_cvt_pk_bf16_f32 v105, v98, v99
    v_cvt_pk_bf16_f32 v106, v100, v101
    v_cvt_pk_bf16_f32 v107, v102, v103
    s_add_u32 s72, s70, 98304
    s_cmp_eq_u32 s31, 6
    s_cselect_b32 s72, s69, s72
    buffer_store_dwordx4 v[104:107], v237, s[40:43], s72 offen offset:2048 sc1
    s_cmp_eq_u32 s31, 6
    s_cbranch_scc0 L_keep30
    v_mov_b32 v196, v104
    v_mov_b32 v197, v105
    v_mov_b32 v198, v106
    v_mov_b32 v199, v107
L_keep30:
    v_accvgpr_read_b32 v108, a27
    v_accvgpr_read_b32 v109, a55
    v_accvgpr_read_b32 v110, a83
    v_accvgpr_read_b32 v111, a111
    v_accvgpr_read_b32 v112, a139
    v_accvgpr_read_b32 v113, a167
    v_accvgpr_read_b32 v114, a195
    v_accvgpr_read_b32 v115, a223
    v_cvt_pk_bf16_f32 v116, v108, v109
    v_cvt_pk_bf16_f32 v117, v110, v111
    v_cvt_pk_bf16_f32 v118, v112, v113
    v_cvt_pk_bf16_f32 v119, v114, v115
    s_add_u32 s72, s70, 98304
    s_cmp_eq_u32 s31, 6
    s_cselect_b32 s72, s69, s72
    buffer_store_dwordx4 v[116:119], v237, s[40:43], s72 offen offset:3072 sc1
    s_cmp_eq_u32 s31, 6
    s_cbranch_scc0 L_keep31
    v_mov_b32 v200, v116
    v_mov_b32 v201, v117
    v_mov_b32 v202, v118
    v_mov_b32 v203, v119
L_keep31:
    v_accvgpr_read_b32 v96, a248
    v_accvgpr_read_b32 v97, a249
    v_accvgpr_read_b32 v98, a250
    v_accvgpr_read_b32 v99, a251
    v_cvt_pk_bf16_f32 v120, v96, v97
    v_cvt_pk_bf16_f32 v121, v98, v99
    buffer_store_dwordx4 v[120:123], v237, s[40:43], s71 offen offset:3072 sc1
    s_cmp_eq_u32 s31, 7
    s_cbranch_scc0 L_keep32
    v_mov_b32 v200, v120
    v_mov_b32 v201, v121
    v_mov_b32 v202, v122
    v_mov_b32 v203, v123
L_keep32:
    s_lshl_b32 s60, s31, 14
    s_lshl_b32 s3, s26, 12
    s_add_u32 s60, s60, s3
    s_mov_b32 s100, 0xffff
    s_cmp_lt_u32 s31, 4
    s_cselect_b32 s67, 0x5555, s100
    v_and_b32 v227, 1, v225
    v_lshlrev_b32 v227, 4, v227
    s_movk_i32 s3, 0x3f80
    v_lshlrev_b32 v227, v227, s3
    v_bfe_u32 v240, v225, 1, 1
    v_lshrrev_b32 v241, 2, v225
    v_sub_u32 v241, v226, v241
    v_lshl_add_u32 v241, v241, 1, v240
    v_cmp_eq_u32 vcc, 0, v241
    s_nop 1
    v_cndmask_b32 v176, 0, v227, vcc
    v_cmp_eq_u32 vcc, 1, v241
    s_nop 1
    v_cndmask_b32 v177, 0, v227, vcc
    v_mov_b32 v178, 0
    v_mov_b32 v179, 0
    v_mov_b32 v180, 0
    v_mov_b32 v181, 0
    v_cmp_eq_u32 vcc, 0, v241
    s_nop 1
    v_cndmask_b32 v182, 0, v227, vcc
    v_cmp_eq_u32 vcc, 1, v241
    s_nop 1
    v_cndmask_b32 v183, 0, v227, vcc
    s_mov_b32 s44, s82
    s_mov_b32 s45, s83
    s_mov_b32 s46, 4128768
    s_mul_i32 s3, s32, 112
    v_add_u32 v240, s3, v225
    s_movk_i32 s4, 2304
    v_mul_lo_u32 v240, v240, s4
    s_mul_i32 s3, s30, 1152
    v_add_u32 v240, s3, v240
    v_lshl_add_u32 v241, v226, 3, v240
    v_lshl_add_u32 v240, v226, 6, v240
    s_mul_i32 s3, s31, 36864
    s_lshl_b32 s5, s26, 8
    s_add_u32 s61, s3, s5
    s_lshl_b32 s62, s26, 5
    s_add_u32 s62, s62, 1024
    v_mfma_f32_16x16x32_bf16 v[0:3], v[176:179], v[188:191], 0
    v_mfma_f32_16x16x32_bf16 v[4:7], v[180:183], v[188:191], 0
    v_mfma_f32_16x16x32_bf16 v[8:11], v[176:179], v[192:195], 0
    v_mfma_f32_16x16x32_bf16 v[12:15], v[180:183], v[192:195], 0
    v_mfma_f32_16x16x32_bf16 v[16:19], v[176:179], v[196:199], 0
    v_mfma_f32_16x16x32_bf16 v[20:23], v[180:183], v[196:199], 0
    v_mfma_f32_16x16x32_bf16 v[24:27], v[176:179], v[200:203], 0
    v_mfma_f32_16x16x32_bf16 v[28:31], v[180:183], v[200:203], 0
    s_waitcnt vmcnt(0)
    buffer_store_dword v234, v233, s[52:55], s25 offen offset:4 sc1
    s_mov_b32 s100, 0xaaaa
    s_cmp_lt_u32 s31, 4
    s_cselect_b32 s67, 0x5555, s100
    s_cselect_b32 s68, 0, 1
    s_lshl_b32 s3, s31, 1
    s_add_u32 s3, s3, s68
    s_bitset0_b32 s67, s3
    s_mov_b32 s99, 0
L_cnt:
    v_readfirstlane_b32 s3, v228
    s_add_u32 s99, s99, 1
    s_cmp_ge_u32 s3, 8
    s_cbranch_scc1 L_poll
    s_sleep 8
    buffer_load_dword v228, v244, s[76:79], 0 offen sc1
    s_waitcnt vmcnt(0)
    s_cmp_lt_u32 s99, 0x40000
    s_cbranch_scc1 L_cnt
L_poll:
    buffer_load_dword v227, v231, s[52:55], s74 offen sc1
    s_waitcnt vmcnt(0)
    v_cmp_eq_u32 vcc, 1, v227
    s_nop 0
    s_and_b32 s66, vcc_lo, s67
    s_andn2_b32 s67, s67, s66
    s_mov_b32 s58, s31
    s_add_u32 s58, s58, 1
    s_and_b32 s58, s58, 7
    s_lshl_b32 s3, s58, 1
    s_add_u32 s3, s3, s68
    s_bitcmp1_b32 s66, s3
    s_cbranch_scc0 L_np0
    s_lshl_b32 s59, s58, 17
    s_add_u32 s59, s59, s60
    buffer_load_dwordx4 v[64:67], v237, s[40:43], s59 offen offset:0 sc1
    buffer_load_dwordx4 v[68:71], v237, s[40:43], s59 offen offset:1024 sc1
    buffer_load_dwordx4 v[72:75], v237, s[40:43], s59 offen offset:2048 sc1
    buffer_load_dwordx4 v[76:79], v237, s[40:43], s59 offen offset:3072 sc1
L_np0:
    s_add_u32 s58, s58, 1
    s_and_b32 s58, s58, 7
    s_lshl_b32 s3, s58, 1
    s_add_u32 s3, s3, s68
    s_bitcmp1_b32 s66, s3
    s_cbranch_scc0 L_np1
    s_lshl_b32 s59, s58, 17
    s_add_u32 s59, s59, s60
    buffer_load_dwordx4 v[80:83], v237, s[40:43], s59 offen offset:0 sc1
    buffer_load_dwordx4 v[84:87], v237, s[40:43], s59 offen offset:1024 sc1
    buffer_load_dwordx4 v[88:91], v237, s[40:43], s59 offen offset:2048 sc1
    buffer_load_dwordx4 v[92:95], v237, s[40:43], s59 offen offset:3072 sc1
L_np1:
    s_add_u32 s58, s58, 1
    s_and_b32 s58, s58, 7
    s_lshl_b32 s3, s58, 1
    s_add_u32 s3, s3, s68
    s_bitcmp1_b32 s66, s3
    s_cbranch_scc0 L_np2
    s_lshl_b32 s59, s58, 17
    s_add_u32 s59, s59, s60
    buffer_load_dwordx4 v[96:99], v237, s[40:43], s59 offen offset:0 sc1
    buffer_load_dwordx4 v[100:103], v237, s[40:43], s59 offen offset:1024 sc1
    buffer_load_dwordx4 v[104:107], v237, s[40:43], s59 offen offset:2048 sc1
    buffer_load_dwordx4 v[108:111], v237, s[40:43], s59 offen offset:3072 sc1
L_np2:
    s_add_u32 s58, s58, 1
    s_and_b32 s58, s58, 7
    s_lshl_b32 s3, s58, 1
    s_add_u32 s3, s3, s68
    s_bitcmp1_b32 s66, s3
    s_cbranch_scc0 L_np3
    s_lshl_b32 s59, s58, 17
    s_add_u32 s59, s59, s60
    buffer_load_dwordx4 v[112:115], v237, s[40:43], s59 offen offset:0 sc1
    buffer_load_dwordx4 v[116:119], v237, s[40:43], s59 offen offset:1024 sc1
    buffer_load_dwordx4 v[120:123], v237, s[40:43], s59 offen offset:2048 sc1
    buffer_load_dwordx4 v[124:127], v237, s[40:43], s59 offen offset:3072 sc1
L_np3:
    s_add_u32 s58, s58, 1
    s_and_b32 s58, s58, 7
    s_lshl_b32 s3, s58, 1
    s_add_u32 s3, s3, s68
    s_bitcmp1_b32 s66, s3
    s_cbranch_scc0 L_np4
    s_lshl_b32 s59, s58, 17
    s_add_u32 s59, s59, s60
    buffer_load_dwordx4 v[128:131], v237, s[40:43], s59 offen offset:0 sc1
    buffer_load_dwordx4 v[132:135], v237, s[40:43], s59 offen offset:1024 sc1
    buffer_load_dwordx4 v[136:139], v237, s[40:43], s59 offen offset:2048 sc1
    buffer_load_dwordx4 v[140:143], v237, s[40:43], s59 offen offset:3072 sc1
L_np4:
    s_add_u32 s58, s58, 1
    s_and_b32 s58, s58, 7
    s_lshl_b32 s3, s58, 1
    s_add_u32 s3, s3, s68
    s_bitcmp1_b32 s66, s3
    s_cbranch_scc0 L_np5
    s_lshl_b32 s59, s58, 17
    s_add_u32 s59, s59, s60
    buffer_load_dwordx4 v[144:147], v237, s[40:43], s59 offen offset:0 sc1
    buffer_load_dwordx4 v[148:151], v237, s[40:43], s59 offen offset:1024 sc1
    buffer_load_dwordx4 v[152:155], v237, s[40:43], s59 offen offset:2048 sc1
    buffer_load_dwordx4 v[156:159], v237, s[40:43], s59 offen offset:3072 sc1
L_np5:
    s_add_u32 s58, s58, 1
    s_and_b32 s58, s58, 7
    s_lshl_b32 s3, s58, 1
    s_add_u32 s3, s3, s68
    s_bitcmp1_b32 s66, s3
    s_cbranch_scc0 L_np6
    s_lshl_b32 s59, s58, 17
    s_add_u32 s59, s59, s60
    buffer_load_dwordx4 v[160:163], v237, s[40:43], s59 offen offset:0 sc1
    buffer_load_dwordx4 v[164:167], v237, s[40:43], s59 offen offset:1024 sc1
    buffer_load_dwordx4 v[168:171], v237, s[40:43], s59 offen offset:2048 sc1
    buffer_load_dwordx4 v[172:175], v237, s[40:43], s59 offen offset:3072 sc1
L_np6:
    s_cmp_eq_u32 s67, 0
    s_cbranch_scc1 L_pdone
    s_sleep 2
    s_add_u32 s99, s99, 1
    s_cmp_lt_u32 s99, 0x40000
    s_cbranch_scc1 L_poll
L_pdone:
    s_waitcnt vmcnt(0)
    v_mfma_f32_16x16x32_bf16 v[0:3], v[176:179], v[64:67], v[0:3]
    v_mfma_f32_16x16x32_bf16 v[4:7], v[180:183], v[64:67], v[4:7]
    v_mfma_f32_16x16x32_bf16 v[8:11], v[176:179], v[68:71], v[8:11]
    v_mfma_f32_16x16x32_bf16 v[12:15], v[180:183], v[68:71], v[12:15]
    v_mfma_f32_16x16x32_bf16 v[16:19], v[176:179], v[72:75], v[16:19]
    v_mfma_f32_16x16x32_bf16 v[20:23], v[180:183], v[72:75], v[20:23]
    v_mfma_f32_16x16x32_bf16 v[24:27], v[176:179], v[76:79], v[24:27]
    v_mfma_f32_16x16x32_bf16 v[28:31], v[180:183], v[76:79], v[28:31]
    v_mfma_f32_16x16x32_bf16 v[0:3], v[176:179], v[80:83], v[0:3]
    v_mfma_f32_16x16x32_bf16 v[4:7], v[180:183], v[80:83], v[4:7]
    v_mfma_f32_16x16x32_bf16 v[8:11], v[176:179], v[84:87], v[8:11]
    v_mfma_f32_16x16x32_bf16 v[12:15], v[180:183], v[84:87], v[12:15]
    v_mfma_f32_16x16x32_bf16 v[16:19], v[176:179], v[88:91], v[16:19]
    v_mfma_f32_16x16x32_bf16 v[20:23], v[180:183], v[88:91], v[20:23]
    v_mfma_f32_16x16x32_bf16 v[24:27], v[176:179], v[92:95], v[24:27]
    v_mfma_f32_16x16x32_bf16 v[28:31], v[180:183], v[92:95], v[28:31]
    v_mfma_f32_16x16x32_bf16 v[0:3], v[176:179], v[96:99], v[0:3]
    v_mfma_f32_16x16x32_bf16 v[4:7], v[180:183], v[96:99], v[4:7]
    v_mfma_f32_16x16x32_bf16 v[8:11], v[176:179], v[100:103], v[8:11]
    v_mfma_f32_16x16x32_bf16 v[12:15], v[180:183], v[100:103], v[12:15]
    v_mfma_f32_16x16x32_bf16 v[16:19], v[176:179], v[104:107], v[16:19]
    v_mfma_f32_16x16x32_bf16 v[20:23], v[180:183], v[104:107], v[20:23]
    v_mfma_f32_16x16x32_bf16 v[24:27], v[176:179], v[108:111], v[24:27]
    v_mfma_f32_16x16x32_bf16 v[28:31], v[180:183], v[108:111], v[28:31]
    v_mfma_f32_16x16x32_bf16 v[0:3], v[176:179], v[112:115], v[0:3]
    v_mfma_f32_16x16x32_bf16 v[4:7], v[180:183], v[112:115], v[4:7]
    v_mfma_f32_16x16x32_bf16 v[8:11], v[176:179], v[116:119], v[8:11]
    v_mfma_f32_16x16x32_bf16 v[12:15], v[180:183], v[116:119], v[12:15]
    v_mfma_f32_16x16x32_bf16 v[16:19], v[176:179], v[120:123], v[16:19]
    v_mfma_f32_16x16x32_bf16 v[20:23], v[180:183], v[120:123], v[20:23]
    v_mfma_f32_16x16x32_bf16 v[24:27], v[176:179], v[124:127], v[24:27]
    v_mfma_f32_16x16x32_bf16 v[28:31], v[180:183], v[124:127], v[28:31]
    v_mfma_f32_16x16x32_bf16 v[0:3], v[176:179], v[128:131], v[0:3]
    v_mfma_f32_16x16x32_bf16 v[4:7], v[180:183], v[128:131], v[4:7]
    v_mfma_f32_16x16x32_bf16 v[8:11], v[176:179], v[132:135], v[8:11]
    v_mfma_f32_16x16x32_bf16 v[12:15], v[180:183], v[132:135], v[12:15]
    v_mfma_f32_16x16x32_bf16 v[16:19], v[176:179], v[136:139], v[16:19]
    v_mfma_f32_16x16x32_bf16 v[20:23], v[180:183], v[136:139], v[20:23]
    v_mfma_f32_16x16x32_bf16 v[24:27], v[176:179], v[140:143], v[24:27]
    v_mfma_f32_16x16x32_bf16 v[28:31], v[180:183], v[140:143], v[28:31]
    v_mfma_f32_16x16x32_bf16 v[0:3], v[176:179], v[144:147], v[0:3]
    v_mfma_f32_16x16x32_bf16 v[4:7], v[180:183], v[144:147], v[4:7]
    v_mfma_f32_16x16x32_bf16 v[8:11], v[176:179], v[148:151], v[8:11]
    v_mfma_f32_16x16x32_bf16 v[12:15], v[180:183], v[148:151], v[12:15]
    v_mfma_f32_16x16x32_bf16 v[16:19], v[176:179], v[152:155], v[16:19]
    v_mfma_f32_16x16x32_bf16 v[20:23], v[180:183], v[152:155], v[20:23]
    v_mfma_f32_16x16x32_bf16 v[24:27], v[176:179], v[156:159], v[24:27]
    v_mfma_f32_16x16x32_bf16 v[28:31], v[180:183], v[156:159], v[28:31]
    v_mfma_f32_16x16x32_bf16 v[0:3], v[176:179], v[160:163], v[0:3]
    v_mfma_f32_16x16x32_bf16 v[4:7], v[180:183], v[160:163], v[4:7]
    v_mfma_f32_16x16x32_bf16 v[8:11], v[176:179], v[164:167], v[8:11]
    v_mfma_f32_16x16x32_bf16 v[12:15], v[180:183], v[164:167], v[12:15]
    v_mfma_f32_16x16x32_bf16 v[16:19], v[176:179], v[168:171], v[16:19]
    v_mfma_f32_16x16x32_bf16 v[20:23], v[180:183], v[168:171], v[20:23]
    v_mfma_f32_16x16x32_bf16 v[24:27], v[176:179], v[172:175], v[24:27]
    v_mfma_f32_16x16x32_bf16 v[28:31], v[180:183], v[172:175], v[28:31]
    s_nop 0
    v_cvt_pk_bf16_f32 v208, v0, v1
    v_cvt_pk_bf16_f32 v209, v2, v3
    v_cvt_pk_bf16_f32 v210, v4, v5
    v_cvt_pk_bf16_f32 v211, v6, v7
    v_cvt_pk_bf16_f32 v212, v8, v9
    v_cvt_pk_bf16_f32 v213, v10, v11
    v_cvt_pk_bf16_f32 v214, v12, v13
    v_cvt_pk_bf16_f32 v215, v14, v15
    v_cvt_pk_bf16_f32 v216, v16, v17
    v_cvt_pk_bf16_f32 v217, v18, v19
    v_cvt_pk_bf16_f32 v218, v20, v21
    v_cvt_pk_bf16_f32 v219, v22, v23
    v_cvt_pk_bf16_f32 v220, v24, v25
    v_cvt_pk_bf16_f32 v221, v26, v27
    v_cvt_pk_bf16_f32 v222, v28, v29
    v_cvt_pk_bf16_f32 v223, v30, v31
    s_cmp_lt_u32 s31, 7
    s_cbranch_scc0 L_osp
    buffer_store_dwordx4 v[208:211], v240, s[44:47], s61 offen offset:0
    buffer_store_dwordx4 v[212:215], v240, s[44:47], s61 offen offset:16
    buffer_store_dwordx4 v[216:219], v240, s[44:47], s61 offen offset:32
    buffer_store_dwordx4 v[220:223], v240, s[44:47], s61 offen offset:48
    s_branch L_oj
L_osp:
    buffer_store_dwordx2 v[208:209], v241, s[44:47], s62 offen
    s_add_u32 s62, s62, 36864
    buffer_store_dwordx2 v[210:211], v241, s[44:47], s62 offen
    s_add_u32 s62, s62, 36864
    buffer_store_dwordx2 v[212:213], v241, s[44:47], s62 offen
    s_add_u32 s62, s62, 36864
    buffer_store_dwordx2 v[214:215], v241, s[44:47], s62 offen
    s_add_u32 s62, s62, 36864
    buffer_store_dwordx2 v[216:217], v241, s[44:47], s62 offen
    s_add_u32 s62, s62, 36864
    buffer_store_dwordx2 v[218:219], v241, s[44:47], s62 offen
    s_add_u32 s62, s62, 36864
    buffer_store_dwordx2 v[220:221], v241, s[44:47], s62 offen
    s_add_u32 s62, s62, 36864
L_oj:
    s_endpgm
L_slow:
    s_add_u32 s48, s10, s29
    s_addc_u32 s49, s11, 0
    s_sub_u32 s48, s48, 4096
    s_subb_u32 s49, s49, 0
    s_add_u32 s44, s12, s29
    s_addc_u32 s45, s13, 0
    s_sub_u32 s44, s44, 4096
    s_subb_u32 s45, s45, 0
    s_mov_b32 s46, 135168
    s_mov_b32 s50, 135168
    s_mul_i32 s67, s26, 28672
    v_and_b32 v227, 7, v225
    v_mul_u32_u24 v245, 1056, v227
    v_lshrrev_b32 v227, 3, v225
    v_lshl_add_u32 v245, v227, 8, v245
    v_and_b32 v227, 1, v226
    v_lshl_add_u32 v245, v227, 4, v245
    v_lshrrev_b32 v227, 1, v226
    v_lshl_add_u32 v245, v227, 7, v245
    v_add_u32 v245, s67, v245
    v_lshrrev_b32 v227, 2, v225
    v_and_b32 v228, 1, v226
    v_lshl_or_b32 v227, v228, 2, v227
    v_mul_u32_u24 v246, 1056, v227
    v_and_b32 v228, 3, v225
    v_lshl_add_u32 v246, v228, 3, v246
    v_lshrrev_b32 v228, 1, v226
    v_lshl_add_u32 v246, v228, 8, v246
    s_add_u32 s3, s67, 8448
    v_add_u32 v246, s3, v246
    s_mov_b32 s99, 1
    s_mov_b32 s66, 0
    s_mov_b32 s63, 0
    v_mov_b32 v84, 0xff61b1e6
    v_mov_b32 v248, 0
    v_mov_b32 v85, 0xff61b1e6
    v_mov_b32 v249, 0
    v_mov_b32 v86, 0xff61b1e6
    v_mov_b32 v250, 0
    v_mov_b32 v87, 0xff61b1e6
    v_mov_b32 v251, 0
    v_mov_b32 v88, 0xff61b1e6
    v_mov_b32 v252, 0
    v_mov_b32 v89, 0xff61b1e6
    v_mov_b32 v253, 0
    v_mov_b32 v90, 0xff61b1e6
    v_mov_b32 v254, 0
    v_mov_b32 v92, 0
    v_mov_b32 v93, 0
    v_mov_b32 v94, 0
    v_mov_b32 v95, 0
    s_nop 1
    v_mfma_f32_32x32x16_bf16 a[0:15], v[92:95], v[92:95], 0
    v_mfma_f32_32x32x16_bf16 a[16:31], v[92:95], v[92:95], 0
    v_mfma_f32_32x32x16_bf16 a[32:47], v[92:95], v[92:95], 0
    v_mfma_f32_32x32x16_bf16 a[48:63], v[92:95], v[92:95], 0
    v_mfma_f32_32x32x16_bf16 a[64:79], v[92:95], v[92:95], 0
    v_mfma_f32_32x32x16_bf16 a[80:95], v[92:95], v[92:95], 0
    v_mfma_f32_32x32x16_bf16 a[96:111], v[92:95], v[92:95], 0
    v_mfma_f32_32x32x16_bf16 a[112:127], v[92:95], v[92:95], 0
    v_mfma_f32_32x32x16_bf16 a[128:143], v[92:95], v[92:95], 0
    v_mfma_f32_32x32x16_bf16 a[144:159], v[92:95], v[92:95], 0
    v_mfma_f32_32x32x16_bf16 a[160:175], v[92:95], v[92:95], 0
    v_mfma_f32_32x32x16_bf16 a[176:191], v[92:95], v[92:95], 0
    v_mfma_f32_32x32x16_bf16 a[192:207], v[92:95], v[92:95], 0
    v_mfma_f32_32x32x16_bf16 a[208:223], v[92:95], v[92:95], 0
    s_nop 11
L_sloop:
    s_add_u32 m0, s67, 0
    s_add_u32 s3, s63, 0
    buffer_load_dwordx4 v240, s[48:51], s3 offen offset:0 lds
    s_add_u32 s3, s63, 1024
    buffer_load_dwordx4 v241, s[48:51], s3 offen offset:1056 lds
    s_add_u32 s3, s63, 2048
    buffer_load_dwordx4 v242, s[48:51], s3 offen offset:2112 lds
    s_add_u32 s3, s63, 3072
    buffer_load_dwordx4 v243, s[48:51], s3 offen offset:3168 lds
    s_add_u32 m0, s67, 4224
    s_add_u32 s3, s63, 4096
    buffer_load_dwordx4 v240, s[48:51], s3 offen offset:0 lds
    s_add_u32 s3, s63, 5120
    buffer_load_dwordx4 v241, s[48:51], s3 offen offset:1056 lds
    s_add_u32 s3, s63, 6144
    buffer_load_dwordx4 v242, s[48:51], s3 offen offset:2112 lds
    s_add_u32 s3, s63, 7168
    buffer_load_dwordx4 v243, s[48:51], s3 offen offset:3168 lds
    s_add_u32 m0, s67, 8448
    s_add_u32 s3, s63, 0
    buffer_load_dwordx4 v240, s[44:47], s3 offen offset:0 lds
    s_add_u32 s3, s63, 1024
    buffer_load_dwordx4 v241, s[44:47], s3 offen offset:1056 lds
    s_add_u32 s3, s63, 2048
    buffer_load_dwordx4 v242, s[44:47], s3 offen offset:2112 lds
    s_add_u32 s3, s63, 3072
    buffer_load_dwordx4 v243, s[44:47], s3 offen offset:3168 lds
    s_add_u32 m0, s67, 12672
    s_add_u32 s3, s63, 4096
    buffer_load_dwordx4 v240, s[44:47], s3 offen offset:0 lds
    s_add_u32 s3, s63, 5120
    buffer_load_dwordx4 v241, s[44:47], s3 offen offset:1056 lds
    s_add_u32 s3, s63, 6144
    buffer_load_dwordx4 v242, s[44:47], s3 offen offset:2112 lds
    s_add_u32 s3, s63, 7168
    buffer_load_dwordx4 v243, s[44:47], s3 offen offset:3168 lds
    s_waitcnt vmcnt(0)
    ds_read_b128 a[224:227], v245 offset:0
    s_waitcnt lgkmcnt(0)
    v_mfma_f32_16x16x32_bf16 v[0:3], a[224:227], v[96:99], 0
    v_mfma_f32_16x16x32_bf16 v[12:15], a[224:227], v[112:115], 0
    v_mfma_f32_16x16x32_bf16 v[24:27], a[224:227], v[128:131], 0
    v_mfma_f32_16x16x32_bf16 v[36:39], a[224:227], v[144:147], 0
    v_mfma_f32_16x16x32_bf16 v[48:51], a[224:227], v[160:163], 0
    v_mfma_f32_16x16x32_bf16 v[60:63], a[224:227], v[176:179], 0
    v_mfma_f32_16x16x32_bf16 v[72:75], a[224:227], v[192:195], 0
    ds_read_b128 a[224:227], v245 offset:32
    s_waitcnt lgkmcnt(0)
    v_mfma_f32_16x16x32_bf16 v[0:3], a[224:227], v[100:103], v[0:3]
    v_mfma_f32_16x16x32_bf16 v[12:15], a[224:227], v[116:119], v[12:15]
    v_mfma_f32_16x16x32_bf16 v[24:27], a[224:227], v[132:135], v[24:27]
    v_mfma_f32_16x16x32_bf16 v[36:39], a[224:227], v[148:151], v[36:39]
    v_mfma_f32_16x16x32_bf16 v[48:51], a[224:227], v[164:167], v[48:51]
    v_mfma_f32_16x16x32_bf16 v[60:63], a[224:227], v[180:183], v[60:63]
    v_mfma_f32_16x16x32_bf16 v[72:75], a[224:227], v[196:199], v[72:75]
    ds_read_b128 a[224:227], v245 offset:64
    s_waitcnt lgkmcnt(0)
    v_mfma_f32_16x16x32_bf16 v[0:3], a[224:227], v[104:107], v[0:3]
    v_mfma_f32_16x16x32_bf16 v[12:15], a[224:227], v[120:123], v[12:15]
    v_mfma_f32_16x16x32_bf16 v[24:27], a[224:227], v[136:139], v[24:27]
    v_mfma_f32_16x16x32_bf16 v[36:39], a[224:227], v[152:155], v[36:39]
    v_mfma_f32_16x16x32_bf16 v[48:51], a[224:227], v[168:171], v[48:51]
    v_mfma_f32_16x16x32_bf16 v[60:63], a[224:227], v[184:187], v[60:63]
    v_mfma_f32_16x16x32_bf16 v[72:75], a[224:227], v[200:203], v[72:75]
    ds_read_b128 a[224:227], v245 offset:96
    s_waitcnt lgkmcnt(0)
    v_mfma_f32_16x16x32_bf16 v[0:3], a[224:227], v[108:111], v[0:3]
    v_mfma_f32_16x16x32_bf16 v[12:15], a[224:227], v[124:127], v[12:15]
    v_mfma_f32_16x16x32_bf16 v[24:27], a[224:227], v[140:143], v[24:27]
    v_mfma_f32_16x16x32_bf16 v[36:39], a[224:227], v[156:159], v[36:39]
    v_mfma_f32_16x16x32_bf16 v[48:51], a[224:227], v[172:175], v[48:51]
    v_mfma_f32_16x16x32_bf16 v[60:63], a[224:227], v[188:191], v[60:63]
    v_mfma_f32_16x16x32_bf16 v[72:75], a[224:227], v[204:207], v[72:75]
    ds_read_b128 a[224:227], v245 offset:512
    s_waitcnt lgkmcnt(0)
    v_mfma_f32_16x16x32_bf16 v[8:11], a[224:227], v[96:99], 0
    v_mfma_f32_16x16x32_bf16 v[20:23], a[224:227], v[112:115], 0
    v_mfma_f32_16x16x32_bf16 v[32:35], a[224:227], v[128:131], 0
    v_mfma_f32_16x16x32_bf16 v[44:47], a[224:227], v[144:147], 0
    v_mfma_f32_16x16x32_bf16 v[56:59], a[224:227], v[160:163], 0
    v_mfma_f32_16x16x32_bf16 v[68:71], a[224:227], v[176:179], 0
    v_mfma_f32_16x16x32_bf16 v[80:83], a[224:227], v[192:195], 0
    ds_read_b128 a[224:227], v245 offset:544
    s_waitcnt lgkmcnt(0)
    v_mfma_f32_16x16x32_bf16 v[8:11], a[224:227], v[100:103], v[8:11]
    v_mfma_f32_16x16x32_bf16 v[20:23], a[224:227], v[116:119], v[20:23]
    v_mfma_f32_16x16x32_bf16 v[32:35], a[224:227], v[132:135], v[32:35]
    v_mfma_f32_16x16x32_bf16 v[44:47], a[224:227], v[148:151], v[44:47]
    v_mfma_f32_16x16x32_bf16 v[56:59], a[224:227], v[164:167], v[56:59]
    v_mfma_f32_16x16x32_bf16 v[68:71], a[224:227], v[180:183], v[68:71]
    v_mfma_f32_16x16x32_bf16 v[80:83], a[224:227], v[196:199], v[80:83]
    ds_read_b128 a[224:227], v245 offset:576
    s_waitcnt lgkmcnt(0)
    v_mfma_f32_16x16x32_bf16 v[8:11], a[224:227], v[104:107], v[8:11]
    v_mfma_f32_16x16x32_bf16 v[20:23], a[224:227], v[120:123], v[20:23]
    v_mfma_f32_16x16x32_bf16 v[32:35], a[224:227], v[136:139], v[32:35]
    v_mfma_f32_16x16x32_bf16 v[44:47], a[224:227], v[152:155], v[44:47]
    v_mfma_f32_16x16x32_bf16 v[56:59], a[224:227], v[168:171], v[56:59]
    v_mfma_f32_16x16x32_bf16 v[68:71], a[224:227], v[184:187], v[68:71]
    v_mfma_f32_16x16x32_bf16 v[80:83], a[224:227], v[200:203], v[80:83]
    ds_read_b128 a[224:227], v245 offset:608
    s_waitcnt lgkmcnt(0)
    v_mfma_f32_16x16x32_bf16 v[8:11], a[224:227], v[108:111], v[8:11]
    v_mfma_f32_16x16x32_bf16 v[20:23], a[224:227], v[124:127], v[20:23]
    v_mfma_f32_16x16x32_bf16 v[32:35], a[224:227], v[140:143], v[32:35]
    v_mfma_f32_16x16x32_bf16 v[44:47], a[224:227], v[156:159], v[44:47]
    v_mfma_f32_16x16x32_bf16 v[56:59], a[224:227], v[172:175], v[56:59]
    v_mfma_f32_16x16x32_bf16 v[68:71], a[224:227], v[188:191], v[68:71]
    v_mfma_f32_16x16x32_bf16 v[80:83], a[224:227], v[204:207], v[80:83]
    s_cmp_ge_u32 s66, 16
    s_cbranch_scc1 L_spass2
    v_max3_f32 v84, v84, v0, v1
    v_max3_f32 v84, v84, v2, v3
    v_max3_f32 v84, v84, v8, v9
    v_max3_f32 v84, v84, v10, v11
    v_max3_f32 v85, v85, v12, v13
    v_max3_f32 v85, v85, v14, v15
    v_max3_f32 v85, v85, v20, v21
    v_max3_f32 v85, v85, v22, v23
    v_max3_f32 v86, v86, v24, v25
    v_max3_f32 v86, v86, v26, v27
    v_max3_f32 v86, v86, v32, v33
    v_max3_f32 v86, v86, v34, v35
    v_max3_f32 v87, v87, v36, v37
    v_max3_f32 v87, v87, v38, v39
    v_max3_f32 v87, v87, v44, v45
    v_max3_f32 v87, v87, v46, v47
    v_max3_f32 v88, v88, v48, v49
    v_max3_f32 v88, v88, v50, v51
    v_max3_f32 v88, v88, v56, v57
    v_max3_f32 v88, v88, v58, v59
    v_max3_f32 v89, v89, v60, v61
    v_max3_f32 v89, v89, v62, v63
    v_max3_f32 v89, v89, v68, v69
    v_max3_f32 v89, v89, v70, v71
    v_max3_f32 v90, v90, v72, v73
    v_max3_f32 v90, v90, v74, v75
    v_max3_f32 v90, v90, v80, v81
    v_max3_f32 v90, v90, v82, v83
    s_cmp_lg_u32 s66, 15
    s_cbranch_scc1 L_snext
    v_mov_b32 v227, v84
    s_nop 1
    v_permlane32_swap_b32 v84, v227
    v_max_f32 v84, v84, v227
    v_mov_b32 v227, v84
    s_nop 1
    v_permlane16_swap_b32 v84, v227
    v_max_f32 v84, v84, v227
    v_mov_b32 v227, v85
    s_nop 1
    v_permlane32_swap_b32 v85, v227
    v_max_f32 v85, v85, v227
    v_mov_b32 v227, v85
    s_nop 1
    v_permlane16_swap_b32 v85, v227
    v_max_f32 v85, v85, v227
    v_mov_b32 v227, v86
    s_nop 1
    v_permlane32_swap_b32 v86, v227
    v_max_f32 v86, v86, v227
    v_mov_b32 v227, v86
    s_nop 1
    v_permlane16_swap_b32 v86, v227
    v_max_f32 v86, v86, v227
    v_mov_b32 v227, v87
    s_nop 1
    v_permlane32_swap_b32 v87, v227
    v_max_f32 v87, v87, v227
    v_mov_b32 v227, v87
    s_nop 1
    v_permlane16_swap_b32 v87, v227
    v_max_f32 v87, v87, v227
    v_mov_b32 v227, v88
    s_nop 1
    v_permlane32_swap_b32 v88, v227
    v_max_f32 v88, v88, v227
    v_mov_b32 v227, v88
    s_nop 1
    v_permlane16_swap_b32 v88, v227
    v_max_f32 v88, v88, v227
    v_mov_b32 v227, v89
    s_nop 1
    v_permlane32_swap_b32 v89, v227
    v_max_f32 v89, v89, v227
    v_mov_b32 v227, v89
    s_nop 1
    v_permlane16_swap_b32 v89, v227
    v_max_f32 v89, v89, v227
    v_mov_b32 v227, v90
    s_nop 1
    v_permlane32_swap_b32 v90, v227
    v_max_f32 v90, v90, v227
    v_mov_b32 v227, v90
    s_nop 1
    v_permlane16_swap_b32 v90, v227
    v_max_f32 v90, v90, v227
    s_mov_b32 s63, 4294959104
    s_branch L_snext
L_spass2:
    v_sub_f32 v0, v0, v84
    v_sub_f32 v1, v1, v84
    v_sub_f32 v2, v2, v84
    v_sub_f32 v3, v3, v84
    v_sub_f32 v8, v8, v84
    v_sub_f32 v9, v9, v84
    v_sub_f32 v10, v10, v84
    v_sub_f32 v11, v11, v84
    v_sub_f32 v12, v12, v85
    v_sub_f32 v13, v13, v85
    v_sub_f32 v14, v14, v85
    v_sub_f32 v15, v15, v85
    v_sub_f32 v20, v20, v85
    v_sub_f32 v21, v21, v85
    v_sub_f32 v22, v22, v85
    v_sub_f32 v23, v23, v85
    v_sub_f32 v24, v24, v86
    v_sub_f32 v25, v25, v86
    v_sub_f32 v26, v26, v86
    v_sub_f32 v27, v27, v86
    v_sub_f32 v32, v32, v86
    v_sub_f32 v33, v33, v86
    v_sub_f32 v34, v34, v86
    v_sub_f32 v35, v35, v86
    v_sub_f32 v36, v36, v87
    v_sub_f32 v37, v37, v87
    v_sub_f32 v38, v38, v87
    v_sub_f32 v39, v39, v87
    v_sub_f32 v44, v44, v87
    v_sub_f32 v45, v45, v87
    v_sub_f32 v46, v46, v87
    v_sub_f32 v47, v47, v87
    v_sub_f32 v48, v48, v88
    v_sub_f32 v49, v49, v88
    v_sub_f32 v50, v50, v88
    v_sub_f32 v51, v51, v88
    v_sub_f32 v56, v56, v88
    v_sub_f32 v57, v57, v88
    v_sub_f32 v58, v58, v88
    v_sub_f32 v59, v59, v88
    v_sub_f32 v60, v60, v89
    v_sub_f32 v61, v61, v89
    v_sub_f32 v62, v62, v89
    v_sub_f32 v63, v63, v89
    v_sub_f32 v68, v68, v89
    v_sub_f32 v69, v69, v89
    v_sub_f32 v70, v70, v89
    v_sub_f32 v71, v71, v89
    v_sub_f32 v72, v72, v90
    v_sub_f32 v73, v73, v90
    v_sub_f32 v74, v74, v90
    v_sub_f32 v75, v75, v90
    v_sub_f32 v80, v80, v90
    v_sub_f32 v81, v81, v90
    v_sub_f32 v82, v82, v90
    v_sub_f32 v83, v83, v90
    v_exp_f32 v0, v0
    v_exp_f32 v1, v1
    v_exp_f32 v2, v2
    v_exp_f32 v3, v3
    v_add_f32 v248, v248, v0
    v_add_f32 v248, v248, v1
    v_add_f32 v248, v248, v2
    v_add_f32 v248, v248, v3
    v_cvt_pk_bf16_f32 v0, v0, v1
    v_cvt_pk_bf16_f32 v1, v2, v3
    v_exp_f32 v12, v12
    v_exp_f32 v13, v13
    v_exp_f32 v14, v14
    v_exp_f32 v15, v15
    v_add_f32 v249, v249, v12
    v_add_f32 v249, v249, v13
    v_add_f32 v249, v249, v14
    v_add_f32 v249, v249, v15
    v_cvt_pk_bf16_f32 v12, v12, v13
    v_cvt_pk_bf16_f32 v13, v14, v15
    v_exp_f32 v24, v24
    v_exp_f32 v25, v25
    v_exp_f32 v26, v26
    v_exp_f32 v27, v27
    v_add_f32 v250, v250, v24
    v_add_f32 v250, v250, v25
    v_add_f32 v250, v250, v26
    v_add_f32 v250, v250, v27
    v_cvt_pk_bf16_f32 v24, v24, v25
    v_cvt_pk_bf16_f32 v25, v26, v27
    v_exp_f32 v36, v36
    v_exp_f32 v37, v37
    v_exp_f32 v38, v38
    v_exp_f32 v39, v39
    v_add_f32 v251, v251, v36
    v_add_f32 v251, v251, v37
    v_add_f32 v251, v251, v38
    v_add_f32 v251, v251, v39
    v_cvt_pk_bf16_f32 v36, v36, v37
    v_cvt_pk_bf16_f32 v37, v38, v39
    v_exp_f32 v48, v48
    v_exp_f32 v49, v49
    v_exp_f32 v50, v50
    v_exp_f32 v51, v51
    v_add_f32 v252, v252, v48
    v_add_f32 v252, v252, v49
    v_add_f32 v252, v252, v50
    v_add_f32 v252, v252, v51
    v_cvt_pk_bf16_f32 v48, v48, v49
    v_cvt_pk_bf16_f32 v49, v50, v51
    v_exp_f32 v60, v60
    v_exp_f32 v61, v61
    v_exp_f32 v62, v62
    v_exp_f32 v63, v63
    v_add_f32 v253, v253, v60
    v_add_f32 v253, v253, v61
    v_add_f32 v253, v253, v62
    v_add_f32 v253, v253, v63
    v_cvt_pk_bf16_f32 v60, v60, v61
    v_cvt_pk_bf16_f32 v61, v62, v63
    v_exp_f32 v72, v72
    v_exp_f32 v73, v73
    v_exp_f32 v74, v74
    v_exp_f32 v75, v75
    v_add_f32 v254, v254, v72
    v_add_f32 v254, v254, v73
    v_add_f32 v254, v254, v74
    v_add_f32 v254, v254, v75
    v_cvt_pk_bf16_f32 v72, v72, v73
    v_cvt_pk_bf16_f32 v73, v74, v75
    v_exp_f32 v8, v8
    v_exp_f32 v9, v9
    v_exp_f32 v10, v10
    v_exp_f32 v11, v11
    v_add_f32 v248, v248, v8
    v_add_f32 v248, v248, v9
    v_add_f32 v248, v248, v10
    v_add_f32 v248, v248, v11
    v_cvt_pk_bf16_f32 v2, v8, v9
    v_cvt_pk_bf16_f32 v3, v10, v11
    v_exp_f32 v20, v20
    v_exp_f32 v21, v21
    v_exp_f32 v22, v22
    v_exp_f32 v23, v23
    v_add_f32 v249, v249, v20
    v_add_f32 v249, v249, v21
    v_add_f32 v249, v249, v22
    v_add_f32 v249, v249, v23
    v_cvt_pk_bf16_f32 v14, v20, v21
    v_cvt_pk_bf16_f32 v15, v22, v23
    v_exp_f32 v32, v32
    v_exp_f32 v33, v33
    v_exp_f32 v34, v34
    v_exp_f32 v35, v35
    v_add_f32 v250, v250, v32
    v_add_f32 v250, v250, v33
    v_add_f32 v250, v250, v34
    v_add_f32 v250, v250, v35
    v_cvt_pk_bf16_f32 v26, v32, v33
    v_cvt_pk_bf16_f32 v27, v34, v35
    v_exp_f32 v44, v44
    v_exp_f32 v45, v45
    v_exp_f32 v46, v46
    v_exp_f32 v47, v47
    v_add_f32 v251, v251, v44
    v_add_f32 v251, v251, v45
    v_add_f32 v251, v251, v46
    v_add_f32 v251, v251, v47
    v_cvt_pk_bf16_f32 v38, v44, v45
    v_cvt_pk_bf16_f32 v39, v46, v47
    v_exp_f32 v56, v56
    v_exp_f32 v57, v57
    v_exp_f32 v58, v58
    v_exp_f32 v59, v59
    v_add_f32 v252, v252, v56
    v_add_f32 v252, v252, v57
    v_add_f32 v252, v252, v58
    v_add_f32 v252, v252, v59
    v_cvt_pk_bf16_f32 v50, v56, v57
    v_cvt_pk_bf16_f32 v51, v58, v59
    v_exp_f32 v68, v68
    v_exp_f32 v69, v69
    v_exp_f32 v70, v70
    v_exp_f32 v71, v71
    v_add_f32 v253, v253, v68
    v_add_f32 v253, v253, v69
    v_add_f32 v253, v253, v70
    v_add_f32 v253, v253, v71
    v_cvt_pk_bf16_f32 v62, v68, v69
    v_cvt_pk_bf16_f32 v63, v70, v71
    v_exp_f32 v80, v80
    v_exp_f32 v81, v81
    v_exp_f32 v82, v82
    v_exp_f32 v83, v83
    v_add_f32 v254, v254, v80
    v_add_f32 v254, v254, v81
    v_add_f32 v254, v254, v82
    v_add_f32 v254, v254, v83
    v_cvt_pk_bf16_f32 v74, v80, v81
    v_cvt_pk_bf16_f32 v75, v82, v83
    ds_read_b64_tr_b16 a[224:225], v246 offset:0
    ds_read_b64_tr_b16 a[226:227], v246 offset:512
    s_waitcnt lgkmcnt(0)
    v_mfma_f32_16x16x32_bf16 a[0:3], a[224:227], v[0:3], a[0:3]
    v_mfma_f32_16x16x32_bf16 a[4:7], a[224:227], v[12:15], a[4:7]
    v_mfma_f32_16x16x32_bf16 a[8:11], a[224:227], v[24:27], a[8:11]
    v_mfma_f32_16x16x32_bf16 a[12:15], a[224:227], v[36:39], a[12:15]
    v_mfma_f32_16x16x32_bf16 a[16:19], a[224:227], v[48:51], a[16:19]
    v_mfma_f32_16x16x32_bf16 a[20:23], a[224:227], v[60:63], a[20:23]
    v_mfma_f32_16x16x32_bf16 a[24:27], a[224:227], v[72:75], a[24:27]
    ds_read_b64_tr_b16 a[224:225], v246 offset:32
    ds_read_b64_tr_b16 a[226:227], v246 offset:544
    s_waitcnt lgkmcnt(0)
    v_mfma_f32_16x16x32_bf16 a[28:31], a[224:227], v[0:3], a[28:31]
    v_mfma_f32_16x16x32_bf16 a[32:35], a[224:227], v[12:15], a[32:35]
    v_mfma_f32_16x16x32_bf16 a[36:39], a[224:227], v[24:27], a[36:39]
    v_mfma_f32_16x16x32_bf16 a[40:43], a[224:227], v[36:39], a[40:43]
    v_mfma_f32_16x16x32_bf16 a[44:47], a[224:227], v[48:51], a[44:47]
    v_mfma_f32_16x16x32_bf16 a[48:51], a[224:227], v[60:63], a[48:51]
    v_mfma_f32_16x16x32_bf16 a[52:55], a[224:227], v[72:75], a[52:55]
    ds_read_b64_tr_b16 a[224:225], v246 offset:64
    ds_read_b64_tr_b16 a[226:227], v246 offset:576
    s_waitcnt lgkmcnt(0)
    v_mfma_f32_16x16x32_bf16 a[56:59], a[224:227], v[0:3], a[56:59]
    v_mfma_f32_16x16x32_bf16 a[60:63], a[224:227], v[12:15], a[60:63]
    v_mfma_f32_16x16x32_bf16 a[64:67], a[224:227], v[24:27], a[64:67]
    v_mfma_f32_16x16x32_bf16 a[68:71], a[224:227], v[36:39], a[68:71]
    v_mfma_f32_16x16x32_bf16 a[72:75], a[224:227], v[48:51], a[72:75]
    v_mfma_f32_16x16x32_bf16 a[76:79], a[224:227], v[60:63], a[76:79]
    v_mfma_f32_16x16x32_bf16 a[80:83], a[224:227], v[72:75], a[80:83]
    ds_read_b64_tr_b16 a[224:225], v246 offset:96
    ds_read_b64_tr_b16 a[226:227], v246 offset:608
    s_waitcnt lgkmcnt(0)
    v_mfma_f32_16x16x32_bf16 a[84:87], a[224:227], v[0:3], a[84:87]
    v_mfma_f32_16x16x32_bf16 a[88:91], a[224:227], v[12:15], a[88:91]
    v_mfma_f32_16x16x32_bf16 a[92:95], a[224:227], v[24:27], a[92:95]
    v_mfma_f32_16x16x32_bf16 a[96:99], a[224:227], v[36:39], a[96:99]
    v_mfma_f32_16x16x32_bf16 a[100:103], a[224:227], v[48:51], a[100:103]
    v_mfma_f32_16x16x32_bf16 a[104:107], a[224:227], v[60:63], a[104:107]
    v_mfma_f32_16x16x32_bf16 a[108:111], a[224:227], v[72:75], a[108:111]
    ds_read_b64_tr_b16 a[224:225], v246 offset:128
    ds_read_b64_tr_b16 a[226:227], v246 offset:640
    s_waitcnt lgkmcnt(0)
    v_mfma_f32_16x16x32_bf16 a[112:115], a[224:227], v[0:3], a[112:115]
    v_mfma_f32_16x16x32_bf16 a[116:119], a[224:227], v[12:15], a[116:119]
    v_mfma_f32_16x16x32_bf16 a[120:123], a[224:227], v[24:27], a[120:123]
    v_mfma_f32_16x16x32_bf16 a[124:127], a[224:227], v[36:39], a[124:127]
    v_mfma_f32_16x16x32_bf16 a[128:131], a[224:227], v[48:51], a[128:131]
    v_mfma_f32_16x16x32_bf16 a[132:135], a[224:227], v[60:63], a[132:135]
    v_mfma_f32_16x16x32_bf16 a[136:139], a[224:227], v[72:75], a[136:139]
    ds_read_b64_tr_b16 a[224:225], v246 offset:160
    ds_read_b64_tr_b16 a[226:227], v246 offset:672
    s_waitcnt lgkmcnt(0)
    v_mfma_f32_16x16x32_bf16 a[140:143], a[224:227], v[0:3], a[140:143]
    v_mfma_f32_16x16x32_bf16 a[144:147], a[224:227], v[12:15], a[144:147]
    v_mfma_f32_16x16x32_bf16 a[148:151], a[224:227], v[24:27], a[148:151]
    v_mfma_f32_16x16x32_bf16 a[152:155], a[224:227], v[36:39], a[152:155]
    v_mfma_f32_16x16x32_bf16 a[156:159], a[224:227], v[48:51], a[156:159]
    v_mfma_f32_16x16x32_bf16 a[160:163], a[224:227], v[60:63], a[160:163]
    v_mfma_f32_16x16x32_bf16 a[164:167], a[224:227], v[72:75], a[164:167]
    ds_read_b64_tr_b16 a[224:225], v246 offset:192
    ds_read_b64_tr_b16 a[226:227], v246 offset:704
    s_waitcnt lgkmcnt(0)
    v_mfma_f32_16x16x32_bf16 a[168:171], a[224:227], v[0:3], a[168:171]
    v_mfma_f32_16x16x32_bf16 a[172:175], a[224:227], v[12:15], a[172:175]
    v_mfma_f32_16x16x32_bf16 a[176:179], a[224:227], v[24:27], a[176:179]
    v_mfma_f32_16x16x32_bf16 a[180:183], a[224:227], v[36:39], a[180:183]
    v_mfma_f32_16x16x32_bf16 a[184:187], a[224:227], v[48:51], a[184:187]
    v_mfma_f32_16x16x32_bf16 a[188:191], a[224:227], v[60:63], a[188:191]
    v_mfma_f32_16x16x32_bf16 a[192:195], a[224:227], v[72:75], a[192:195]
    ds_read_b64_tr_b16 a[224:225], v246 offset:224
    ds_read_b64_tr_b16 a[226:227], v246 offset:736
    s_waitcnt lgkmcnt(0)
    v_mfma_f32_16x16x32_bf16 a[196:199], a[224:227], v[0:3], a[196:199]
    v_mfma_f32_16x16x32_bf16 a[200:203], a[224:227], v[12:15], a[200:203]
    v_mfma_f32_16x16x32_bf16 a[204:207], a[224:227], v[24:27], a[204:207]
    v_mfma_f32_16x16x32_bf16 a[208:211], a[224:227], v[36:39], a[208:211]
    v_mfma_f32_16x16x32_bf16 a[212:215], a[224:227], v[48:51], a[212:215]
    v_mfma_f32_16x16x32_bf16 a[216:219], a[224:227], v[60:63], a[216:219]
    v_mfma_f32_16x16x32_bf16 a[220:223], a[224:227], v[72:75], a[220:223]
    s_nop 7
L_snext:
    s_add_u32 s63, s63, 8192
    s_add_u32 s66, s66, 1
    s_cmp_lt_u32 s66, 32
    s_cbranch_scc1 L_sloop
    s_nop 7
    v_mov_b32 v227, v248
    s_nop 1
    v_permlane32_swap_b32 v248, v227
    v_add_f32 v248, v248, v227
    v_mov_b32 v227, v248
    s_nop 1
    v_permlane16_swap_b32 v248, v227
    v_add_f32 v248, v248, v227
    v_rcp_f32 v248, v248
    v_mov_b32 v227, v249
    s_nop 1
    v_permlane32_swap_b32 v249, v227
    v_add_f32 v249, v249, v227
    v_mov_b32 v227, v249
    s_nop 1
    v_permlane16_swap_b32 v249, v227
    v_add_f32 v249, v249, v227
    v_rcp_f32 v249, v249
    v_mov_b32 v227, v250
    s_nop 1
    v_permlane32_swap_b32 v250, v227
    v_add_f32 v250, v250, v227
    v_mov_b32 v227, v250
    s_nop 1
    v_permlane16_swap_b32 v250, v227
    v_add_f32 v250, v250, v227
    v_rcp_f32 v250, v250
    v_mov_b32 v227, v251
    s_nop 1
    v_permlane32_swap_b32 v251, v227
    v_add_f32 v251, v251, v227
    v_mov_b32 v227, v251
    s_nop 1
    v_permlane16_swap_b32 v251, v227
    v_add_f32 v251, v251, v227
    v_rcp_f32 v251, v251
    v_mov_b32 v227, v252
    s_nop 1
    v_permlane32_swap_b32 v252, v227
    v_add_f32 v252, v252, v227
    v_mov_b32 v227, v252
    s_nop 1
    v_permlane16_swap_b32 v252, v227
    v_add_f32 v252, v252, v227
    v_rcp_f32 v252, v252
    v_mov_b32 v227, v253
    s_nop 1
    v_permlane32_swap_b32 v253, v227
    v_add_f32 v253, v253, v227
    v_mov_b32 v227, v253
    s_nop 1
    v_permlane16_swap_b32 v253, v227
    v_add_f32 v253, v253, v227
    v_rcp_f32 v253, v253
    v_mov_b32 v227, v254
    s_nop 1
    v_permlane32_swap_b32 v254, v227
    v_add_f32 v254, v254, v227
    v_mov_b32 v227, v254
    s_nop 1
    v_permlane16_swap_b32 v254, v227
    v_add_f32 v254, v254, v227
    v_rcp_f32 v254, v254
    s_nop 1
    s_branch L_norm
L_end:
    s_endpgm
.section .rodata,"a"
.p2align 6
.amdhsa_kernel concat_heads__gqa_block_cached__gqa_block_cached__near_ridge_kernel
  .amdhsa_next_free_vgpr 512
  .amdhsa_next_free_sgpr 102
  .amdhsa_accum_offset 256
  .amdhsa_group_segment_fixed_size 0
  .amdhsa_kernarg_size 104
  .amdhsa_user_sgpr_count 2
  .amdhsa_user_sgpr_kernarg_segment_ptr 1
  .amdhsa_system_sgpr_workgroup_id_x 1
.end_amdhsa_kernel
```
